```python
import torch

def _softmax(x, axis=-1):
    return torch.softmax(x, dim=axis)
def _gelu(x):
    return torch.nn.functional.gelu(x, approximate="tanh")
def _silu(x):
    return torch.nn.functional.silu(x)
def _sigmoid(x):
    return torch.sigmoid(x)
def _layernorm(x, axis=-1, eps=1e-5):
    m = x.mean(dim=axis, keepdim=True)
    v = x.var(dim=axis, keepdim=True, unbiased=False)
    return (x - m) / torch.sqrt(v + eps)
def _scatter_add(tgt, idx, src, axis=0):
    return tgt.clone().index_add_(axis, idx, src)
def _segment_sum(src, seg, n):
    out = torch.zeros((n,) + src.shape[1:], dtype=src.dtype)
    return out.index_add_(0, seg, src)
def _pad(x, pw):
    flat = tuple(v for pair in reversed(pw) for v in pair)
    return torch.nn.functional.pad(x, flat)

kernel_name = 'gated_mix__linear_kernel_hedgehog__glu_gated_glu__prompt'

def setup_inputs():

    _w = (lambda a: (lambda t: t.to(torch.bfloat16) if t.is_floating_point() else t)(torch.as_tensor(a)))
    def _A_setup():
        B, S, D, H = 1, 2048, 448, 16
        Dh = D // H
        return {
            "x": _w((lambda *s: torch.randn(*s, dtype=torch.bfloat16) * 0.05)(B, S, D)),
            "wqkv": _w((lambda *s: torch.randn(*s, dtype=torch.bfloat16) * 0.8)(D, 3 * D)),
            "w_phi": _w((lambda *s: torch.randn(*s, dtype=torch.bfloat16) * 0.8)(H, Dh, Dh) * (Dh ** -0.5)),
            "wo": _w((lambda *s: torch.randn(*s, dtype=torch.bfloat16) * 0.2)(D, D)),
        }
    _A_in = _A_setup()

    def _B_setup():
        B, S, D, F = 1, 2048, 448, 1792
        return {
            "x": _w((lambda *s: torch.randn(*s, dtype=torch.bfloat16) * 0.05)(B, S, D)),
            "w_gate": _w((lambda *s: torch.randn(*s, dtype=torch.bfloat16) * 0.4)(D, F)),
            "w_up": _w((lambda *s: torch.randn(*s, dtype=torch.bfloat16) * 0.05)(D, F)),
            "w_down": _w((lambda *s: torch.randn(*s, dtype=torch.bfloat16) * 0.05)(F, D)),
        }
    _B_in = _B_setup()

    return {
        "A_x": _A_in["x"],
        "A_wqkv": _A_in["wqkv"],
        "A_w_phi": _A_in["w_phi"],
        "A_wo": _A_in["wo"],
        "B_x": _B_in["x"],
        "B_w_gate": _B_in["w_gate"],
        "B_w_up": _B_in["w_up"],
        "B_w_down": _B_in["w_down"],
        "gate_w": _w((lambda *s: torch.randn(*s, dtype=torch.bfloat16) * 0.05)(448) * 16.0),
    }

def reference(A_x, A_wqkv, A_w_phi, A_wo, B_x, B_w_gate, B_w_up, B_w_down, gate_w):
    def _A_ref(x, wqkv, w_phi, wo):
        B, S, D = x.shape
        H = 16; Dh = D // H
        qkv = (lambda x, *d: x.permute(*d))((x @ wqkv).reshape(B, S, 3, H, Dh), 2, 0, 3, 1, 4)
        q, k, v = qkv[0], qkv[1], qkv[2]
        pq = torch.einsum("bhsd,hdf->bhsf", q, w_phi)
        pk = torch.einsum("bhsd,hdf->bhsf", k, w_phi)
        phi_q = torch.concatenate([_softmax(pq, axis=-1), _softmax(-pq, axis=-1)], axis=-1)
        phi_k = torch.concatenate([_softmax(pk, axis=-1), _softmax(-pk, axis=-1)], axis=-1)
        kv = torch.einsum("bhsf,bhsd->bhfd", phi_k, v)
        z  = torch.einsum("bhsf->bhf", phi_k)
        num = torch.einsum("bhqf,bhfd->bhqd", phi_q, kv)
        den = torch.einsum("bhqf,bhf->bhq", phi_q, z)[..., None] + 1e-6
        o = num / den
        return (lambda x, *d: x.permute(*d))(o, 0, 2, 1, 3).reshape(B, S, D) @ wo

    def _B_ref(x, w_gate, w_up, w_down):
        g = torch.einsum("bsd,df->bsf", x, w_gate)
        u = torch.einsum("bsd,df->bsf", x, w_up)
        h = _sigmoid(g) * u
        return torch.einsum("bsf,fd->bsd", h, w_down)

    x = A_x
    g = _sigmoid((x * gate_w).sum(-1, keepdims=True))
    a = _A_ref(x, A_wqkv, A_w_phi, A_wo)
    b = _B_ref(x, B_w_gate, B_w_up, B_w_down)
    return g * a + (1 - g) * b
```

```asm
; @launch grid=(256,1,1) block=(512,1,1) lds=163840
.amdgcn_target "amdgcn-amd-amdhsa--gfx950"
.text
.globl gated_mix__linear_kernel_hedgehog__glu_gated_glu__prompt_kernel
.p2align 12
.p2align 8
.type gated_mix__linear_kernel_hedgehog__glu_gated_glu__prompt_kernel,@function
gated_mix__linear_kernel_hedgehog__glu_gated_glu__prompt_kernel:
  s_load_dwordx16 s[64:79], s[0:1], 0
  s_load_dwordx8 s[80:87], s[0:1], 64
  s_cmp_ge_u32 s2, 256
  s_cbranch_scc1 L_exit
  v_lshrrev_b32 v22, 6, v0
  v_lshrrev_b32 v27, 3, v0
  v_readfirstlane_b32 s60, v22
  v_and_b32 v23, 7, v0
  s_bfe_u32 s95, s2, 0x30003
  s_or_b32 s8, s95, s60
  s_cbranch_scc1 L_nh
  s_getpc_b64 s[88:89]
L_pc0:
  v_min_u32 v248, 2, v27
  v_lshlrev_b32 v248, 14, v248
  v_lshl_add_u32 v248, v23, 7, v248
  v_add_u32 v248, L_far - L_pc0, v248
  global_load_dword v20, v248, s[88:89]
L_nh:
  s_lshr_b32 s4, s2, 6
  s_and_b32 s5, s2, 6
  s_and_b32 s8, s2, 1
  s_lshl3_add_u32 s10, s8, s95
  s_lshr_b32 s14, s95, 1
  s_xor_b32 s14, s14, s4
  s_and_b32 s15, s95, 1
  s_mul_i32 s15, s15, 2
  s_add_u32 s15, s5, s15
  s_sub_u32 s8, s15, 7
  s_cselect_b32 s15, s15, s8
  s_add_u32 s13, s14, s15
  s_sub_u32 s8, s13, 7
  s_cselect_b32 s13, s13, s8
  s_lshl_b32 s13, s13, 7
  v_bfe_u32 v24, v0, 4, 3
  v_xor_b32 v24, v24, v23
  v_mul_u32_u24 v25, 896, v27
  s_mul_i32 s8, s10, 114688
  v_lshlrev_b32 v24, 4, v24
  v_add3_u32 v1, v24, v25, s8
  s_lshl_b32 s61, s60, 10
  s_mov_b32 s18, 1835008
  s_mov_b32 s19, 0x20000
  s_add_u32 s9, s13, 57344
  s_mov_b32 m0, s61
  v_lshrrev_b32 v24, 2, v0
  v_and_b32 v24, 4, v24
  v_xor_b32 v24, v24, v23
  v_mul_u32_u24 v26, 2688, v27
  s_waitcnt lgkmcnt(0)
  s_mov_b64 s[16:17], s[64:65]
  buffer_load_dwordx4 v1, s[16:19], s13 offen lds
  s_add_u32 m0, s61, 8192
  s_and_b32 s8, s4, 1
  buffer_load_dwordx4 v1, s[16:19], s9 offen lds
  s_add_u32 s6, s5, s8
  v_lshl_add_u32 v4, v24, 4, v25
  v_min_u32 v24, 6, v24
  v_lshl_add_u32 v3, v24, 4, v26
  s_add_u32 m0, s61, 65536
  s_cmp_ge_u32 s4, 2
  s_cbranch_scc1 L_w0u
  s_mov_b64 s[20:21], s[66:67]
  s_mov_b32 s22, 1204224
  s_mov_b32 s23, 0x20000
  s_mul_i32 s8, s6, 112
  s_add_u32 s8, s8, 896
  v_add_u32 v3, s8, v3
  s_mul_i32 s8, s13, 1344
  buffer_load_dwordx4 v3, s[20:23], s8 offen lds
  s_mov_b32 s11, s6
  s_add_u32 s12, s6, 20
  s_mov_b32 s3, L_KVQ - L_pc
  s_sub_u32 s8, s6, 1
  s_cmp_lt_u32 s8, 6
  s_cselect_b32 s7, 0, 1
  s_cselect_b32 s3, L_KV - L_pc, s3
  s_lshl_b32 s8, s12, 7
  v_add3_u32 v2, v4, v26, s8
  s_mov_b64 s[32:33], s[74:75]
  s_mov_b32 s34, 1605632
  s_mov_b32 s35, 0x20000
  s_mov_b64 s[36:37], s[76:77]
  s_mov_b32 s38, 1605632
  s_mov_b32 s39, 0x20000
  s_branch L_w0d
L_w0u:
  s_lshr_b32 s7, s2, 2
  s_xor_b32 s7, s7, s95
  s_andn2_b32 s7, s4, s7
  s_and_b32 s7, s7, 1
  s_bfe_u32 s11, s2, 0x10001
  s_lshl1_add_u32 s9, s7, s11
  s_mov_b64 s[32:33], s[74:75]
  s_mov_b32 s34, 1605632
  s_mov_b32 s35, 0x20000
  s_add_u32 s9, s9, 4
  s_lshr_b32 s12, s5, 1
  s_cmp_eq_u32 s4, 2
  s_cselect_b32 s12, s12, s9
  s_lshl_b32 s8, s12, 7
  v_add3_u32 v2, v4, v26, s8
  s_mul_i32 s8, s13, 1792
  buffer_load_dwordx4 v2, s[32:35], s8 offen lds
  s_add_u32 m0, s61, 73728
  s_mov_b64 s[36:37], s[76:77]
  s_mov_b32 s38, 1605632
  s_mov_b32 s39, 0x20000
  buffer_load_dwordx4 v2, s[36:39], s8 offen lds
  s_mov_b32 s3, L_Q - L_pc
  s_cmp_eq_u32 s7, 1
  s_cselect_b32 s7, 3, 2
  s_cselect_b32 s3, L_L - L_pc, s3
  s_lshl_b32 s11, s11, 2
  s_mul_i32 s8, s11, 112
  v_add_u32 v3, s8, v3
  s_mov_b64 s[20:21], s[66:67]
  s_mov_b32 s22, 1204224
  s_mov_b32 s23, 0x20000
L_w0d:
  v_and_b32 v0, 63, v0
  s_getpc_b64 s[88:89]
L_pc:
  s_cmp_lg_u32 s60, 0
  s_cbranch_scc1 L_npf
  s_add_u32 s88, s88, s3
  s_addc_u32 s89, s89, 0
  s_lshr_b32 s8, s95, 1
  s_mul_i32 s8, s8, 27
  v_min_u32 v248, 26, v0
  v_add_lshl_u32 v248, v248, s8, 7
  global_load_dword v20, v248, s[88:89]
L_npf:
  s_mov_b64 s[24:25], s[68:69]
  s_mov_b32 s26, 25088
  s_mov_b32 s27, 0x20000
  s_mov_b64 s[28:29], s[70:71]
  s_mov_b32 s30, 401408
  s_mov_b32 s31, 0x20000
  s_mov_b64 s[40:41], s[78:79]
  s_mov_b32 s42, 1605632
  s_mov_b32 s43, 0x20000
  s_mov_b64 s[44:45], s[80:81]
  s_mov_b32 s46, 896
  s_mov_b32 s47, 0x20000
  s_mov_b64 s[48:49], s[82:83]
  s_mov_b32 s50, 1835008
  s_mov_b32 s51, 0x20000
  s_mov_b64 s[56:57], s[84:85]
  s_mov_b32 s58, 256
  s_mov_b32 s59, 0x20000
  s_mov_b64 s[52:53], s[86:87]
  s_mov_b32 s54, 11538432
  s_mov_b32 s55, 0x20000
  s_cmp_lg_u32 s2, 0
  s_cbranch_scc1 L_nz
  s_cmp_ge_u32 s60, 3
  s_cbranch_scc1 L_nz
  v_mov_b32 v249, 0
  v_lshlrev_b32 v252, 7, v0
  s_lshl_b32 s8, s60, 13
  s_add_u32 s8, s8, 9830400
  buffer_store_dword v249, v252, s[52:55], s8 offen sc1
L_nz:
  s_mov_b32 s64, s10
  s_mov_b32 s65, s11
  s_mov_b32 s66, s12
  s_mov_b32 s68, s13
  s_lshr_b32 s62, s60, 2
  s_and_b32 s63, s60, 3
  v_lshlrev_b32 v5, 4, v0
  s_mul_i32 s9, s14, 6
  s_lshr_b32 s9, 8675940, s9
  s_add_u32 s3, s15, 4
  s_xor_b32 s69, s14, 1
  s_add_u32 s69, s69, s15
  s_sub_u32 s8, s69, 7
  s_cselect_b32 s69, s69, s8
  s_lshl_b32 s69, s69, 7
  s_xor_b32 s70, s14, 2
  s_add_u32 s70, s70, s15
  s_sub_u32 s8, s70, 7
  s_cselect_b32 s70, s70, s8
  s_lshl_b32 s70, s70, 7
  s_xor_b32 s71, s14, 3
  s_add_u32 s71, s71, s15
  s_sub_u32 s8, s71, 7
  s_cselect_b32 s71, s71, s8
  s_lshl_b32 s71, s71, 7
  s_bfe_u32 s72, s9, 131072
  s_add_u32 s72, s72, s3
  s_sub_u32 s8, s72, 7
  s_cselect_b32 s72, s72, s8
  s_lshl_b32 s72, s72, 7
  s_bfe_u32 s73, s9, 131074
  s_add_u32 s73, s73, s3
  s_sub_u32 s8, s73, 7
  s_cselect_b32 s73, s73, s8
  s_lshl_b32 s73, s73, 7
  s_bfe_u32 s74, s9, 131076
  s_add_u32 s74, s74, s3
  s_sub_u32 s8, s74, 7
  s_cselect_b32 s74, s74, s8
  s_lshl_b32 s74, s74, 7
  s_mov_b32 s87, 1
  v_lshrrev_b32 v22, 5, v0
  v_bfe_u32 v23, v0, 1, 3
  v_xor_b32 v23, v23, v22
  v_and_b32 v24, 31, v0
  v_lshl_or_b32 v23, v24, 3, v23
  s_lshl_b32 s77, s63, 12
  v_lshl_add_u32 v10, v23, 4, s77
  v_xor_b32 v11, 32, v10
  v_xor_b32 v12, 64, v10
  v_xor_b32 v13, 96, v10
  v_bfe_u32 v23, v0, 2, 2
  v_bfe_u32 v24, v0, 4, 1
  v_and_b32 v25, 3, v0
  v_lshl_or_b32 v24, v24, 2, v25
  v_and_b32 v25, 8, v0
  v_lshlrev_b32 v25, 3, v25
  v_lshl_add_u32 v26, v22, 3, v23
  v_lshlrev_b32 v26, 7, v26
  s_lshl_b32 s77, s62, 6
  v_lshl_add_u32 v27, v24, 3, s77
  v_xad_u32 v6, v27, v25, v26
  s_mul_i32 s77, s62, 56
  v_lshl_add_u32 v27, v24, 3, s77
  v_xad_u32 v7, v27, v25, v26
  s_cmp_eq_u32 s7, 0
  s_cbranch_scc1 L_KV
  s_cmp_eq_u32 s7, 2
  s_cbranch_scc1 L_Q
  s_cmp_eq_u32 s7, 1
  s_cbranch_scc1 L_KVQ
L_L:
  s_add_u32 m0, s61, 16384
  s_nop 0
  buffer_load_dwordx4 v1, s[16:19], s69 offen lds
  s_add_u32 m0, s61, 24576
  s_add_u32 s76, s69, 57344
  buffer_load_dwordx4 v1, s[16:19], s76 offen lds
  s_add_u32 m0, s61, 81920
  s_mul_i32 s5, s69, 1792
  buffer_load_dwordx4 v2, s[32:35], s5 offen lds
  s_mov_b32 s88, 0x3fb8aa3b
  s_mov_b32 s90, 0xbfb8aa3b
  s_lshl2_add_u32 s80, s64, s63
  s_mul_i32 s80, s80, 145
  s_lshl1_add_u32 s80, s62, s80
  s_lshl_b32 s80, s80, 10
  s_lshl_b32 s84, s64, 10
  s_add_u32 s14, s52, 9830400
  s_addc_u32 s15, s53, 0
  v_lshrrev_b32 v248, 5, v0
  v_bfe_u32 v249, v0, 2, 2
  v_lshl_add_u32 v248, v248, 2, v249
  v_mul_u32_u24 v248, 56, v248
  v_bfe_u32 v249, v0, 4, 1
  v_and_b32 v250, 3, v0
  v_lshl_add_u32 v249, v249, 2, v250
  v_min_u32 v249, 6, v249
  v_lshl_add_u32 v248, v249, 3, v248
  s_mul_i32 s77, s62, 1568
  v_add_u32 v19, s77, v248
  v_add_u32 v252, 0x10000, v7
  v_add_u32 v253, 0x20000, v7
  v_mov_b32 v250, v19
  s_mov_b32 exec_lo, 0
  v_mov_b32 v250, 5120
  s_mov_b32 exec_lo, -1
  s_lshl_b32 s77, s62, 12
  v_add_u32 v18, s77, v5
  s_lshl_b32 s97, s65, 13
  s_add_u32 s97, s97, 9699328
  s_add_u32 s97, s97, s61
  s_add_u32 s92, s65, s63
  s_lshl_b32 s92, s92, 7
  s_add_u32 s92, s92, 16384
  s_lshl_b32 s86, s65, 12
  s_add_u32 s86, s86, 114688
  s_waitcnt vmcnt(3)
  s_barrier
  v_add_u32 v14, 65536, v6
  ds_read_b128 v[136:139], v10 offset:0
  ds_read_b64_tr_b16 v[48:49], v14 offset:0
  ds_read_b64_tr_b16 v[50:51], v14 offset:512
  v_add_u32 v15, 73728, v6
  ds_read_b128 v[140:143], v11 offset:0
  ds_read_b64_tr_b16 v[52:53], v15 offset:0
  ds_read_b64_tr_b16 v[54:55], v15 offset:512
  ds_read_b128 v[144:147], v12 offset:0
  ds_read_b64_tr_b16 v[56:57], v14 offset:2048
  ds_read_b64_tr_b16 v[58:59], v14 offset:2560
  ds_read_b128 v[148:151], v13 offset:0
  ds_read_b64_tr_b16 v[60:61], v15 offset:2048
  ds_read_b64_tr_b16 v[62:63], v15 offset:2560
  s_waitcnt lgkmcnt(6)
  v_mfma_f32_32x32x16_bf16 v[72:87], v[48:51], v[136:139], 0
  s_add_u32 m0, s61, 90112
  ds_read_b64_tr_b16 v[64:65], v14 offset:4096
  ds_read_b64_tr_b16 v[66:67], v14 offset:4608
  buffer_load_dwordx4 v2, s[36:39], s5 offen lds
  s_add_u32 m0, s61, 32768
  s_nop 0
  buffer_load_dwordx4 v1, s[16:19], s70 offen lds
  v_mfma_f32_32x32x16_bf16 v[88:103], v[52:55], v[136:139], 0
  s_add_u32 m0, s61, 40960
  ds_read_b64_tr_b16 v[68:69], v15 offset:4096
  ds_read_b64_tr_b16 v[70:71], v15 offset:4608
  s_add_u32 s76, s70, 57344
  buffer_load_dwordx4 v1, s[16:19], s76 offen lds
  s_add_u32 m0, s61, 98304
  s_mul_i32 s6, s70, 1792
  buffer_load_dwordx4 v2, s[32:35], s6 offen lds
  s_waitcnt lgkmcnt(4)
  v_mfma_f32_32x32x16_bf16 v[72:87], v[56:59], v[140:143], v[72:87]
  s_add_u32 m0, s61, 106496
  ds_read_b64_tr_b16 v[48:49], v14 offset:6144
  ds_read_b64_tr_b16 v[50:51], v14 offset:6656
  buffer_load_dwordx4 v2, s[36:39], s6 offen lds
  s_add_u32 m0, s61, 49152
  s_nop 0
  buffer_load_dwordx4 v1, s[16:19], s71 offen lds
  v_mfma_f32_32x32x16_bf16 v[88:103], v[60:63], v[140:143], v[88:103]
  s_add_u32 m0, s61, 57344
  ds_read_b64_tr_b16 v[52:53], v15 offset:6144
  ds_read_b64_tr_b16 v[54:55], v15 offset:6656
  s_add_u32 s76, s71, 57344
  buffer_load_dwordx4 v1, s[16:19], s76 offen lds
  s_waitcnt vmcnt(6)
  s_barrier
  s_waitcnt lgkmcnt(4)
  v_mfma_f32_32x32x16_bf16 v[72:87], v[64:67], v[144:147], v[72:87]
  s_add_u32 m0, s61, 114688
  v_add_u32 v14, 81920, v6
  ds_read_b128 v[152:155], v10 offset:16384
  ds_read_b64_tr_b16 v[56:57], v14 offset:0
  ds_read_b64_tr_b16 v[58:59], v14 offset:512
  s_mul_i32 s7, s71, 1792
  buffer_load_dwordx4 v2, s[32:35], s7 offen lds
  v_mfma_f32_32x32x16_bf16 v[88:103], v[68:71], v[144:147], v[88:103]
  s_add_u32 m0, s61, 122880
  v_add_u32 v15, 90112, v6
  ds_read_b128 v[156:159], v11 offset:16384
  ds_read_b64_tr_b16 v[60:61], v15 offset:0
  ds_read_b64_tr_b16 v[62:63], v15 offset:512
  buffer_load_dwordx4 v2, s[36:39], s7 offen lds
  s_waitcnt lgkmcnt(6)
  v_mfma_f32_32x32x16_bf16 v[72:87], v[48:51], v[148:151], v[72:87]
  ds_read_b128 v[160:163], v12 offset:16384
  ds_read_b64_tr_b16 v[64:65], v14 offset:2048
  ds_read_b64_tr_b16 v[66:67], v14 offset:2560
  v_mfma_f32_32x32x16_bf16 v[88:103], v[52:55], v[148:151], v[88:103]
  s_add_u32 m0, s61, 0
  ds_read_b128 v[164:167], v13 offset:16384
  ds_read_b64_tr_b16 v[68:69], v15 offset:2048
  ds_read_b64_tr_b16 v[70:71], v15 offset:2560
  buffer_load_dwordx4 v1, s[16:19], s72 offen lds
  s_waitcnt lgkmcnt(6)
  v_mfma_f32_32x32x16_bf16 v[72:87], v[56:59], v[152:155], v[72:87]
  s_add_u32 m0, s61, 8192
  ds_read_b64_tr_b16 v[48:49], v14 offset:4096
  ds_read_b64_tr_b16 v[50:51], v14 offset:4608
  s_add_u32 s76, s72, 57344
  buffer_load_dwordx4 v1, s[16:19], s76 offen lds
  v_mfma_f32_32x32x16_bf16 v[88:103], v[60:63], v[152:155], v[88:103]
  ds_read_b64_tr_b16 v[52:53], v15 offset:4096
  ds_read_b64_tr_b16 v[54:55], v15 offset:4608
  s_waitcnt lgkmcnt(4)
  v_mfma_f32_32x32x16_bf16 v[72:87], v[64:67], v[156:159], v[72:87]
  s_add_u32 m0, s61, 131072
  ds_read_b64_tr_b16 v[56:57], v14 offset:6144
  ds_read_b64_tr_b16 v[58:59], v14 offset:6656
  s_mul_i32 s8, s72, 1792
  buffer_load_dwordx4 v2, s[32:35], s8 offen lds
  v_mfma_f32_32x32x16_bf16 v[88:103], v[68:71], v[156:159], v[88:103]
  ds_read_b64_tr_b16 v[60:61], v15 offset:6144
  ds_read_b64_tr_b16 v[62:63], v15 offset:6656
  s_waitcnt vmcnt(7)
  s_barrier
  s_waitcnt lgkmcnt(4)
  v_mfma_f32_32x32x16_bf16 v[72:87], v[48:51], v[160:163], v[72:87]
  s_add_u32 m0, s61, 65536
  v_add_u32 v14, 98304, v6
  ds_read_b128 v[168:171], v10 offset:32768
  ds_read_b64_tr_b16 v[64:65], v14 offset:0
  ds_read_b64_tr_b16 v[66:67], v14 offset:512
  buffer_load_dwordx4 v2, s[36:39], s8 offen lds
  v_mfma_f32_32x32x16_bf16 v[88:103], v[52:55], v[160:163], v[88:103]
  v_add_u32 v15, 106496, v6
  ds_read_b128 v[172:175], v11 offset:32768
  ds_read_b64_tr_b16 v[68:69], v15 offset:0
  ds_read_b64_tr_b16 v[70:71], v15 offset:512
  s_waitcnt lgkmcnt(6)
  v_mfma_f32_32x32x16_bf16 v[72:87], v[56:59], v[164:167], v[72:87]
  s_add_u32 m0, s61, 16384
  ds_read_b128 v[176:179], v12 offset:32768
  ds_read_b64_tr_b16 v[48:49], v14 offset:2048
  ds_read_b64_tr_b16 v[50:51], v14 offset:2560
  buffer_load_dwordx4 v1, s[16:19], s73 offen lds
  v_mfma_f32_32x32x16_bf16 v[88:103], v[60:63], v[164:167], v[88:103]
  ds_read_b128 v[180:183], v13 offset:32768
  ds_read_b64_tr_b16 v[52:53], v15 offset:2048
  ds_read_b64_tr_b16 v[54:55], v15 offset:2560
  s_waitcnt lgkmcnt(6)
  v_mfma_f32_32x32x16_bf16 v[72:87], v[64:67], v[168:171], v[72:87]
  s_add_u32 m0, s61, 24576
  ds_read_b64_tr_b16 v[56:57], v14 offset:4096
  ds_read_b64_tr_b16 v[58:59], v14 offset:4608
  s_add_u32 s76, s73, 57344
  buffer_load_dwordx4 v1, s[16:19], s76 offen lds
  v_mfma_f32_32x32x16_bf16 v[88:103], v[68:71], v[168:171], v[88:103]
  ds_read_b64_tr_b16 v[60:61], v15 offset:4096
  ds_read_b64_tr_b16 v[62:63], v15 offset:4608
  s_waitcnt lgkmcnt(4)
  v_mfma_f32_32x32x16_bf16 v[72:87], v[48:51], v[172:175], v[72:87]
  s_add_u32 m0, s61, 73728
  ds_read_b64_tr_b16 v[64:65], v14 offset:6144
  ds_read_b64_tr_b16 v[66:67], v14 offset:6656
  s_mul_i32 s9, s73, 1792
  buffer_load_dwordx4 v2, s[32:35], s9 offen lds
  v_mfma_f32_32x32x16_bf16 v[88:103], v[52:55], v[172:175], v[88:103]
  ds_read_b64_tr_b16 v[68:69], v15 offset:6144
  ds_read_b64_tr_b16 v[70:71], v15 offset:6656
  s_waitcnt vmcnt(7)
  s_barrier
  s_waitcnt lgkmcnt(4)
  v_mfma_f32_32x32x16_bf16 v[72:87], v[56:59], v[176:179], v[72:87]
  s_add_u32 m0, s61, 81920
  v_add_u32 v14, 114688, v6
  ds_read_b128 v[184:187], v10 offset:49152
  ds_read_b64_tr_b16 v[48:49], v14 offset:0
  ds_read_b64_tr_b16 v[50:51], v14 offset:512
  buffer_load_dwordx4 v2, s[36:39], s9 offen lds
  v_mfma_f32_32x32x16_bf16 v[88:103], v[60:63], v[176:179], v[88:103]
  v_add_u32 v15, 122880, v6
  ds_read_b128 v[188:191], v11 offset:49152
  ds_read_b64_tr_b16 v[52:53], v15 offset:0
  ds_read_b64_tr_b16 v[54:55], v15 offset:512
  s_waitcnt lgkmcnt(6)
  v_mfma_f32_32x32x16_bf16 v[72:87], v[64:67], v[180:183], v[72:87]
  s_add_u32 m0, s61, 32768
  ds_read_b128 v[192:195], v12 offset:49152
  ds_read_b64_tr_b16 v[56:57], v14 offset:2048
  ds_read_b64_tr_b16 v[58:59], v14 offset:2560
  buffer_load_dwordx4 v1, s[16:19], s74 offen lds
  v_mfma_f32_32x32x16_bf16 v[88:103], v[68:71], v[180:183], v[88:103]
  ds_read_b128 v[196:199], v13 offset:49152
  ds_read_b64_tr_b16 v[60:61], v15 offset:2048
  ds_read_b64_tr_b16 v[62:63], v15 offset:2560
  s_waitcnt lgkmcnt(6)
  v_mfma_f32_32x32x16_bf16 v[72:87], v[48:51], v[184:187], v[72:87]
  ds_read_b64_tr_b16 v[64:65], v14 offset:4096
  ds_read_b64_tr_b16 v[66:67], v14 offset:4608
  v_mfma_f32_32x32x16_bf16 v[88:103], v[52:55], v[184:187], v[88:103]
  s_add_u32 m0, s61, 40960
  ds_read_b64_tr_b16 v[68:69], v15 offset:4096
  ds_read_b64_tr_b16 v[70:71], v15 offset:4608
  s_add_u32 s76, s74, 57344
  buffer_load_dwordx4 v1, s[16:19], s76 offen lds
  s_waitcnt lgkmcnt(4)
  v_mfma_f32_32x32x16_bf16 v[72:87], v[56:59], v[188:191], v[72:87]
  ds_read_b64_tr_b16 v[48:49], v14 offset:6144
  ds_read_b64_tr_b16 v[50:51], v14 offset:6656
  v_mfma_f32_32x32x16_bf16 v[88:103], v[60:63], v[188:191], v[88:103]
  ds_read_b64_tr_b16 v[52:53], v15 offset:6144
  ds_read_b64_tr_b16 v[54:55], v15 offset:6656
  s_waitcnt vmcnt(6)
  s_barrier
  s_waitcnt lgkmcnt(4)
  v_mfma_f32_32x32x16_bf16 v[72:87], v[64:67], v[192:195], v[72:87]
  s_add_u32 m0, s61, 155648
  v_add_u32 v14, 131072, v6
  ds_read_b128 v[200:203], v10 offset:0
  ds_read_b64_tr_b16 v[56:57], v14 offset:0
  ds_read_b64_tr_b16 v[58:59], v14 offset:512
  s_mul_i32 s10, s74, 1792
  buffer_load_dwordx4 v2, s[32:35], s10 offen lds
  v_mfma_f32_32x32x16_bf16 v[88:103], v[68:71], v[192:195], v[88:103]
  v_add_u32 v15, 65536, v6
  ds_read_b128 v[204:207], v11 offset:0
  ds_read_b64_tr_b16 v[60:61], v15 offset:0
  ds_read_b64_tr_b16 v[62:63], v15 offset:512
  s_waitcnt lgkmcnt(6)
  v_mfma_f32_32x32x16_bf16 v[72:87], v[48:51], v[196:199], v[72:87]
  s_add_u32 m0, s61, 147456
  ds_read_b128 v[208:211], v12 offset:0
  ds_read_b64_tr_b16 v[64:65], v14 offset:2048
  ds_read_b64_tr_b16 v[66:67], v14 offset:2560
  buffer_load_dwordx4 v2, s[36:39], s10 offen lds
  v_mfma_f32_32x32x16_bf16 v[88:103], v[52:55], v[196:199], v[88:103]
  ds_read_b128 v[212:215], v13 offset:0
  ds_read_b64_tr_b16 v[68:69], v15 offset:2048
  ds_read_b64_tr_b16 v[70:71], v15 offset:2560
  s_waitcnt lgkmcnt(6)
  v_mfma_f32_32x32x16_bf16 v[72:87], v[56:59], v[200:203], v[72:87]
  s_add_u32 m0, s61, 139264
  ds_read_b64_tr_b16 v[48:49], v14 offset:4096
  ds_read_b64_tr_b16 v[50:51], v14 offset:4608
  s_mul_i32 s4, s68, 1344
  buffer_load_dwordx4 v3, s[20:23], s4 offen lds
  v_mfma_f32_32x32x16_bf16 v[88:103], v[60:63], v[200:203], v[88:103]
  ds_read_b64_tr_b16 v[52:53], v15 offset:4096
  ds_read_b64_tr_b16 v[54:55], v15 offset:4608
  s_waitcnt lgkmcnt(4)
  v_mfma_f32_32x32x16_bf16 v[72:87], v[64:67], v[204:207], v[72:87]
  s_add_u32 m0, s61, 106496
  ds_read_b64_tr_b16 v[56:57], v14 offset:6144
  ds_read_b64_tr_b16 v[58:59], v14 offset:6656
  s_mul_i32 s5, s69, 1344
  buffer_load_dwordx4 v3, s[20:23], s5 offen lds
  v_mfma_f32_32x32x16_bf16 v[88:103], v[68:71], v[204:207], v[88:103]
  ds_read_b64_tr_b16 v[60:61], v15 offset:6144
  ds_read_b64_tr_b16 v[62:63], v15 offset:6656
  s_waitcnt vmcnt(6)
  s_barrier
  s_waitcnt lgkmcnt(4)
  v_mfma_f32_32x32x16_bf16 v[72:87], v[48:51], v[208:211], v[72:87]
  s_add_u32 m0, s61, 122880
  v_add_u32 v14, 73728, v6
  ds_read_b128 v[216:219], v10 offset:16384
  ds_read_b64_tr_b16 v[64:65], v14 offset:0
  ds_read_b64_tr_b16 v[66:67], v14 offset:512
  s_mul_i32 s6, s70, 1344
  buffer_load_dwordx4 v3, s[20:23], s6 offen lds
  v_mfma_f32_32x32x16_bf16 v[88:103], v[52:55], v[208:211], v[88:103]
  v_add_u32 v15, 81920, v6
  ds_read_b128 v[220:223], v11 offset:16384
  ds_read_b64_tr_b16 v[68:69], v15 offset:0
  ds_read_b64_tr_b16 v[70:71], v15 offset:512
  s_waitcnt lgkmcnt(6)
  v_mfma_f32_32x32x16_bf16 v[72:87], v[56:59], v[212:215], v[72:87]
  s_add_u32 m0, s61, 114688
  ds_read_b128 v[224:227], v12 offset:16384
  ds_read_b64_tr_b16 v[48:49], v14 offset:2048
  ds_read_b64_tr_b16 v[50:51], v14 offset:2560
  s_mul_i32 s7, s71, 1344
  buffer_load_dwordx4 v3, s[20:23], s7 offen lds
  v_mfma_f32_32x32x16_bf16 v[88:103], v[60:63], v[212:215], v[88:103]
  ds_read_b128 v[228:231], v13 offset:16384
  ds_read_b64_tr_b16 v[52:53], v15 offset:2048
  ds_read_b64_tr_b16 v[54:55], v15 offset:2560
  s_waitcnt lgkmcnt(6)
  v_mfma_f32_32x32x16_bf16 v[72:87], v[64:67], v[216:219], v[72:87]
  ds_read_b64_tr_b16 v[56:57], v14 offset:4096
  ds_read_b64_tr_b16 v[58:59], v14 offset:4608
  v_mfma_f32_32x32x16_bf16 v[88:103], v[68:71], v[216:219], v[88:103]
  s_add_u32 m0, s61, 98304
  ds_read_b64_tr_b16 v[60:61], v15 offset:4096
  ds_read_b64_tr_b16 v[62:63], v15 offset:4608
  s_mul_i32 s8, s72, 1344
  buffer_load_dwordx4 v3, s[20:23], s8 offen lds
  s_waitcnt lgkmcnt(4)
  v_mfma_f32_32x32x16_bf16 v[72:87], v[48:51], v[220:223], v[72:87]
  ds_read_b64_tr_b16 v[64:65], v14 offset:6144
  ds_read_b64_tr_b16 v[66:67], v14 offset:6656
  v_mfma_f32_32x32x16_bf16 v[88:103], v[52:55], v[220:223], v[88:103]
  ds_read_b64_tr_b16 v[68:69], v15 offset:6144
  ds_read_b64_tr_b16 v[70:71], v15 offset:6656
  s_waitcnt vmcnt(5)
  s_barrier
  s_waitcnt lgkmcnt(4)
  v_mfma_f32_32x32x16_bf16 v[72:87], v[56:59], v[224:227], v[72:87]
  v_add_u32 v14, 155648, v6
  ds_read_b128 v[232:235], v10 offset:32768
  ds_read_b64_tr_b16 v[48:49], v14 offset:0
  ds_read_b64_tr_b16 v[50:51], v14 offset:512
  s_cmp_lg_u32 s60, 0
  s_cbranch_scc1 Lpi_1
  buffer_load_dword v20, off, s[56:59], 0 sc1
Lpi_1:
  s_add_u32 m0, s61, 131072
  s_mul_i32 s9, s73, 1344
  buffer_load_dwordx4 v3, s[20:23], s9 offen lds
  v_mfma_f32_32x32x16_bf16 v[88:103], v[60:63], v[224:227], v[88:103]
  v_add_u32 v15, 147456, v6
  ds_read_b128 v[236:239], v11 offset:32768
  ds_read_b64_tr_b16 v[52:53], v15 offset:0
  ds_read_b64_tr_b16 v[54:55], v15 offset:512
  s_waitcnt lgkmcnt(6)
  v_mfma_f32_32x32x16_bf16 v[72:87], v[64:67], v[228:231], v[72:87]
  s_add_u32 m0, s61, 90112
  ds_read_b128 v[240:243], v12 offset:32768
  ds_read_b64_tr_b16 v[56:57], v14 offset:2048
  ds_read_b64_tr_b16 v[58:59], v14 offset:2560
  s_mul_i32 s10, s74, 1344
  buffer_load_dwordx4 v3, s[20:23], s10 offen lds
  v_mfma_f32_32x32x16_bf16 v[88:103], v[68:71], v[228:231], v[88:103]
  ds_read_b128 v[244:247], v13 offset:32768
  ds_read_b64_tr_b16 v[60:61], v15 offset:2048
  ds_read_b64_tr_b16 v[62:63], v15 offset:2560
  s_waitcnt lgkmcnt(6)
  v_mfma_f32_32x32x16_bf16 v[72:87], v[48:51], v[232:235], v[72:87]
  s_add_u32 m0, s61, 49152
  ds_read_b64_tr_b16 v[64:65], v14 offset:4096
  ds_read_b64_tr_b16 v[66:67], v14 offset:4608
  v_add_u32 v248, s61, v5
  v_mov_b32 v249, 0x7ffffff0
  v_cmp_gt_u32 vcc, 6272, v248
  s_add_u32 s75, s65, 0
  s_mul_i32 s75, s75, 3136
  v_cndmask_b32 v248, v249, v248, vcc
  buffer_load_dwordx4 v248, s[24:27], s75 offen lds
  v_mfma_f32_32x32x16_bf16 v[88:103], v[52:55], v[232:235], v[88:103]
  ds_read_b64_tr_b16 v[68:69], v15 offset:4096
  ds_read_b64_tr_b16 v[70:71], v15 offset:4608
  s_waitcnt lgkmcnt(4)
  v_mfma_f32_32x32x16_bf16 v[72:87], v[56:59], v[236:239], v[72:87]
  s_add_u32 m0, s61, 57344
  ds_read_b64_tr_b16 v[48:49], v14 offset:6144
  ds_read_b64_tr_b16 v[50:51], v14 offset:6656
  v_add_u32 v248, s61, v5
  v_mov_b32 v249, 0x7ffffff0
  v_cmp_gt_u32 vcc, 6272, v248
  s_add_u32 s75, s65, 2
  s_mul_i32 s75, s75, 3136
  v_cndmask_b32 v248, v249, v248, vcc
  buffer_load_dwordx4 v248, s[24:27], s75 offen lds
  v_mfma_f32_32x32x16_bf16 v[88:103], v[60:63], v[236:239], v[88:103]
  ds_read_b64_tr_b16 v[52:53], v15 offset:6144
  ds_read_b64_tr_b16 v[54:55], v15 offset:6656
  s_waitcnt vmcnt(5)
  s_barrier
  s_waitcnt lgkmcnt(4)
  v_mfma_f32_32x32x16_bf16 v[72:87], v[64:67], v[240:243], v[72:87]
  s_add_u32 m0, s61, 81920
  ds_read_b64_tr_b16 v[56:57], v253 offset:8192
  ds_read_b64_tr_b16 v[58:59], v253 offset:8704
  v_add_u32 v3, 112, v3
  buffer_load_dwordx4 v3, s[20:23], s4 offen lds
  v_mfma_f32_32x32x16_bf16 v[88:103], v[68:71], v[240:243], v[88:103]
  ds_read_b64_tr_b16 v[60:61], v253 offset:10240
  ds_read_b64_tr_b16 v[62:63], v253 offset:10752
  s_waitcnt lgkmcnt(4)
  v_mfma_f32_32x32x16_bf16 v[72:87], v[48:51], v[244:247], v[72:87]
  ds_read_b64_tr_b16 v[64:65], v253 offset:12288
  ds_read_b64_tr_b16 v[66:67], v253 offset:12800
  v_mfma_f32_32x32x16_bf16 v[88:103], v[52:55], v[244:247], v[88:103]
  ds_read_b64_tr_b16 v[68:69], v253 offset:14336
  ds_read_b64_tr_b16 v[70:71], v253 offset:14848
  s_waitcnt lgkmcnt(4)
  v_mfma_f32_32x32x16_bf16 v[104:119], v[56:59], v[136:139], 0
  s_add_u32 m0, s61, 73728
  ds_read_b64_tr_b16 v[48:49], v252 offset:40960
  ds_read_b64_tr_b16 v[50:51], v252 offset:41472
  buffer_load_dwordx4 v3, s[20:23], s5 offen lds
  v_mfma_f32_32x32x16_bf16 v[104:119], v[60:63], v[140:143], v[104:119]
  ds_read_b64_tr_b16 v[52:53], v252 offset:43008
  ds_read_b64_tr_b16 v[54:55], v252 offset:43520
  s_waitcnt lgkmcnt(4)
  v_mfma_f32_32x32x16_bf16 v[104:119], v[64:67], v[144:147], v[104:119]
  ds_read_b64_tr_b16 v[56:57], v252 offset:45056
  ds_read_b64_tr_b16 v[58:59], v252 offset:45568
  v_mul_f32 v72, s90, v72
  v_mul_f32 v73, s90, v73
  v_mul_f32 v74, s90, v74
  v_mul_f32 v75, s90, v75
  v_mul_f32 v76, s90, v76
  v_mfma_f32_32x32x16_bf16 v[104:119], v[68:71], v[148:151], v[104:119]
  ds_read_b64_tr_b16 v[60:61], v252 offset:47104
  ds_read_b64_tr_b16 v[62:63], v252 offset:47616
  v_mul_f32 v77, s90, v77
  v_mul_f32 v78, s90, v78
  v_mul_f32 v79, s90, v79
  v_exp_f32 v72, v72
  s_waitcnt lgkmcnt(4)
  v_mfma_f32_32x32x16_bf16 v[104:119], v[48:51], v[152:155], v[104:119]
  s_add_u32 m0, s61, 65536
  ds_read_b64_tr_b16 v[64:65], v252 offset:57344
  ds_read_b64_tr_b16 v[66:67], v252 offset:57856
  buffer_load_dwordx4 v3, s[20:23], s6 offen lds
  v_exp_f32 v73, v73
  v_mfma_f32_32x32x16_bf16 v[104:119], v[52:55], v[156:159], v[104:119]
  ds_read_b64_tr_b16 v[68:69], v252 offset:59392
  ds_read_b64_tr_b16 v[70:71], v252 offset:59904
  v_exp_f32 v74, v74
  v_exp_f32 v75, v75
  v_exp_f32 v76, v76
  v_mov_b32 v14, v19
  s_mov_b32 exec_lo, 0
  v_mov_b32 v14, 2048
  s_mov_b32 exec_lo, -1
  s_waitcnt lgkmcnt(4)
  v_mfma_f32_32x32x16_bf16 v[104:119], v[56:59], v[160:163], v[104:119]
  ds_read_b64_tr_b16 v[48:49], v252 offset:61440
  ds_read_b64_tr_b16 v[50:51], v252 offset:61952
  v_exp_f32 v77, v77
  v_exp_f32 v78, v78
  v_exp_f32 v79, v79
  v_mfma_f32_32x32x16_bf16 v[104:119], v[60:63], v[164:167], v[104:119]
  ds_read_b64_tr_b16 v[52:53], v252 offset:63488
  ds_read_b64_tr_b16 v[54:55], v252 offset:64000
  v_add_f32 v72, 1.0, v72
  v_add_f32 v73, 1.0, v73
  v_add_f32 v74, 1.0, v74
  v_add_f32 v75, 1.0, v75
  v_add_f32 v76, 1.0, v76
  v_add_f32 v77, 1.0, v77
  s_waitcnt lgkmcnt(4)
  v_mfma_f32_32x32x16_bf16 v[104:119], v[64:67], v[168:171], v[104:119]
  s_add_u32 m0, s61, 32768
  ds_read_b64_tr_b16 v[56:57], v252 offset:49152
  ds_read_b64_tr_b16 v[58:59], v252 offset:49664
  buffer_load_dwordx4 v3, s[20:23], s7 offen lds
  v_add_f32 v78, 1.0, v78
  v_add_f32 v79, 1.0, v79
  v_mfma_f32_32x32x16_bf16 v[104:119], v[68:71], v[172:175], v[104:119]
  ds_read_b64_tr_b16 v[60:61], v252 offset:51200
  ds_read_b64_tr_b16 v[62:63], v252 offset:51712
  v_rcp_f32 v72, v72
  v_rcp_f32 v73, v73
  v_rcp_f32 v74, v74
  s_waitcnt lgkmcnt(4)
  v_mfma_f32_32x32x16_bf16 v[104:119], v[48:51], v[176:179], v[104:119]
  ds_read_b64_tr_b16 v[64:65], v252 offset:53248
  ds_read_b64_tr_b16 v[66:67], v252 offset:53760
  v_rcp_f32 v75, v75
  v_rcp_f32 v76, v76
  v_rcp_f32 v77, v77
  v_mfma_f32_32x32x16_bf16 v[104:119], v[52:55], v[180:183], v[104:119]
  ds_read_b64_tr_b16 v[68:69], v252 offset:55296
  ds_read_b64_tr_b16 v[70:71], v252 offset:55808
  v_rcp_f32 v78, v78
  v_rcp_f32 v79, v79
  v_mul_f32 v88, v72, v88
  v_mul_f32 v89, v73, v89
  s_cmp_lg_u32 s60, 0
  s_cbranch_scc1 Lpc_2
  s_waitcnt vmcnt(8)
  v_readfirstlane_b32 s13, v20
  s_nop 0
  s_cmp_ge_u32 s13, 1
  s_cbranch_scc1 Lpc_2
  s_mov_b32 s93, 0
Lsp_3:
  buffer_load_dword v20, off, s[56:59], 0 sc1
  s_add_u32 s93, s93, 1
  s_waitcnt vmcnt(0)
  v_readfirstlane_b32 s13, v20
  s_nop 0
  s_cmp_ge_u32 s13, 1
  s_cbranch_scc1 Lpc_2
  s_cmp_lt_u32 s93, 20000
  s_cbranch_scc1 Lsp_3
Lpc_2:
  s_waitcnt vmcnt(6)
  s_barrier
  s_waitcnt lgkmcnt(4)
  v_mfma_f32_32x32x16_bf16 v[104:119], v[56:59], v[184:187], v[104:119]
  s_add_u32 m0, s61, 155648
  ds_read_b64_tr_b16 v[48:49], v252 offset:32768
  ds_read_b64_tr_b16 v[50:51], v252 offset:33280
  buffer_load_dwordx4 v3, s[20:23], s8 offen lds
  v_mul_f32 v90, v74, v90
  v_mul_f32 v91, v75, v91
  v_mul_f32 v92, v76, v92
  v_mfma_f32_32x32x16_bf16 v[104:119], v[60:63], v[188:191], v[104:119]
  ds_read_b64_tr_b16 v[52:53], v252 offset:34816
  ds_read_b64_tr_b16 v[54:55], v252 offset:35328
  v_mul_f32 v93, v77, v93
  v_mul_f32 v94, v78, v94
  v_mul_f32 v95, v79, v95
  v_cvt_pk_bf16_f32 v72, v88, v89
  v_cvt_pk_bf16_f32 v73, v90, v91
  v_cvt_pk_bf16_f32 v74, v92, v93
  s_waitcnt lgkmcnt(4)
  v_mfma_f32_32x32x16_bf16 v[104:119], v[64:67], v[192:195], v[104:119]
  ds_read_b64_tr_b16 v[56:57], v252 offset:36864
  ds_read_b64_tr_b16 v[58:59], v252 offset:37376
  v_cvt_pk_bf16_f32 v75, v94, v95
  s_lshl_b32 s12, s66, 12
  s_add_u32 s12, s12, s80
  buffer_store_dwordx4 v[72:75], v5, s[52:55], s12 offen sc1
  v_mul_f32 v80, s90, v80
  v_mfma_f32_32x32x16_bf16 v[104:119], v[68:71], v[196:199], v[104:119]
  s_add_u32 m0, s61, 147456
  ds_read_b64_tr_b16 v[60:61], v252 offset:38912
  ds_read_b64_tr_b16 v[62:63], v252 offset:39424
  buffer_load_dwordx4 v3, s[20:23], s9 offen lds
  v_mul_f32 v81, s90, v81
  v_mul_f32 v82, s90, v82
  v_mul_f32 v83, s90, v83
  s_waitcnt lgkmcnt(4)
  v_mfma_f32_32x32x16_bf16 v[104:119], v[48:51], v[200:203], v[104:119]
  ds_read_b64_tr_b16 v[64:65], v253 offset:0
  ds_read_b64_tr_b16 v[66:67], v253 offset:512
  v_mul_f32 v84, s90, v84
  v_mul_f32 v85, s90, v85
  v_mul_f32 v86, s90, v86
  v_mul_f32 v87, s90, v87
  v_exp_f32 v80, v80
  v_mfma_f32_32x32x16_bf16 v[104:119], v[52:55], v[204:207], v[104:119]
  ds_read_b64_tr_b16 v[68:69], v253 offset:2048
  ds_read_b64_tr_b16 v[70:71], v253 offset:2560
  v_exp_f32 v81, v81
  v_exp_f32 v82, v82
  v_exp_f32 v83, v83
  s_waitcnt lgkmcnt(4)
  v_mfma_f32_32x32x16_bf16 v[104:119], v[56:59], v[208:211], v[104:119]
  s_add_u32 m0, s61, 139264
  ds_read_b64_tr_b16 v[48:49], v253 offset:4096
  ds_read_b64_tr_b16 v[50:51], v253 offset:4608
  buffer_load_dwordx4 v3, s[20:23], s10 offen lds
  v_exp_f32 v84, v84
  v_mfma_f32_32x32x16_bf16 v[104:119], v[60:63], v[212:215], v[104:119]
  ds_read_b64_tr_b16 v[52:53], v253 offset:6144
  ds_read_b64_tr_b16 v[54:55], v253 offset:6656
  v_exp_f32 v85, v85
  v_exp_f32 v86, v86
  v_exp_f32 v87, v87
  s_waitcnt lgkmcnt(4)
  v_mfma_f32_32x32x16_bf16 v[104:119], v[64:67], v[216:219], v[104:119]
  ds_read_b64_tr_b16 v[56:57], v252 offset:24576
  ds_read_b64_tr_b16 v[58:59], v252 offset:25088
  v_add_f32 v80, 1.0, v80
  v_add_f32 v81, 1.0, v81
  v_add_f32 v82, 1.0, v82
  v_add_f32 v83, 1.0, v83
  v_add_f32 v84, 1.0, v84
  v_add_f32 v85, 1.0, v85
  v_mfma_f32_32x32x16_bf16 v[104:119], v[68:71], v[220:223], v[104:119]
  s_add_u32 m0, s61, 122880
  ds_read_b64_tr_b16 v[60:61], v252 offset:26624
  ds_read_b64_tr_b16 v[62:63], v252 offset:27136
  v_add_u32 v3, 112, v3
  buffer_load_dwordx4 v3, s[20:23], s4 offen lds
  v_add_f32 v86, 1.0, v86
  v_add_f32 v87, 1.0, v87
  s_waitcnt lgkmcnt(4)
  v_mfma_f32_32x32x16_bf16 v[104:119], v[48:51], v[224:227], v[104:119]
  ds_read_b64_tr_b16 v[64:65], v252 offset:28672
  ds_read_b64_tr_b16 v[66:67], v252 offset:29184
  v_rcp_f32 v80, v80
  v_rcp_f32 v81, v81
  v_rcp_f32 v82, v82
  v_mfma_f32_32x32x16_bf16 v[104:119], v[52:55], v[228:231], v[104:119]
  ds_read_b64_tr_b16 v[68:69], v252 offset:30720
  ds_read_b64_tr_b16 v[70:71], v252 offset:31232
  v_rcp_f32 v83, v83
  v_rcp_f32 v84, v84
  v_rcp_f32 v85, v85
  s_waitcnt vmcnt(5)
  s_barrier
  s_waitcnt lgkmcnt(4)
  v_mfma_f32_32x32x16_bf16 v[104:119], v[56:59], v[232:235], v[104:119]
  s_add_u32 m0, s61, 131072
  ds_read_b64_tr_b16 v[48:49], v252 offset:16384
  ds_read_b64_tr_b16 v[50:51], v252 offset:16896
  buffer_load_dwordx4 v3, s[20:23], s5 offen lds
  v_rcp_f32 v86, v86
  v_mfma_f32_32x32x16_bf16 v[104:119], v[60:63], v[236:239], v[104:119]
  ds_read_b64_tr_b16 v[52:53], v252 offset:18432
  ds_read_b64_tr_b16 v[54:55], v252 offset:18944
  v_rcp_f32 v87, v87
  v_mul_f32 v96, v80, v96
  v_mul_f32 v97, v81, v97
  v_mul_f32 v98, v82, v98
  v_mul_f32 v99, v83, v99
  s_waitcnt lgkmcnt(4)
  v_mfma_f32_32x32x16_bf16 v[104:119], v[64:67], v[240:243], v[104:119]
  ds_read_b64_tr_b16 v[56:57], v252 offset:20480
  ds_read_b64_tr_b16 v[58:59], v252 offset:20992
  v_mul_f32 v100, v84, v100
  v_mul_f32 v101, v85, v101
  v_mul_f32 v102, v86, v102
  v_mul_f32 v103, v87, v103
  v_cvt_pk_bf16_f32 v80, v96, v97
  v_cvt_pk_bf16_f32 v81, v98, v99
  v_mfma_f32_32x32x16_bf16 v[104:119], v[68:71], v[244:247], v[104:119]
  ds_read_b64_tr_b16 v[60:61], v252 offset:22528
  ds_read_b64_tr_b16 v[62:63], v252 offset:23040
  v_cvt_pk_bf16_f32 v82, v100, v101
  v_cvt_pk_bf16_f32 v83, v102, v103
  buffer_store_dwordx4 v[80:83], v5, s[52:55], s12 offen offset:1024 sc1
  s_waitcnt lgkmcnt(4)
  s_nop 0
  v_mfma_f32_32x32x16_bf16 v[72:87], v[48:51], v[136:139], 0
  s_add_u32 m0, s61, 114688
  ds_read_b64_tr_b16 v[64:65], v252 offset:8192
  ds_read_b64_tr_b16 v[66:67], v252 offset:8704
  buffer_load_dwordx4 v3, s[20:23], s6 offen lds
  ds_read_b64_tr_b16 v[40:41], v19 offset:49152
  ds_read_b64_tr_b16 v[42:43], v19 offset:49600
  ds_read_b64_tr_b16 v[44:45], v19 offset:50048
  ds_read_b64_tr_b16 v[46:47], v250 offset:50496
  v_mfma_f32_32x32x16_bf16 v[72:87], v[52:55], v[140:143], v[72:87]
  ds_read_b64_tr_b16 v[68:69], v252 offset:10240
  ds_read_b64_tr_b16 v[70:71], v252 offset:10752
  v_cvt_pk_bf16_f32 v22, v104, v105
  v_cvt_pk_bf16_f32 v23, v106, v107
  v_cvt_pk_bf16_f32 v24, v108, v109
  v_cvt_pk_bf16_f32 v25, v110, v111
  v_cvt_pk_bf16_f32 v26, v112, v113
  v_cvt_pk_bf16_f32 v27, v114, v115
  s_waitcnt lgkmcnt(8)
  v_mfma_f32_32x32x16_bf16 v[72:87], v[56:59], v[144:147], v[72:87]
  ds_read_b64_tr_b16 v[48:49], v252 offset:12288
  ds_read_b64_tr_b16 v[50:51], v252 offset:12800
  v_cvt_pk_bf16_f32 v28, v116, v117
  v_cvt_pk_bf16_f32 v29, v118, v119
  s_waitcnt lgkmcnt(4)
  v_mfma_f32_32x32x16_bf16 v[120:135], v[40:43], v[22:25], 0
  v_mfma_f32_32x32x16_bf16 v[72:87], v[60:63], v[148:151], v[72:87]
  ds_read_b64_tr_b16 v[52:53], v252 offset:14336
  ds_read_b64_tr_b16 v[54:55], v252 offset:14848
  v_mfma_f32_32x32x16_bf16 v[120:135], v[44:47], v[26:29], v[120:135]
  s_waitcnt lgkmcnt(4)
  v_mfma_f32_32x32x16_bf16 v[72:87], v[64:67], v[152:155], v[72:87]
  s_add_u32 m0, s61, 106496
  ds_read_b64_tr_b16 v[56:57], v252 offset:0
  ds_read_b64_tr_b16 v[58:59], v252 offset:512
  buffer_load_dwordx4 v3, s[20:23], s7 offen lds
  v_mfma_f32_32x32x16_bf16 v[72:87], v[68:71], v[156:159], v[72:87]
  ds_read_b64_tr_b16 v[60:61], v252 offset:2048
  ds_read_b64_tr_b16 v[62:63], v252 offset:2560
  s_nop 2
  v_max3_f32 v30, v120, v121, v122
  v_min3_f32 v31, v120, v121, v122
  v_max3_f32 v30, v30, v123, v124
  s_waitcnt lgkmcnt(4)
  v_mfma_f32_32x32x16_bf16 v[72:87], v[48:51], v[160:163], v[72:87]
  ds_read_b64_tr_b16 v[64:65], v252 offset:4096
  ds_read_b64_tr_b16 v[66:67], v252 offset:4608
  v_min3_f32 v31, v31, v123, v124
  v_max3_f32 v30, v30, v125, v126
  v_min3_f32 v31, v31, v125, v126
  v_max3_f32 v30, v30, v127, v128
  v_min3_f32 v31, v31, v127, v128
  v_max3_f32 v30, v30, v129, v130
  v_mfma_f32_32x32x16_bf16 v[72:87], v[52:55], v[164:167], v[72:87]
  ds_read_b64_tr_b16 v[68:69], v252 offset:6144
  ds_read_b64_tr_b16 v[70:71], v252 offset:6656
  v_min3_f32 v31, v31, v129, v130
  v_max3_f32 v30, v30, v131, v132
  v_min3_f32 v31, v31, v131, v132
  v_max3_f32 v30, v30, v133, v134
  v_min3_f32 v31, v31, v133, v134
  v_max_f32 v30, v30, v135
  s_waitcnt lgkmcnt(4)
  v_mfma_f32_32x32x16_bf16 v[72:87], v[56:59], v[168:171], v[72:87]
  s_add_u32 m0, s61, 98304
  ds_read_b64_tr_b16 v[48:49], v7 offset:32768
  ds_read_b64_tr_b16 v[50:51], v7 offset:33280
  buffer_load_dwordx4 v3, s[20:23], s8 offen lds
  v_min_f32 v31, v31, v135
  v_mov_b32 v32, v30
  v_mov_b32 v33, v31
  v_mfma_f32_32x32x16_bf16 v[72:87], v[60:63], v[172:175], v[72:87]
  ds_read_b64_tr_b16 v[52:53], v7 offset:34816
  ds_read_b64_tr_b16 v[54:55], v7 offset:35328
  v_permlane32_swap_b32 v30, v32
  v_permlane32_swap_b32 v31, v33
  v_max_f32 v30, v30, v32
  v_min_f32 v31, v31, v33
  v_mul_f32 v34, s90, v30
  v_mul_f32 v35, s88, v31
  s_waitcnt lgkmcnt(4)
  v_mfma_f32_32x32x16_bf16 v[72:87], v[64:67], v[176:179], v[72:87]
  ds_read_b64_tr_b16 v[56:57], v7 offset:36864
  ds_read_b64_tr_b16 v[58:59], v7 offset:37376
  v_fma_f32 v104, v120, s88, v34
  v_fma_f32 v105, v121, s88, v34
  v_fma_f32 v120, v120, s90, v35
  v_fma_f32 v121, v121, s90, v35
  v_fma_f32 v106, v122, s88, v34
  v_fma_f32 v107, v123, s88, v34
  v_mfma_f32_32x32x16_bf16 v[72:87], v[68:71], v[180:183], v[72:87]
  ds_read_b64_tr_b16 v[60:61], v7 offset:38912
  ds_read_b64_tr_b16 v[62:63], v7 offset:39424
  v_fma_f32 v122, v122, s90, v35
  v_fma_f32 v123, v123, s90, v35
  v_fma_f32 v108, v124, s88, v34
  v_fma_f32 v109, v125, s88, v34
  v_fma_f32 v124, v124, s90, v35
  v_fma_f32 v125, v125, s90, v35
  s_waitcnt vmcnt(6)
  s_barrier
  s_waitcnt lgkmcnt(4)
  v_mfma_f32_32x32x16_bf16 v[72:87], v[48:51], v[184:187], v[72:87]
  s_add_u32 m0, s61, 90112
  ds_read_b64_tr_b16 v[64:65], v253 offset:24576
  ds_read_b64_tr_b16 v[66:67], v253 offset:25088
  buffer_load_dwordx4 v3, s[20:23], s9 offen lds
  v_fma_f32 v110, v126, s88, v34
  v_fma_f32 v111, v127, s88, v34
  v_fma_f32 v126, v126, s90, v35
  v_mfma_f32_32x32x16_bf16 v[72:87], v[52:55], v[188:191], v[72:87]
  ds_read_b64_tr_b16 v[68:69], v253 offset:26624
  ds_read_b64_tr_b16 v[70:71], v253 offset:27136
  v_fma_f32 v127, v127, s90, v35
  v_fma_f32 v112, v128, s88, v34
  v_fma_f32 v113, v129, s88, v34
  v_fma_f32 v128, v128, s90, v35
  v_fma_f32 v129, v129, s90, v35
  v_fma_f32 v114, v130, s88, v34
  s_waitcnt lgkmcnt(4)
  v_mfma_f32_32x32x16_bf16 v[72:87], v[56:59], v[192:195], v[72:87]
  ds_read_b64_tr_b16 v[48:49], v253 offset:28672
  ds_read_b64_tr_b16 v[50:51], v253 offset:29184
  v_fma_f32 v115, v131, s88, v34
  v_fma_f32 v130, v130, s90, v35
  v_fma_f32 v131, v131, s90, v35
  v_fma_f32 v116, v132, s88, v34
  v_fma_f32 v117, v133, s88, v34
  v_fma_f32 v132, v132, s90, v35
  v_mfma_f32_32x32x16_bf16 v[72:87], v[60:63], v[196:199], v[72:87]
  s_add_u32 m0, s61, 81920
  ds_read_b64_tr_b16 v[52:53], v253 offset:30720
  ds_read_b64_tr_b16 v[54:55], v253 offset:31232
  buffer_load_dwordx4 v3, s[20:23], s10 offen lds
  v_fma_f32 v133, v133, s90, v35
  v_fma_f32 v118, v134, s88, v34
  v_fma_f32 v119, v135, s88, v34
  s_waitcnt lgkmcnt(4)
  v_mfma_f32_32x32x16_bf16 v[72:87], v[64:67], v[200:203], v[72:87]
  ds_read_b64_tr_b16 v[56:57], v253 offset:16384
  ds_read_b64_tr_b16 v[58:59], v253 offset:16896
  v_fma_f32 v134, v134, s90, v35
  v_fma_f32 v135, v135, s90, v35
  v_exp_f32 v104, v104
  v_exp_f32 v120, v120
  v_mfma_f32_32x32x16_bf16 v[72:87], v[68:71], v[204:207], v[72:87]
  ds_read_b64_tr_b16 v[60:61], v253 offset:18432
  ds_read_b64_tr_b16 v[62:63], v253 offset:18944
  v_exp_f32 v105, v105
  v_exp_f32 v121, v121
  v_exp_f32 v106, v106
  s_waitcnt lgkmcnt(4)
  v_mfma_f32_32x32x16_bf16 v[72:87], v[48:51], v[208:211], v[72:87]
  s_add_u32 m0, s61, 73728
  ds_read_b64_tr_b16 v[64:65], v253 offset:20480
  ds_read_b64_tr_b16 v[66:67], v253 offset:20992
  v_add_u32 v3, 112, v3
  buffer_load_dwordx4 v3, s[20:23], s4 offen lds
  v_exp_f32 v122, v122
  v_mfma_f32_32x32x16_bf16 v[72:87], v[52:55], v[212:215], v[72:87]
  ds_read_b64_tr_b16 v[68:69], v253 offset:22528
  ds_read_b64_tr_b16 v[70:71], v253 offset:23040
  v_exp_f32 v107, v107
  v_exp_f32 v123, v123
  v_exp_f32 v108, v108
  s_waitcnt lgkmcnt(4)
  v_mfma_f32_32x32x16_bf16 v[72:87], v[56:59], v[216:219], v[72:87]
  ds_read_b64_tr_b16 v[48:49], v253 offset:8192
  ds_read_b64_tr_b16 v[50:51], v253 offset:8704
  v_exp_f32 v124, v124
  v_exp_f32 v109, v109
  v_exp_f32 v125, v125
  v_mfma_f32_32x32x16_bf16 v[72:87], v[60:63], v[220:223], v[72:87]
  s_add_u32 m0, s61, 65536
  ds_read_b64_tr_b16 v[52:53], v253 offset:10240
  ds_read_b64_tr_b16 v[54:55], v253 offset:10752
  buffer_load_dwordx4 v3, s[20:23], s5 offen lds
  v_exp_f32 v110, v110
  s_waitcnt lgkmcnt(4)
  v_mfma_f32_32x32x16_bf16 v[72:87], v[64:67], v[224:227], v[72:87]
  ds_read_b64_tr_b16 v[56:57], v253 offset:12288
  ds_read_b64_tr_b16 v[58:59], v253 offset:12800
  v_exp_f32 v126, v126
  v_exp_f32 v111, v111
  v_exp_f32 v127, v127
  v_mfma_f32_32x32x16_bf16 v[72:87], v[68:71], v[228:231], v[72:87]
  ds_read_b64_tr_b16 v[60:61], v253 offset:14336
  ds_read_b64_tr_b16 v[62:63], v253 offset:14848
  v_exp_f32 v112, v112
  v_exp_f32 v128, v128
  v_exp_f32 v113, v113
  s_waitcnt vmcnt(5)
  s_barrier
  s_cmp_lg_u32 s60, 1
  s_cbranch_scc1 Lsig_4
  s_atomic_add s87, s[14:15], s84 offset:0
Lsig_4:
  s_waitcnt lgkmcnt(4)
  v_mfma_f32_32x32x16_bf16 v[72:87], v[48:51], v[232:235], v[72:87]
  s_add_u32 m0, s61, 155648
  ds_read_b64_tr_b16 v[64:65], v252 offset:57344
  ds_read_b64_tr_b16 v[66:67], v252 offset:57856
  buffer_load_dwordx4 v3, s[20:23], s6 offen lds
  v_exp_f32 v129, v129
  v_mfma_f32_32x32x16_bf16 v[72:87], v[52:55], v[236:239], v[72:87]
  ds_read_b64_tr_b16 v[68:69], v252 offset:59392
  ds_read_b64_tr_b16 v[70:71], v252 offset:59904
  v_exp_f32 v114, v114
  v_exp_f32 v130, v130
  v_exp_f32 v115, v115
  s_waitcnt lgkmcnt(4)
  v_mfma_f32_32x32x16_bf16 v[72:87], v[56:59], v[240:243], v[72:87]
  ds_read_b64_tr_b16 v[48:49], v252 offset:61440
  ds_read_b64_tr_b16 v[50:51], v252 offset:61952
  v_exp_f32 v131, v131
  v_exp_f32 v116, v116
  v_exp_f32 v132, v132
  v_mfma_f32_32x32x16_bf16 v[72:87], v[60:63], v[244:247], v[72:87]
  ds_read_b64_tr_b16 v[52:53], v252 offset:63488
  ds_read_b64_tr_b16 v[54:55], v252 offset:64000
  v_exp_f32 v117, v117
  v_exp_f32 v133, v133
  v_exp_f32 v118, v118
  v_exp_f32 v134, v134
  v_exp_f32 v119, v119
  v_exp_f32 v135, v135
  v_cvt_pk_bf16_f32 v12, v120, v121
  v_cvt_pk_bf16_f32 v13, v122, v123
  v_cvt_pk_bf16_f32 v15, v124, v125
  v_cvt_pk_bf16_f32 v16, v126, v127
  v_cvt_pk_bf16_f32 v17, v128, v129
  v_cvt_pk_bf16_f32 v21, v130, v131
  v_cvt_pk_bf16_f32 v38, v132, v133
  v_cvt_pk_bf16_f32 v39, v134, v135
  v_cvt_pk_bf16_f32 v1, v104, v105
  v_cvt_pk_bf16_f32 v2, v106, v107
  v_cvt_pk_bf16_f32 v4, v108, v109
  v_cvt_pk_bf16_f32 v6, v110, v111
  v_cvt_pk_bf16_f32 v8, v112, v113
  v_cvt_pk_bf16_f32 v9, v114, v115
  v_cvt_pk_bf16_f32 v10, v116, v117
  v_cvt_pk_bf16_f32 v11, v118, v119
  s_waitcnt lgkmcnt(4)
  v_mfma_f32_32x32x16_bf16 v[104:119], v[64:67], v[136:139], 0
  s_add_u32 m0, s61, 147456
  ds_read_b64_tr_b16 v[56:57], v253 offset:0
  ds_read_b64_tr_b16 v[58:59], v253 offset:512
  buffer_load_dwordx4 v3, s[20:23], s7 offen lds
  ds_read_b64_tr_b16 v[40:41], v19 offset:52288
  ds_read_b64_tr_b16 v[42:43], v19 offset:52736
  ds_read_b64_tr_b16 v[44:45], v19 offset:53184
  ds_read_b64_tr_b16 v[46:47], v14 offset:53632
  v_mfma_f32_32x32x16_bf16 v[104:119], v[68:71], v[140:143], v[104:119]
  ds_read_b64_tr_b16 v[60:61], v253 offset:2048
  ds_read_b64_tr_b16 v[62:63], v253 offset:2560
  v_cvt_pk_bf16_f32 v22, v72, v73
  v_cvt_pk_bf16_f32 v23, v74, v75
  v_cvt_pk_bf16_f32 v24, v76, v77
  v_cvt_pk_bf16_f32 v25, v78, v79
  v_cvt_pk_bf16_f32 v26, v80, v81
  v_cvt_pk_bf16_f32 v27, v82, v83
  v_cvt_pk_bf16_f32 v28, v84, v85
  s_waitcnt lgkmcnt(8)
  v_mfma_f32_32x32x16_bf16 v[104:119], v[48:51], v[144:147], v[104:119]
  ds_read_b64_tr_b16 v[64:65], v253 offset:4096
  ds_read_b64_tr_b16 v[66:67], v253 offset:4608
  v_cvt_pk_bf16_f32 v29, v86, v87
  s_waitcnt lgkmcnt(4)
  v_mfma_f32_32x32x16_bf16 v[88:103], v[40:43], v[22:25], 0
  v_mfma_f32_32x32x16_bf16 v[88:103], v[44:47], v[26:29], v[88:103]
  v_mfma_f32_32x32x16_bf16 v[104:119], v[52:55], v[148:151], v[104:119]
  ds_read_b64_tr_b16 v[68:69], v253 offset:6144
  ds_read_b64_tr_b16 v[70:71], v253 offset:6656
  s_waitcnt lgkmcnt(4)
  v_mfma_f32_32x32x16_bf16 v[104:119], v[56:59], v[152:155], v[104:119]
  s_add_u32 m0, s61, 32768
  ds_read_b64_tr_b16 v[48:49], v252 offset:49152
  ds_read_b64_tr_b16 v[50:51], v252 offset:49664
  buffer_load_dwordx4 v3, s[20:23], s8 offen lds
  s_nop 2
  v_max3_f32 v30, v88, v89, v90
  v_min3_f32 v31, v88, v89, v90
  v_mfma_f32_32x32x16_bf16 v[104:119], v[60:63], v[156:159], v[104:119]
  ds_read_b64_tr_b16 v[52:53], v252 offset:51200
  ds_read_b64_tr_b16 v[54:55], v252 offset:51712
  v_max3_f32 v30, v30, v91, v92
  v_min3_f32 v31, v31, v91, v92
  v_max3_f32 v30, v30, v93, v94
  v_min3_f32 v31, v31, v93, v94
  v_max3_f32 v30, v30, v95, v96
  v_min3_f32 v31, v31, v95, v96
  v_max3_f32 v30, v30, v97, v98
  s_waitcnt lgkmcnt(4)
  v_mfma_f32_32x32x16_bf16 v[104:119], v[64:67], v[160:163], v[104:119]
  ds_read_b64_tr_b16 v[56:57], v252 offset:53248
  ds_read_b64_tr_b16 v[58:59], v252 offset:53760
  v_min3_f32 v31, v31, v97, v98
  v_max3_f32 v30, v30, v99, v100
  v_min3_f32 v31, v31, v99, v100
  v_max3_f32 v30, v30, v101, v102
  v_min3_f32 v31, v31, v101, v102
  v_max_f32 v30, v30, v103
  v_min_f32 v31, v31, v103
  v_mfma_f32_32x32x16_bf16 v[104:119], v[68:71], v[164:167], v[104:119]
  ds_read_b64_tr_b16 v[60:61], v252 offset:55296
  ds_read_b64_tr_b16 v[62:63], v252 offset:55808
  v_mov_b32 v32, v30
  v_mov_b32 v33, v31
  s_nop 0
  v_permlane32_swap_b32 v30, v32
  v_permlane32_swap_b32 v31, v33
  v_max_f32 v30, v30, v32
  v_min_f32 v31, v31, v33
  v_mul_f32 v34, s90, v30
  s_waitcnt lgkmcnt(4)
  v_mfma_f32_32x32x16_bf16 v[104:119], v[48:51], v[168:171], v[104:119]
  s_add_u32 m0, s61, 24576
  ds_read_b64_tr_b16 v[64:65], v252 offset:40960
  ds_read_b64_tr_b16 v[66:67], v252 offset:41472
  buffer_load_dwordx4 v3, s[20:23], s9 offen lds
  v_mul_f32 v35, s88, v31
  v_fma_f32 v72, v88, s88, v34
  v_fma_f32 v73, v89, s88, v34
  v_fma_f32 v88, v88, s90, v35
  v_mfma_f32_32x32x16_bf16 v[104:119], v[52:55], v[172:175], v[104:119]
  ds_read_b64_tr_b16 v[68:69], v252 offset:43008
  ds_read_b64_tr_b16 v[70:71], v252 offset:43520
  v_fma_f32 v89, v89, s90, v35
  v_fma_f32 v74, v90, s88, v34
  v_fma_f32 v75, v91, s88, v34
  v_fma_f32 v90, v90, s90, v35
  v_fma_f32 v91, v91, s90, v35
  v_fma_f32 v76, v92, s88, v34
  v_fma_f32 v77, v93, s88, v34
  s_waitcnt lgkmcnt(4)
  v_mfma_f32_32x32x16_bf16 v[104:119], v[56:59], v[176:179], v[104:119]
  ds_read_b64_tr_b16 v[48:49], v252 offset:45056
  ds_read_b64_tr_b16 v[50:51], v252 offset:45568
  v_fma_f32 v92, v92, s90, v35
  v_fma_f32 v93, v93, s90, v35
  v_fma_f32 v78, v94, s88, v34
  v_fma_f32 v79, v95, s88, v34
  v_fma_f32 v94, v94, s90, v35
  v_fma_f32 v95, v95, s90, v35
  v_fma_f32 v80, v96, s88, v34
  v_mfma_f32_32x32x16_bf16 v[104:119], v[60:63], v[180:183], v[104:119]
  ds_read_b64_tr_b16 v[52:53], v252 offset:47104
  ds_read_b64_tr_b16 v[54:55], v252 offset:47616
  v_fma_f32 v81, v97, s88, v34
  v_fma_f32 v96, v96, s90, v35
  v_fma_f32 v97, v97, s90, v35
  v_fma_f32 v82, v98, s88, v34
  v_fma_f32 v83, v99, s88, v34
  v_fma_f32 v98, v98, s90, v35
  v_fma_f32 v99, v99, s90, v35
  s_waitcnt vmcnt(6)
  s_barrier
  s_waitcnt lgkmcnt(4)
  v_mfma_f32_32x32x16_bf16 v[104:119], v[64:67], v[184:187], v[104:119]
  s_add_u32 m0, s61, 139264
  ds_read_b64_tr_b16 v[56:57], v252 offset:32768
  ds_read_b64_tr_b16 v[58:59], v252 offset:33280
  buffer_load_dwordx4 v3, s[20:23], s10 offen lds
  v_fma_f32 v84, v100, s88, v34
  v_fma_f32 v85, v101, s88, v34
  v_fma_f32 v100, v100, s90, v35
  v_fma_f32 v101, v101, s90, v35
  v_mfma_f32_32x32x16_bf16 v[104:119], v[68:71], v[188:191], v[104:119]
  ds_read_b64_tr_b16 v[60:61], v252 offset:34816
  ds_read_b64_tr_b16 v[62:63], v252 offset:35328
  v_fma_f32 v86, v102, s88, v34
  v_fma_f32 v87, v103, s88, v34
  v_fma_f32 v102, v102, s90, v35
  v_fma_f32 v103, v103, s90, v35
  v_exp_f32 v72, v72
  s_waitcnt lgkmcnt(4)
  v_mfma_f32_32x32x16_bf16 v[104:119], v[48:51], v[192:195], v[104:119]
  ds_read_b64_tr_b16 v[64:65], v252 offset:36864
  ds_read_b64_tr_b16 v[66:67], v252 offset:37376
  v_exp_f32 v88, v88
  v_exp_f32 v73, v73
  v_exp_f32 v89, v89
  v_mfma_f32_32x32x16_bf16 v[104:119], v[52:55], v[196:199], v[104:119]
  ds_read_b64_tr_b16 v[68:69], v252 offset:38912
  ds_read_b64_tr_b16 v[70:71], v252 offset:39424
  v_exp_f32 v74, v74
  v_exp_f32 v90, v90
  v_exp_f32 v75, v75
  s_waitcnt lgkmcnt(4)
  v_mfma_f32_32x32x16_bf16 v[104:119], v[56:59], v[200:203], v[104:119]
  ds_read_b64_tr_b16 v[48:49], v252 offset:24576
  ds_read_b64_tr_b16 v[50:51], v252 offset:25088
  v_exp_f32 v91, v91
  v_exp_f32 v76, v76
  v_exp_f32 v92, v92
  v_mfma_f32_32x32x16_bf16 v[104:119], v[60:63], v[204:207], v[104:119]
  ds_read_b64_tr_b16 v[52:53], v252 offset:26624
  ds_read_b64_tr_b16 v[54:55], v252 offset:27136
  v_exp_f32 v77, v77
  v_exp_f32 v93, v93
  v_exp_f32 v78, v78
  s_waitcnt lgkmcnt(4)
  v_mfma_f32_32x32x16_bf16 v[104:119], v[64:67], v[208:211], v[104:119]
  ds_read_b64_tr_b16 v[56:57], v252 offset:28672
  ds_read_b64_tr_b16 v[58:59], v252 offset:29184
  v_exp_f32 v94, v94
  v_exp_f32 v79, v79
  v_exp_f32 v95, v95
  v_mfma_f32_32x32x16_bf16 v[104:119], v[68:71], v[212:215], v[104:119]
  ds_read_b64_tr_b16 v[60:61], v252 offset:30720
  ds_read_b64_tr_b16 v[62:63], v252 offset:31232
  v_exp_f32 v80, v80
  v_exp_f32 v96, v96
  v_exp_f32 v81, v81
  s_waitcnt lgkmcnt(4)
  v_mfma_f32_32x32x16_bf16 v[104:119], v[48:51], v[216:219], v[104:119]
  ds_read_b64_tr_b16 v[64:65], v252 offset:16384
  ds_read_b64_tr_b16 v[66:67], v252 offset:16896
  v_exp_f32 v97, v97
  v_exp_f32 v82, v82
  v_exp_f32 v98, v98
  v_mfma_f32_32x32x16_bf16 v[104:119], v[52:55], v[220:223], v[104:119]
  ds_read_b64_tr_b16 v[68:69], v252 offset:18432
  ds_read_b64_tr_b16 v[70:71], v252 offset:18944
  v_exp_f32 v83, v83
  v_exp_f32 v99, v99
  v_exp_f32 v84, v84
  s_waitcnt lgkmcnt(4)
  v_mfma_f32_32x32x16_bf16 v[104:119], v[56:59], v[224:227], v[104:119]
  ds_read_b64_tr_b16 v[48:49], v252 offset:20480
  ds_read_b64_tr_b16 v[50:51], v252 offset:20992
  v_exp_f32 v100, v100
  v_exp_f32 v85, v85
  v_exp_f32 v101, v101
  v_mfma_f32_32x32x16_bf16 v[104:119], v[60:63], v[228:231], v[104:119]
  ds_read_b64_tr_b16 v[52:53], v252 offset:22528
  ds_read_b64_tr_b16 v[54:55], v252 offset:23040
  v_exp_f32 v86, v86
  v_exp_f32 v102, v102
  v_exp_f32 v87, v87
  s_waitcnt vmcnt(3)
  s_barrier
  s_cmp_lg_u32 s60, 0
  s_cbranch_scc1 Lpi_5
  s_mov_b32 s13, 0
  s_atomic_add s13, s[14:15], s84 offset:0 glc
Lpi_5:
  s_waitcnt lgkmcnt(4)
  v_mfma_f32_32x32x16_bf16 v[104:119], v[64:67], v[232:235], v[104:119]
  ds_read_b64_tr_b16 v[56:57], v252 offset:8192
  ds_read_b64_tr_b16 v[58:59], v252 offset:8704
  v_exp_f32 v103, v103
  v_cvt_pk_bf16_f32 v88, v88, v89
  v_cvt_pk_bf16_f32 v89, v90, v91
  v_cvt_pk_bf16_f32 v90, v92, v93
  v_cvt_pk_bf16_f32 v91, v94, v95
  v_cvt_pk_bf16_f32 v92, v96, v97
  v_mfma_f32_32x32x16_bf16 v[104:119], v[68:71], v[236:239], v[104:119]
  ds_read_b64_tr_b16 v[60:61], v252 offset:10240
  ds_read_b64_tr_b16 v[62:63], v252 offset:10752
  v_cvt_pk_bf16_f32 v93, v98, v99
  v_cvt_pk_bf16_f32 v94, v100, v101
  v_cvt_pk_bf16_f32 v95, v102, v103
  v_cvt_pk_bf16_f32 v96, v72, v73
  v_cvt_pk_bf16_f32 v97, v74, v75
  v_cvt_pk_bf16_f32 v98, v76, v77
  v_cvt_pk_bf16_f32 v99, v78, v79
  s_waitcnt lgkmcnt(4)
  v_mfma_f32_32x32x16_bf16 v[104:119], v[48:51], v[240:243], v[104:119]
  ds_read_b64_tr_b16 v[64:65], v252 offset:12288
  ds_read_b64_tr_b16 v[66:67], v252 offset:12800
  v_cvt_pk_bf16_f32 v100, v80, v81
  v_cvt_pk_bf16_f32 v101, v82, v83
  v_cvt_pk_bf16_f32 v102, v84, v85
  v_cvt_pk_bf16_f32 v103, v86, v87
  v_mfma_f32_32x32x16_bf16 v[104:119], v[52:55], v[244:247], v[104:119]
  ds_read_b64_tr_b16 v[68:69], v252 offset:14336
  ds_read_b64_tr_b16 v[70:71], v252 offset:14848
  s_waitcnt lgkmcnt(4)
  v_mfma_f32_32x32x16_bf16 v[72:87], v[56:59], v[136:139], 0
  ds_read_b64_tr_b16 v[48:49], v252 offset:0
  ds_read_b64_tr_b16 v[50:51], v252 offset:512
  ds_read_b64_tr_b16 v[40:41], v19 offset:57344
  ds_read_b64_tr_b16 v[42:43], v19 offset:57792
  ds_read_b64_tr_b16 v[44:45], v19 offset:58240
  ds_read_b64_tr_b16 v[46:47], v250 offset:58688
  s_nop 1
  v_cvt_pk_bf16_f32 v22, v104, v105
  v_cvt_pk_bf16_f32 v23, v106, v107
  v_mfma_f32_32x32x16_bf16 v[72:87], v[60:63], v[140:143], v[72:87]
  ds_read_b64_tr_b16 v[52:53], v252 offset:2048
  ds_read_b64_tr_b16 v[54:55], v252 offset:2560
  v_cvt_pk_bf16_f32 v24, v108, v109
  v_cvt_pk_bf16_f32 v25, v110, v111
  v_cvt_pk_bf16_f32 v26, v112, v113
  v_cvt_pk_bf16_f32 v27, v114, v115
  v_cvt_pk_bf16_f32 v28, v116, v117
  v_cvt_pk_bf16_f32 v29, v118, v119
  s_waitcnt lgkmcnt(8)
  v_mfma_f32_32x32x16_bf16 v[72:87], v[64:67], v[144:147], v[72:87]
  ds_read_b64_tr_b16 v[56:57], v252 offset:4096
  ds_read_b64_tr_b16 v[58:59], v252 offset:4608
  s_waitcnt lgkmcnt(4)
  v_mfma_f32_32x32x16_bf16 v[120:135], v[40:43], v[22:25], 0
  v_mfma_f32_32x32x16_bf16 v[120:135], v[44:47], v[26:29], v[120:135]
  v_mfma_f32_32x32x16_bf16 v[72:87], v[68:71], v[148:151], v[72:87]
  ds_read_b64_tr_b16 v[60:61], v252 offset:6144
  ds_read_b64_tr_b16 v[62:63], v252 offset:6656
  s_waitcnt lgkmcnt(4)
  v_mfma_f32_32x32x16_bf16 v[72:87], v[48:51], v[152:155], v[72:87]
  ds_read_b64_tr_b16 v[64:65], v253 offset:24576
  ds_read_b64_tr_b16 v[66:67], v253 offset:25088
  s_nop 4
  v_max3_f32 v30, v120, v121, v122
  v_min3_f32 v31, v120, v121, v122
  v_max3_f32 v30, v30, v123, v124
  v_mfma_f32_32x32x16_bf16 v[72:87], v[52:55], v[156:159], v[72:87]
  ds_read_b64_tr_b16 v[68:69], v253 offset:26624
  ds_read_b64_tr_b16 v[70:71], v253 offset:27136
  v_min3_f32 v31, v31, v123, v124
  v_max3_f32 v30, v30, v125, v126
  v_min3_f32 v31, v31, v125, v126
  v_max3_f32 v30, v30, v127, v128
  v_min3_f32 v31, v31, v127, v128
  v_max3_f32 v30, v30, v129, v130
  s_waitcnt lgkmcnt(4)
  v_mfma_f32_32x32x16_bf16 v[72:87], v[56:59], v[160:163], v[72:87]
  ds_read_b64_tr_b16 v[48:49], v253 offset:28672
  ds_read_b64_tr_b16 v[50:51], v253 offset:29184
  v_min3_f32 v31, v31, v129, v130
  v_max3_f32 v30, v30, v131, v132
  v_min3_f32 v31, v31, v131, v132
  v_max3_f32 v30, v30, v133, v134
  v_min3_f32 v31, v31, v133, v134
  v_max_f32 v30, v30, v135
  v_mfma_f32_32x32x16_bf16 v[72:87], v[60:63], v[164:167], v[72:87]
  ds_read_b64_tr_b16 v[52:53], v253 offset:30720
  ds_read_b64_tr_b16 v[54:55], v253 offset:31232
  v_min_f32 v31, v31, v135
  v_mov_b32 v32, v30
  v_mov_b32 v33, v31
  s_nop 0
  v_permlane32_swap_b32 v30, v32
  v_permlane32_swap_b32 v31, v33
  v_max_f32 v30, v30, v32
  s_waitcnt lgkmcnt(4)
  v_mfma_f32_32x32x16_bf16 v[72:87], v[64:67], v[168:171], v[72:87]
  ds_read_b64_tr_b16 v[56:57], v253 offset:16384
  ds_read_b64_tr_b16 v[58:59], v253 offset:16896
  v_min_f32 v31, v31, v33
  v_mul_f32 v34, s90, v30
  v_mul_f32 v35, s88, v31
  v_fma_f32 v104, v120, s88, v34
  v_fma_f32 v105, v121, s88, v34
  v_fma_f32 v120, v120, s90, v35
  v_mfma_f32_32x32x16_bf16 v[72:87], v[68:71], v[172:175], v[72:87]
  ds_read_b64_tr_b16 v[60:61], v253 offset:18432
  ds_read_b64_tr_b16 v[62:63], v253 offset:18944
  v_fma_f32 v121, v121, s90, v35
  v_fma_f32 v106, v122, s88, v34
  v_fma_f32 v107, v123, s88, v34
  v_fma_f32 v122, v122, s90, v35
  v_fma_f32 v123, v123, s90, v35
  v_fma_f32 v108, v124, s88, v34
  s_waitcnt lgkmcnt(4)
  v_mfma_f32_32x32x16_bf16 v[72:87], v[48:51], v[176:179], v[72:87]
  ds_read_b64_tr_b16 v[64:65], v253 offset:20480
  ds_read_b64_tr_b16 v[66:67], v253 offset:20992
  v_fma_f32 v109, v125, s88, v34
  v_fma_f32 v124, v124, s90, v35
  v_fma_f32 v125, v125, s90, v35
  v_fma_f32 v110, v126, s88, v34
  v_fma_f32 v111, v127, s88, v34
  v_fma_f32 v126, v126, s90, v35
  v_mfma_f32_32x32x16_bf16 v[72:87], v[52:55], v[180:183], v[72:87]
  ds_read_b64_tr_b16 v[68:69], v253 offset:22528
  ds_read_b64_tr_b16 v[70:71], v253 offset:23040
  v_fma_f32 v127, v127, s90, v35
  v_fma_f32 v112, v128, s88, v34
  v_fma_f32 v113, v129, s88, v34
  v_fma_f32 v128, v128, s90, v35
  v_fma_f32 v129, v129, s90, v35
  v_fma_f32 v114, v130, s88, v34
  s_cmp_lg_u32 s60, 0
  s_cbranch_scc1 Lpc_6
  s_waitcnt lgkmcnt(0)
  s_cmp_ge_u32 s13, 10
  s_cbranch_scc1 Lpc_6
  s_mov_b32 s93, 0
Lsp_7:
  s_mov_b32 s13, 0
  s_atomic_add s13, s[14:15], s84 offset:0 glc
  s_add_u32 s93, s93, 1
  s_waitcnt lgkmcnt(0)
  s_cmp_ge_u32 s13, 10
  s_cbranch_scc1 Lpc_6
  s_cmp_lt_u32 s93, 20000
  s_cbranch_scc1 Lsp_7
Lpc_6:
  s_waitcnt vmcnt(0)
  s_barrier
  v_and_b32 v248, 31, v0
  v_lshlrev_b32 v248, 2, v248
  s_lshl2_add_u32 s77, s64, s63
  s_lshl_b32 s77, s77, 7
  s_add_u32 s77, s77, 9773056
  buffer_load_dword v251, v248, s[52:55], s77 offen sc1
  s_waitcnt lgkmcnt(4)
  v_mfma_f32_32x32x16_bf16 v[72:87], v[56:59], v[184:187], v[72:87]
  ds_read_b64_tr_b16 v[48:49], v7 offset:32768
  ds_read_b64_tr_b16 v[50:51], v7 offset:33280
  v_fma_f32 v115, v131, s88, v34
  v_fma_f32 v130, v130, s90, v35
  v_fma_f32 v131, v131, s90, v35
  v_fma_f32 v116, v132, s88, v34
  v_fma_f32 v117, v133, s88, v34
  v_fma_f32 v132, v132, s90, v35
  v_mfma_f32_32x32x16_bf16 v[72:87], v[60:63], v[188:191], v[72:87]
  ds_read_b64_tr_b16 v[52:53], v7 offset:34816
  ds_read_b64_tr_b16 v[54:55], v7 offset:35328
  v_fma_f32 v133, v133, s90, v35
  v_fma_f32 v118, v134, s88, v34
  v_fma_f32 v119, v135, s88, v34
  v_fma_f32 v134, v134, s90, v35
  v_fma_f32 v135, v135, s90, v35
  s_waitcnt lgkmcnt(4)
  v_mfma_f32_32x32x16_bf16 v[72:87], v[64:67], v[192:195], v[72:87]
  ds_read_b64_tr_b16 v[56:57], v7 offset:36864
  ds_read_b64_tr_b16 v[58:59], v7 offset:37376
  v_exp_f32 v104, v104
  v_exp_f32 v120, v120
  v_exp_f32 v105, v105
  v_mfma_f32_32x32x16_bf16 v[72:87], v[68:71], v[196:199], v[72:87]
  ds_read_b64_tr_b16 v[60:61], v7 offset:38912
  ds_read_b64_tr_b16 v[62:63], v7 offset:39424
  v_exp_f32 v121, v121
  v_exp_f32 v106, v106
  v_exp_f32 v122, v122
  s_waitcnt lgkmcnt(4)
  v_mfma_f32_32x32x16_bf16 v[72:87], v[48:51], v[200:203], v[72:87]
  ds_read_b64_tr_b16 v[64:65], v7 offset:24576
  ds_read_b64_tr_b16 v[66:67], v7 offset:25088
  v_exp_f32 v107, v107
  v_exp_f32 v123, v123
  v_exp_f32 v108, v108
  v_mfma_f32_32x32x16_bf16 v[72:87], v[52:55], v[204:207], v[72:87]
  ds_read_b64_tr_b16 v[68:69], v7 offset:26624
  ds_read_b64_tr_b16 v[70:71], v7 offset:27136
  v_exp_f32 v124, v124
  v_exp_f32 v109, v109
  v_exp_f32 v125, v125
  s_waitcnt lgkmcnt(4)
  v_mfma_f32_32x32x16_bf16 v[72:87], v[56:59], v[208:211], v[72:87]
  ds_read_b64_tr_b16 v[48:49], v7 offset:28672
  ds_read_b64_tr_b16 v[50:51], v7 offset:29184
  v_exp_f32 v110, v110
  v_exp_f32 v126, v126
  v_exp_f32 v111, v111
  v_mfma_f32_32x32x16_bf16 v[72:87], v[60:63], v[212:215], v[72:87]
  ds_read_b64_tr_b16 v[52:53], v7 offset:30720
  ds_read_b64_tr_b16 v[54:55], v7 offset:31232
  v_exp_f32 v127, v127
  v_exp_f32 v112, v112
  v_exp_f32 v128, v128
  s_waitcnt lgkmcnt(4)
  v_mfma_f32_32x32x16_bf16 v[72:87], v[64:67], v[216:219], v[72:87]
  ds_read_b64_tr_b16 v[56:57], v253 offset:8192
  ds_read_b64_tr_b16 v[58:59], v253 offset:8704
  v_exp_f32 v113, v113
  v_exp_f32 v129, v129
  v_exp_f32 v114, v114
  v_mfma_f32_32x32x16_bf16 v[72:87], v[68:71], v[220:223], v[72:87]
  ds_read_b64_tr_b16 v[60:61], v253 offset:10240
  ds_read_b64_tr_b16 v[62:63], v253 offset:10752
  v_exp_f32 v130, v130
  v_exp_f32 v115, v115
  v_exp_f32 v131, v131
  s_waitcnt lgkmcnt(4)
  v_mfma_f32_32x32x16_bf16 v[72:87], v[48:51], v[224:227], v[72:87]
  ds_read_b64_tr_b16 v[64:65], v253 offset:12288
  ds_read_b64_tr_b16 v[66:67], v253 offset:12800
  v_exp_f32 v116, v116
  v_exp_f32 v132, v132
  v_exp_f32 v117, v117
  v_mfma_f32_32x32x16_bf16 v[72:87], v[52:55], v[228:231], v[72:87]
  ds_read_b64_tr_b16 v[68:69], v253 offset:14336
  ds_read_b64_tr_b16 v[70:71], v253 offset:14848
  v_exp_f32 v133, v133
  v_exp_f32 v118, v118
  v_exp_f32 v134, v134
  s_waitcnt lgkmcnt(4)
  v_mfma_f32_32x32x16_bf16 v[72:87], v[56:59], v[232:235], v[72:87]
  v_exp_f32 v119, v119
  v_exp_f32 v135, v135
  v_cvt_pk_bf16_f32 v120, v120, v121
  v_cvt_pk_bf16_f32 v121, v122, v123
  v_mfma_f32_32x32x16_bf16 v[72:87], v[60:63], v[236:239], v[72:87]
  v_cvt_pk_bf16_f32 v122, v124, v125
  v_cvt_pk_bf16_f32 v123, v126, v127
  v_cvt_pk_bf16_f32 v124, v128, v129
  v_cvt_pk_bf16_f32 v125, v130, v131
  v_cvt_pk_bf16_f32 v126, v132, v133
  v_cvt_pk_bf16_f32 v127, v134, v135
  s_waitcnt lgkmcnt(0)
  v_mfma_f32_32x32x16_bf16 v[72:87], v[64:67], v[240:243], v[72:87]
  v_cvt_pk_bf16_f32 v104, v104, v105
  v_cvt_pk_bf16_f32 v105, v106, v107
  v_cvt_pk_bf16_f32 v106, v108, v109
  v_cvt_pk_bf16_f32 v107, v110, v111
  v_cvt_pk_bf16_f32 v108, v112, v113
  v_cvt_pk_bf16_f32 v109, v114, v115
  v_mfma_f32_32x32x16_bf16 v[72:87], v[68:71], v[244:247], v[72:87]
  v_cvt_pk_bf16_f32 v110, v116, v117
  v_cvt_pk_bf16_f32 v111, v118, v119
  v_mov_b32 v136, v1
  v_mov_b32 v137, v2
  v_mov_b32 v138, v4
  v_mov_b32 v139, v6
  v_mov_b32 v140, v8
  v_mov_b32 v141, v9
  v_mov_b32 v142, v10
  v_mov_b32 v143, v11
  v_mov_b32 v144, v12
  v_mov_b32 v145, v13
  v_mov_b32 v146, v15
  v_mov_b32 v147, v16
  v_mov_b32 v148, v17
  v_mov_b32 v149, v21
  v_mov_b32 v150, v38
  v_mov_b32 v151, v39
  ds_read_b64_tr_b16 v[40:41], v19 offset:60480
  ds_read_b64_tr_b16 v[42:43], v19 offset:60928
  ds_read_b64_tr_b16 v[44:45], v19 offset:61376
  ds_read_b64_tr_b16 v[46:47], v14 offset:61824
  v_cvt_pk_bf16_f32 v22, v72, v73
  v_cvt_pk_bf16_f32 v23, v74, v75
  v_cvt_pk_bf16_f32 v24, v76, v77
  v_cvt_pk_bf16_f32 v25, v78, v79
  v_cvt_pk_bf16_f32 v26, v80, v81
  v_cvt_pk_bf16_f32 v27, v82, v83
  v_cvt_pk_bf16_f32 v28, v84, v85
  v_cvt_pk_bf16_f32 v29, v86, v87
  s_waitcnt lgkmcnt(0)
  v_mfma_f32_32x32x16_bf16 v[152:167], v[40:43], v[22:25], 0
  v_mfma_f32_32x32x16_bf16 v[152:167], v[44:47], v[26:29], v[152:167]
  s_cmp_lt_u32 s60, 4
  s_cbranch_scc1 Lpi_8
  s_mov_b32 s13, 0
  s_atomic_add s13, s[14:15], s92 offset:1024 glc
Lpi_8:
  s_nop 9
  v_max3_f32 v30, v152, v153, v154
  v_min3_f32 v31, v152, v153, v154
  v_max3_f32 v30, v30, v155, v156
  v_min3_f32 v31, v31, v155, v156
  v_max3_f32 v30, v30, v157, v158
  v_min3_f32 v31, v31, v157, v158
  v_max3_f32 v30, v30, v159, v160
  v_min3_f32 v31, v31, v159, v160
  v_max3_f32 v30, v30, v161, v162
  v_min3_f32 v31, v31, v161, v162
  v_max3_f32 v30, v30, v163, v164
  v_min3_f32 v31, v31, v163, v164
  v_max3_f32 v30, v30, v165, v166
  v_min3_f32 v31, v31, v165, v166
  v_max_f32 v30, v30, v167
  v_min_f32 v31, v31, v167
  v_mov_b32 v32, v30
  v_mov_b32 v33, v31
  s_nop 0
  v_permlane32_swap_b32 v30, v32
  v_permlane32_swap_b32 v31, v33
  v_max_f32 v30, v30, v32
  v_min_f32 v31, v31, v33
  v_mul_f32 v34, s90, v30
  v_mul_f32 v35, s88, v31
  v_pk_fma_f32 v[72:73], v[152:153], s[88:89], v[34:35] op_sel:[0,0,0] op_sel_hi:[1,0,0]
  v_pk_fma_f32 v[152:153], v[152:153], s[90:91], v[34:35] op_sel:[0,0,1] op_sel_hi:[1,0,1]
  v_pk_fma_f32 v[74:75], v[154:155], s[88:89], v[34:35] op_sel:[0,0,0] op_sel_hi:[1,0,0]
  v_pk_fma_f32 v[154:155], v[154:155], s[90:91], v[34:35] op_sel:[0,0,1] op_sel_hi:[1,0,1]
  v_pk_fma_f32 v[76:77], v[156:157], s[88:89], v[34:35] op_sel:[0,0,0] op_sel_hi:[1,0,0]
  v_pk_fma_f32 v[156:157], v[156:157], s[90:91], v[34:35] op_sel:[0,0,1] op_sel_hi:[1,0,1]
  v_pk_fma_f32 v[78:79], v[158:159], s[88:89], v[34:35] op_sel:[0,0,0] op_sel_hi:[1,0,0]
  v_pk_fma_f32 v[158:159], v[158:159], s[90:91], v[34:35] op_sel:[0,0,1] op_sel_hi:[1,0,1]
  v_pk_fma_f32 v[80:81], v[160:161], s[88:89], v[34:35] op_sel:[0,0,0] op_sel_hi:[1,0,0]
  v_pk_fma_f32 v[160:161], v[160:161], s[90:91], v[34:35] op_sel:[0,0,1] op_sel_hi:[1,0,1]
  v_pk_fma_f32 v[82:83], v[162:163], s[88:89], v[34:35] op_sel:[0,0,0] op_sel_hi:[1,0,0]
  v_pk_fma_f32 v[162:163], v[162:163], s[90:91], v[34:35] op_sel:[0,0,1] op_sel_hi:[1,0,1]
  v_pk_fma_f32 v[84:85], v[164:165], s[88:89], v[34:35] op_sel:[0,0,0] op_sel_hi:[1,0,0]
  v_pk_fma_f32 v[164:165], v[164:165], s[90:91], v[34:35] op_sel:[0,0,1] op_sel_hi:[1,0,1]
  v_pk_fma_f32 v[86:87], v[166:167], s[88:89], v[34:35] op_sel:[0,0,0] op_sel_hi:[1,0,0]
  v_pk_fma_f32 v[166:167], v[166:167], s[90:91], v[34:35] op_sel:[0,0,1] op_sel_hi:[1,0,1]
  v_exp_f32 v72, v72
  v_exp_f32 v152, v152
  v_exp_f32 v73, v73
  v_exp_f32 v153, v153
  s_cmp_lt_u32 s60, 4
  s_cbranch_scc1 Lpc_9
  s_waitcnt lgkmcnt(0)
  s_cmp_ge_u32 s13, 16
  s_cbranch_scc1 Lpc_9
  s_mov_b32 s93, 0
Lsp_10:
  s_mov_b32 s13, 0
  s_atomic_add s13, s[14:15], s92 offset:1024 glc
  s_add_u32 s93, s93, 1
  s_waitcnt lgkmcnt(0)
  s_cmp_ge_u32 s13, 16
  s_cbranch_scc1 Lpc_9
  s_cmp_lt_u32 s93, 20000
  s_cbranch_scc1 Lsp_10
Lpc_9:
  s_barrier
  s_add_u32 m0, s61, 0
  s_add_u32 s75, s97, 0
  buffer_load_dwordx4 v5, s[52:55], s75 offen sc1 lds
  s_add_u32 m0, s61, 8192
  s_add_u32 s75, s97, 8192
  buffer_load_dwordx4 v5, s[52:55], s75 offen sc1 lds
  s_add_u32 m0, s61, 16384
  s_add_u32 s75, s97, 16384
  buffer_load_dwordx4 v5, s[52:55], s75 offen sc1 lds
  s_add_u32 m0, s61, 24576
  s_add_u32 s75, s97, 24576
  buffer_load_dwordx4 v5, s[52:55], s75 offen sc1 lds
  v_exp_f32 v74, v74
  v_exp_f32 v154, v154
  v_exp_f32 v75, v75
  v_exp_f32 v155, v155
  v_exp_f32 v76, v76
  v_exp_f32 v156, v156
  v_exp_f32 v77, v77
  v_exp_f32 v157, v157
  v_exp_f32 v78, v78
  v_exp_f32 v158, v158
  v_exp_f32 v79, v79
  v_exp_f32 v159, v159
  v_exp_f32 v80, v80
  v_exp_f32 v160, v160
  v_exp_f32 v81, v81
  v_exp_f32 v161, v161
  v_exp_f32 v82, v82
  v_exp_f32 v162, v162
  v_exp_f32 v83, v83
  v_exp_f32 v163, v163
  v_exp_f32 v84, v84
  v_exp_f32 v164, v164
  v_exp_f32 v85, v85
  v_exp_f32 v165, v165
  v_exp_f32 v86, v86
  v_exp_f32 v166, v166
  v_exp_f32 v87, v87
  v_exp_f32 v167, v167
  v_cvt_pk_bf16_f32 v152, v152, v153
  v_cvt_pk_bf16_f32 v153, v154, v155
  v_cvt_pk_bf16_f32 v154, v156, v157
  v_cvt_pk_bf16_f32 v155, v158, v159
  v_cvt_pk_bf16_f32 v156, v160, v161
  v_cvt_pk_bf16_f32 v157, v162, v163
  v_cvt_pk_bf16_f32 v158, v164, v165
  v_cvt_pk_bf16_f32 v159, v166, v167
  v_cvt_pk_bf16_f32 v72, v72, v73
  v_cvt_pk_bf16_f32 v73, v74, v75
  v_cvt_pk_bf16_f32 v74, v76, v77
  v_cvt_pk_bf16_f32 v75, v78, v79
  v_cvt_pk_bf16_f32 v76, v80, v81
  v_cvt_pk_bf16_f32 v77, v82, v83
  v_cvt_pk_bf16_f32 v78, v84, v85
  v_cvt_pk_bf16_f32 v79, v86, v87
  s_add_u32 s86, s86, s80
  s_waitcnt vmcnt(0)
  s_barrier
  ds_read_b128 v[168:171], v18 offset:0
  ds_read_b128 v[172:175], v18 offset:1024
  ds_read_b128 v[176:179], v18 offset:2048
  ds_read_b128 v[180:183], v18 offset:3072
  ds_read_b128 v[48:51], v18 offset:8192
  ds_read_b128 v[52:55], v18 offset:9216
  ds_read_b128 v[56:59], v18 offset:10240
  ds_read_b128 v[60:63], v18 offset:11264
  s_waitcnt lgkmcnt(7)
  v_mfma_f32_32x32x16_bf16 v[184:199], v[168:171], v[136:139], 0
  s_waitcnt lgkmcnt(6)
  v_mfma_f32_32x32x16_bf16 v[184:199], v[172:175], v[140:143], v[184:199]
  s_waitcnt lgkmcnt(5)
  v_mfma_f32_32x32x16_bf16 v[200:215], v[176:179], v[144:147], 0
  s_waitcnt lgkmcnt(4)
  v_mfma_f32_32x32x16_bf16 v[200:215], v[180:183], v[148:151], v[200:215]
  ds_read_b128 v[168:171], v18 offset:16384
  ds_read_b128 v[172:175], v18 offset:17408
  ds_read_b128 v[176:179], v18 offset:18432
  ds_read_b128 v[180:183], v18 offset:19456
  s_waitcnt lgkmcnt(7)
  v_mfma_f32_32x32x16_bf16 v[216:231], v[48:51], v[96:99], 0
  s_nop 1
  v_rcp_f32 v10, v197
  s_nop 2
  v_rcp_f32 v12, v213
  v_mov_b32 v11, 0x358637bd
  v_fmac_f32 v11, v196, v10
  v_fmac_f32 v11, v212, v12
  v_rcp_f32 v13, v11
  v_mul_f32 v10, v251, v10
  v_mul_f32 v12, v251, v12
  v_mul_f32 v11, v13, v10
  v_mul_f32 v10, v13, v10
  v_mul_f32 v12, v13, v12
  s_waitcnt lgkmcnt(6)
  v_mfma_f32_32x32x16_bf16 v[216:231], v[52:55], v[100:103], v[216:231]
  v_mov_b32 v13, v12
  v_permlane32_swap_b32 v10, v11
  v_mul_f32 v184, v11, v184
  v_mul_f32 v185, v11, v185
  v_mul_f32 v186, v11, v186
  v_mul_f32 v187, v11, v187
  v_mul_f32 v188, v11, v188
  v_mul_f32 v189, v11, v189
  v_mul_f32 v190, v11, v190
  v_mul_f32 v191, v11, v191
  v_mul_f32 v192, v11, v192
  s_waitcnt lgkmcnt(5)
  v_mfma_f32_32x32x16_bf16 v[232:247], v[56:59], v[88:91], 0
  v_mul_f32 v193, v11, v193
  v_mul_f32 v194, v11, v194
  v_mul_f32 v195, v11, v195
  v_mul_f32 v196, v11, v196
  v_mul_f32 v197, v11, v197
  v_mul_f32 v198, v11, v198
  v_mul_f32 v199, v11, v199
  v_permlane32_swap_b32 v12, v13
  v_fmac_f32 v184, v13, v200
  v_fmac_f32 v185, v13, v201
  v_fmac_f32 v186, v13, v202
  s_waitcnt lgkmcnt(4)
  v_mfma_f32_32x32x16_bf16 v[232:247], v[60:63], v[92:95], v[232:247]
  v_fmac_f32 v187, v13, v203
  v_fmac_f32 v188, v13, v204
  v_fmac_f32 v189, v13, v205
  v_fmac_f32 v190, v13, v206
  v_fmac_f32 v191, v13, v207
  v_fmac_f32 v192, v13, v208
  v_fmac_f32 v193, v13, v209
  v_fmac_f32 v194, v13, v210
  v_fmac_f32 v195, v13, v211
  v_fmac_f32 v196, v13, v212
  v_fmac_f32 v197, v13, v213
  v_fmac_f32 v198, v13, v214
  v_fmac_f32 v199, v13, v215
  v_cvt_pk_bf16_f32 v200, v184, v185
  v_cvt_pk_bf16_f32 v201, v186, v187
  v_cvt_pk_bf16_f32 v202, v188, v189
  v_cvt_pk_bf16_f32 v203, v190, v191
  buffer_store_dwordx4 v[200:203], v5, s[52:55], s86 offen offset:0 sc1
  v_cvt_pk_bf16_f32 v204, v192, v193
  v_cvt_pk_bf16_f32 v205, v194, v195
  v_cvt_pk_bf16_f32 v206, v196, v197
  v_cvt_pk_bf16_f32 v207, v198, v199
  s_mov_b32 exec_lo, 0
  v_mov_b32 v206, 0
  v_mov_b32 v207, 0
  s_mov_b32 exec_lo, -1
  buffer_store_dwordx4 v[204:207], v5, s[52:55], s86 offen offset:1024 sc1
  s_add_u32 s86, s86, 4096
  ds_read_b128 v[48:51], v18 offset:24576
  ds_read_b128 v[52:55], v18 offset:25600
  ds_read_b128 v[56:59], v18 offset:26624
  ds_read_b128 v[60:63], v18 offset:27648
  s_waitcnt lgkmcnt(7)
  v_mfma_f32_32x32x16_bf16 v[184:199], v[168:171], v[104:107], 0
  v_rcp_f32 v10, v229
  v_rcp_f32 v12, v245
  v_mov_b32 v11, 0x358637bd
  v_fmac_f32 v11, v228, v10
  v_fmac_f32 v11, v244, v12
  v_rcp_f32 v13, v11
  v_mul_f32 v10, v251, v10
  v_mul_f32 v12, v251, v12
  v_mul_f32 v11, v13, v10
  v_mul_f32 v10, v13, v10
  v_mul_f32 v12, v13, v12
  s_waitcnt lgkmcnt(6)
  v_mfma_f32_32x32x16_bf16 v[184:199], v[172:175], v[108:111], v[184:199]
  v_mov_b32 v13, v12
  v_permlane32_swap_b32 v10, v11
  v_mul_f32 v216, v11, v216
  v_mul_f32 v217, v11, v217
  v_mul_f32 v218, v11, v218
  v_mul_f32 v219, v11, v219
  v_mul_f32 v220, v11, v220
  v_mul_f32 v221, v11, v221
  v_mul_f32 v222, v11, v222
  v_mul_f32 v223, v11, v223
  v_mul_f32 v224, v11, v224
  s_waitcnt lgkmcnt(5)
  v_mfma_f32_32x32x16_bf16 v[200:215], v[176:179], v[120:123], 0
  v_mul_f32 v225, v11, v225
  v_mul_f32 v226, v11, v226
  v_mul_f32 v227, v11, v227
  v_mul_f32 v228, v11, v228
  v_mul_f32 v229, v11, v229
  v_mul_f32 v230, v11, v230
  v_mul_f32 v231, v11, v231
  v_permlane32_swap_b32 v12, v13
  v_fmac_f32 v216, v13, v232
  v_fmac_f32 v217, v13, v233
  v_fmac_f32 v218, v13, v234
  s_waitcnt lgkmcnt(4)
  v_mfma_f32_32x32x16_bf16 v[200:215], v[180:183], v[124:127], v[200:215]
  v_fmac_f32 v219, v13, v235
  v_fmac_f32 v220, v13, v236
  v_fmac_f32 v221, v13, v237
  v_fmac_f32 v222, v13, v238
  v_fmac_f32 v223, v13, v239
  v_fmac_f32 v224, v13, v240
  v_fmac_f32 v225, v13, v241
  v_fmac_f32 v226, v13, v242
  v_fmac_f32 v227, v13, v243
  v_fmac_f32 v228, v13, v244
  v_fmac_f32 v229, v13, v245
  v_fmac_f32 v230, v13, v246
  v_fmac_f32 v231, v13, v247
  v_cvt_pk_bf16_f32 v232, v216, v217
  v_cvt_pk_bf16_f32 v233, v218, v219
  v_cvt_pk_bf16_f32 v234, v220, v221
  v_cvt_pk_bf16_f32 v235, v222, v223
  buffer_store_dwordx4 v[232:235], v5, s[52:55], s86 offen offset:0 sc1
  v_cvt_pk_bf16_f32 v236, v224, v225
  v_cvt_pk_bf16_f32 v237, v226, v227
  v_cvt_pk_bf16_f32 v238, v228, v229
  v_cvt_pk_bf16_f32 v239, v230, v231
  s_mov_b32 exec_lo, 0
  v_mov_b32 v238, 0
  v_mov_b32 v239, 0
  s_mov_b32 exec_lo, -1
  buffer_store_dwordx4 v[236:239], v5, s[52:55], s86 offen offset:1024 sc1
  s_add_u32 s86, s86, 4096
  s_waitcnt lgkmcnt(3)
  v_mfma_f32_32x32x16_bf16 v[216:231], v[48:51], v[72:75], 0
  v_rcp_f32 v10, v197
  v_rcp_f32 v12, v213
  v_mov_b32 v11, 0x358637bd
  v_fmac_f32 v11, v196, v10
  v_fmac_f32 v11, v212, v12
  v_rcp_f32 v13, v11
  v_mul_f32 v10, v251, v10
  v_mul_f32 v12, v251, v12
  v_mul_f32 v11, v13, v10
  v_mul_f32 v10, v13, v10
  v_mul_f32 v12, v13, v12
  s_waitcnt lgkmcnt(2)
  v_mfma_f32_32x32x16_bf16 v[216:231], v[52:55], v[76:79], v[216:231]
  v_mov_b32 v13, v12
  v_permlane32_swap_b32 v10, v11
  v_mul_f32 v184, v11, v184
  v_mul_f32 v185, v11, v185
  v_mul_f32 v186, v11, v186
  v_mul_f32 v187, v11, v187
  v_mul_f32 v188, v11, v188
  v_mul_f32 v189, v11, v189
  v_mul_f32 v190, v11, v190
  v_mul_f32 v191, v11, v191
  v_mul_f32 v192, v11, v192
  s_waitcnt lgkmcnt(1)
  v_mfma_f32_32x32x16_bf16 v[232:247], v[56:59], v[152:155], 0
  v_mul_f32 v193, v11, v193
  v_mul_f32 v194, v11, v194
  v_mul_f32 v195, v11, v195
  v_mul_f32 v196, v11, v196
  v_mul_f32 v197, v11, v197
  v_mul_f32 v198, v11, v198
  v_mul_f32 v199, v11, v199
  v_permlane32_swap_b32 v12, v13
  v_fmac_f32 v184, v13, v200
  v_fmac_f32 v185, v13, v201
  v_fmac_f32 v186, v13, v202
  s_waitcnt lgkmcnt(0)
  v_mfma_f32_32x32x16_bf16 v[232:247], v[60:63], v[156:159], v[232:247]
  v_fmac_f32 v187, v13, v203
  v_fmac_f32 v188, v13, v204
  v_fmac_f32 v189, v13, v205
  v_fmac_f32 v190, v13, v206
  v_fmac_f32 v191, v13, v207
  v_fmac_f32 v192, v13, v208
  v_fmac_f32 v193, v13, v209
  v_fmac_f32 v194, v13, v210
  v_fmac_f32 v195, v13, v211
  v_fmac_f32 v196, v13, v212
  v_fmac_f32 v197, v13, v213
  v_fmac_f32 v198, v13, v214
  v_fmac_f32 v199, v13, v215
  v_cvt_pk_bf16_f32 v200, v184, v185
  v_cvt_pk_bf16_f32 v201, v186, v187
  v_cvt_pk_bf16_f32 v202, v188, v189
  v_cvt_pk_bf16_f32 v203, v190, v191
  buffer_store_dwordx4 v[200:203], v5, s[52:55], s86 offen offset:0 sc1
  v_cvt_pk_bf16_f32 v204, v192, v193
  v_cvt_pk_bf16_f32 v205, v194, v195
  v_cvt_pk_bf16_f32 v206, v196, v197
  v_cvt_pk_bf16_f32 v207, v198, v199
  s_mov_b32 exec_lo, 0
  v_mov_b32 v206, 0
  v_mov_b32 v207, 0
  s_mov_b32 exec_lo, -1
  buffer_store_dwordx4 v[204:207], v5, s[52:55], s86 offen offset:1024 sc1
  s_add_u32 s86, s86, 4096
  v_rcp_f32 v10, v229
  v_rcp_f32 v12, v245
  v_mov_b32 v11, 0x358637bd
  v_fmac_f32 v11, v228, v10
  v_fmac_f32 v11, v244, v12
  v_rcp_f32 v13, v11
  v_mul_f32 v10, v251, v10
  v_mul_f32 v12, v251, v12
  v_mul_f32 v11, v13, v10
  v_mul_f32 v10, v13, v10
  v_mul_f32 v12, v13, v12
  v_mov_b32 v13, v12
  v_permlane32_swap_b32 v10, v11
  v_pk_mul_f32 v[216:217], v[216:217], v[10:11] op_sel:[0,1] op_sel_hi:[1,1]
  v_pk_mul_f32 v[218:219], v[218:219], v[10:11] op_sel:[0,1] op_sel_hi:[1,1]
  v_pk_mul_f32 v[220:221], v[220:221], v[10:11] op_sel:[0,1] op_sel_hi:[1,1]
  v_pk_mul_f32 v[222:223], v[222:223], v[10:11] op_sel:[0,1] op_sel_hi:[1,1]
  v_pk_mul_f32 v[224:225], v[224:225], v[10:11] op_sel:[0,1] op_sel_hi:[1,1]
  v_pk_mul_f32 v[226:227], v[226:227], v[10:11] op_sel:[0,1] op_sel_hi:[1,1]
  v_pk_mul_f32 v[228:229], v[228:229], v[10:11] op_sel:[0,1] op_sel_hi:[1,1]
  v_pk_mul_f32 v[230:231], v[230:231], v[10:11] op_sel:[0,1] op_sel_hi:[1,1]
  v_permlane32_swap_b32 v12, v13
  v_pk_fma_f32 v[216:217], v[232:233], v[12:13], v[216:217] op_sel:[0,1,0] op_sel_hi:[1,1,1]
  v_pk_fma_f32 v[218:219], v[234:235], v[12:13], v[218:219] op_sel:[0,1,0] op_sel_hi:[1,1,1]
  v_pk_fma_f32 v[220:221], v[236:237], v[12:13], v[220:221] op_sel:[0,1,0] op_sel_hi:[1,1,1]
  v_pk_fma_f32 v[222:223], v[238:239], v[12:13], v[222:223] op_sel:[0,1,0] op_sel_hi:[1,1,1]
  v_pk_fma_f32 v[224:225], v[240:241], v[12:13], v[224:225] op_sel:[0,1,0] op_sel_hi:[1,1,1]
  v_pk_fma_f32 v[226:227], v[242:243], v[12:13], v[226:227] op_sel:[0,1,0] op_sel_hi:[1,1,1]
  v_pk_fma_f32 v[228:229], v[244:245], v[12:13], v[228:229] op_sel:[0,1,0] op_sel_hi:[1,1,1]
  v_pk_fma_f32 v[230:231], v[246:247], v[12:13], v[230:231] op_sel:[0,1,0] op_sel_hi:[1,1,1]
  v_cvt_pk_bf16_f32 v232, v216, v217
  v_cvt_pk_bf16_f32 v233, v218, v219
  v_cvt_pk_bf16_f32 v234, v220, v221
  v_cvt_pk_bf16_f32 v235, v222, v223
  buffer_store_dwordx4 v[232:235], v5, s[52:55], s86 offen offset:0 sc1
  v_cvt_pk_bf16_f32 v236, v224, v225
  v_cvt_pk_bf16_f32 v237, v226, v227
  v_cvt_pk_bf16_f32 v238, v228, v229
  v_cvt_pk_bf16_f32 v239, v230, v231
  s_mov_b32 exec_lo, 0
  v_mov_b32 v238, 0
  v_mov_b32 v239, 0
  s_mov_b32 exec_lo, -1
  buffer_store_dwordx4 v[236:239], v5, s[52:55], s86 offen offset:1024 sc1
  s_add_u32 s86, s86, 4096
  s_waitcnt vmcnt(4)
  s_barrier
  s_cmp_lg_u32 s60, 1
  s_cbranch_scc1 Lsig_11
  s_atomic_add s87, s[14:15], s84 offset:512
Lsig_11:
  s_waitcnt vmcnt(0)
  s_barrier
  s_cmp_lg_u32 s60, 1
  s_cbranch_scc1 Lsig_12
  s_atomic_add s87, s[14:15], s84 offset:640
Lsig_12:
  s_endpgm
L_L_end:
.p2align 12
L_far:
L_KV:
  s_add_u32 m0, s61, 16384
  s_nop 0
  buffer_load_dwordx4 v1, s[16:19], s69 offen lds
  s_add_u32 m0, s61, 24576
  s_add_u32 s76, s69, 57344
  buffer_load_dwordx4 v1, s[16:19], s76 offen lds
  s_add_u32 m0, s61, 73728
  s_mul_i32 s5, s69, 1344
  buffer_load_dwordx4 v3, s[20:23], s5 offen lds
  v_add_u32 v248, s61, v5
  v_mov_b32 v249, 0x7ffffff0
  v_cmp_gt_u32 vcc, 3136, v248
  s_add_u32 m0, s61, 81920
  s_mul_i32 s75, s65, 3136
  v_cndmask_b32 v248, v249, v248, vcc
  buffer_load_dwordx4 v248, s[24:27], s75 offen lds
  s_mov_b32 s88, 0x3fb8aa3b
  s_mov_b32 s90, 0xbfb8aa3b
  s_lshl2_add_u32 s80, s64, s63
  s_mul_i32 s80, s80, 145
  s_lshl1_add_u32 s80, s62, s80
  s_lshl_b32 s80, s80, 10
  s_lshl_b32 s84, s64, 10
  s_add_u32 s14, s52, 9830400
  s_addc_u32 s15, s53, 0
  v_lshl_add_u32 v26, v22, 2, v23
  s_lshl_b32 s79, s63, 11
  v_lshl_add_u32 v26, v26, 7, s79
  v_lshlrev_b32 v24, 3, v24
  v_xad_u32 v8, v24, v25, v26
  v_xor_b32 v9, 64, v8
  s_lshr_b32 s79, s2, 3
  s_lshr_b32 s12, s95, 1
  s_add_u32 s12, s12, 24
  s_cmp_lt_u32 s79, 24
  s_cselect_b32 s79, s79, s12
  s_and_b32 s12, s79, 3
  s_lshr_b32 s79, s79, 2
  s_lshl_b32 s82, s79, 7
  v_add_u32 v4, s82, v4
  s_and_b32 s79, s2, 7
  s_waitcnt vmcnt(4)
  s_barrier
  v_add_u32 v14, 65536, v7
  ds_read_b128 v[136:139], v10 offset:0
  ds_read_b128 v[140:143], v11 offset:0
  ds_read_b64_tr_b16 v[48:49], v14 offset:0
  ds_read_b64_tr_b16 v[50:51], v14 offset:512
  ds_read_b128 v[144:147], v12 offset:0
  ds_read_b128 v[148:151], v13 offset:0
  ds_read_b64_tr_b16 v[56:57], v14 offset:2048
  ds_read_b64_tr_b16 v[58:59], v14 offset:2560
  s_waitcnt lgkmcnt(4)
  v_mfma_f32_32x32x16_bf16 v[72:87], v[48:51], v[136:139], 0
  s_add_u32 m0, s61, 32768
  ds_read_b64_tr_b16 v[64:65], v14 offset:4096
  ds_read_b64_tr_b16 v[66:67], v14 offset:4608
  buffer_load_dwordx4 v1, s[16:19], s70 offen lds
  s_add_u32 m0, s61, 40960
  s_add_u32 s76, s70, 57344
  buffer_load_dwordx4 v1, s[16:19], s76 offen lds
  s_lshl2_add_u32 s79, s79, s12
  s_mul_i32 s86, s79, 57344
  s_add_u32 s86, s86, s82
  s_lshr_b32 s85, s79, 1
  s_waitcnt lgkmcnt(2)
  v_mfma_f32_32x32x16_bf16 v[72:87], v[56:59], v[140:143], v[72:87]
  s_add_u32 m0, s61, 90112
  ds_read_b64_tr_b16 v[48:49], v14 offset:6144
  ds_read_b64_tr_b16 v[50:51], v14 offset:6656
  s_mul_i32 s6, s70, 1344
  buffer_load_dwordx4 v3, s[20:23], s6 offen lds
  s_lshl_b32 s85, s85, 10
  s_lshl1_add_u32 s79, s79, s62
  s_lshl_b32 s96, s79, 7
  s_add_u32 s96, s96, 9764864
  s_mul_i32 s81, s79, 145
  s_add_u32 s81, s81, s63
  s_lshl_b32 s81, s81, 10
  s_waitcnt vmcnt(4)
  s_barrier
  s_waitcnt lgkmcnt(2)
  v_mfma_f32_32x32x16_bf16 v[72:87], v[64:67], v[144:147], v[72:87]
  s_add_u32 m0, s61, 0
  v_add_u32 v14, 73728, v7
  ds_read_b128 v[152:155], v10 offset:16384
  ds_read_b128 v[156:159], v11 offset:16384
  ds_read_b64_tr_b16 v[56:57], v14 offset:0
  ds_read_b64_tr_b16 v[58:59], v14 offset:512
  buffer_load_dwordx4 v1, s[16:19], s71 offen lds
  s_add_u32 m0, s61, 8192
  s_add_u32 s76, s71, 57344
  buffer_load_dwordx4 v1, s[16:19], s76 offen lds
  v_add_u32 v16, s81, v5
  s_lshl_b32 s92, s65, 7
  s_add_u32 s92, s92, 16384
  s_lshl_b32 s94, s65, 17
  s_waitcnt lgkmcnt(4)
  v_mfma_f32_32x32x16_bf16 v[72:87], v[48:51], v[148:151], v[72:87]
  s_add_u32 m0, s61, 98304
  ds_read_b128 v[160:163], v12 offset:16384
  ds_read_b128 v[164:167], v13 offset:16384
  ds_read_b64_tr_b16 v[64:65], v14 offset:2048
  ds_read_b64_tr_b16 v[66:67], v14 offset:2560
  s_mul_i32 s7, s71, 1344
  buffer_load_dwordx4 v3, s[20:23], s7 offen lds
  s_add_u32 s94, s94, 10485760
  v_lshrrev_b32 v22, 5, v0
  v_bfe_u32 v23, v0, 2, 2
  v_xor_b32 v24, v22, v23
  v_bfe_u32 v25, v0, 1, 1
  v_lshl_or_b32 v24, v25, 3, v24
  v_and_b32 v25, 31, v0
  s_waitcnt lgkmcnt(4)
  v_mfma_f32_32x32x16_bf16 v[72:87], v[56:59], v[152:155], v[72:87]
  s_add_u32 m0, s61, 49152
  ds_read_b64_tr_b16 v[48:49], v14 offset:4096
  ds_read_b64_tr_b16 v[50:51], v14 offset:4608
  buffer_load_dwordx4 v1, s[16:19], s72 offen lds
  v_lshl_or_b32 v24, v25, 4, v24
  v_lshlrev_b32 v24, 3, v24
  s_lshl_b32 s79, s61, 2
  v_add_u32 v19, s79, v24
  v_lshl_add_u32 v24, v22, 2, v23
  v_and_b32 v25, 3, v0
  v_xor_b32 v25, v25, v22
  s_waitcnt lgkmcnt(2)
  v_mfma_f32_32x32x16_bf16 v[72:87], v[64:67], v[156:159], v[72:87]
  s_add_u32 m0, s61, 57344
  ds_read_b64_tr_b16 v[56:57], v14 offset:6144
  ds_read_b64_tr_b16 v[58:59], v14 offset:6656
  s_add_u32 s76, s72, 57344
  buffer_load_dwordx4 v1, s[16:19], s76 offen lds
  v_bfe_u32 v22, v0, 4, 1
  v_and_b32 v23, 2, v23
  v_or_b32 v22, v22, v23
  v_xor_b32 v22, s63, v22
  v_lshl_or_b32 v25, v22, 2, v25
  v_lshl_or_b32 v25, v24, 4, v25
  v_lshlrev_b32 v25, 3, v25
  s_waitcnt vmcnt(5)
  s_barrier
  s_waitcnt lgkmcnt(2)
  v_mfma_f32_32x32x16_bf16 v[72:87], v[48:51], v[160:163], v[72:87]
  v_add_u32 v14, 90112, v7
  ds_read_b128 v[168:171], v10 offset:32768
  ds_read_b128 v[172:175], v11 offset:32768
  ds_read_b64_tr_b16 v[64:65], v14 offset:0
  ds_read_b64_tr_b16 v[66:67], v14 offset:512
  v_lshrrev_b32 v248, 5, v0
  v_bfe_u32 v249, v0, 2, 2
  v_lshl_add_u32 v248, v248, 2, v249
  v_mul_u32_u24 v248, 56, v248
  v_bfe_u32 v249, v0, 4, 1
  v_and_b32 v250, 3, v0
  v_lshl_add_u32 v249, v249, 2, v250
  v_min_u32 v249, 6, v249
  v_lshl_add_u32 v248, v249, 3, v248
  s_mul_i32 s77, s62, 1568
  v_add_u32 v248, s77, v248
  v_add_u32 v248, 81920, v248
  ds_read_b64_tr_b16 v[40:41], v248 offset:0
  ds_read_b64_tr_b16 v[42:43], v248 offset:448
  ds_read_b64_tr_b16 v[44:45], v248 offset:896
  ds_read_b64_tr_b16 v[46:47], v248 offset:1344
  s_add_u32 m0, s61, 65536
  s_mul_i32 s8, s72, 1344
  buffer_load_dwordx4 v3, s[20:23], s8 offen lds
  s_lshl_b32 s79, s62, 14
  v_add_u32 v17, s79, v25
  s_lshl_b32 s79, s62, 13
  v_add_u32 v18, s79, v5
  s_waitcnt lgkmcnt(8)
  v_mfma_f32_32x32x16_bf16 v[72:87], v[56:59], v[164:167], v[72:87]
  s_add_u32 m0, s61, 16384
  ds_read_b128 v[176:179], v12 offset:32768
  ds_read_b128 v[180:183], v13 offset:32768
  ds_read_b64_tr_b16 v[48:49], v14 offset:2048
  ds_read_b64_tr_b16 v[50:51], v14 offset:2560
  buffer_load_dwordx4 v1, s[16:19], s73 offen lds
  s_waitcnt lgkmcnt(8)
  v_mfma_f32_32x32x16_bf16 v[72:87], v[64:67], v[168:171], v[72:87]
  s_add_u32 m0, s61, 24576
  ds_read_b64_tr_b16 v[56:57], v14 offset:4096
  ds_read_b64_tr_b16 v[58:59], v14 offset:4608
  s_add_u32 s76, s73, 57344
  buffer_load_dwordx4 v1, s[16:19], s76 offen lds
  s_waitcnt lgkmcnt(2)
  v_mfma_f32_32x32x16_bf16 v[72:87], v[48:51], v[172:175], v[72:87]
  ds_read_b64_tr_b16 v[64:65], v14 offset:6144
  ds_read_b64_tr_b16 v[66:67], v14 offset:6656
  s_waitcnt vmcnt(5)
  s_barrier
  s_waitcnt lgkmcnt(2)
  v_mfma_f32_32x32x16_bf16 v[72:87], v[56:59], v[176:179], v[72:87]
  s_add_u32 m0, s61, 73728
  v_add_u32 v14, 98304, v7
  ds_read_b128 v[184:187], v10 offset:0
  ds_read_b128 v[188:191], v11 offset:0
  ds_read_b64_tr_b16 v[48:49], v14 offset:0
  ds_read_b64_tr_b16 v[50:51], v14 offset:512
  s_mul_i32 s9, s73, 1344
  buffer_load_dwordx4 v3, s[20:23], s9 offen lds
  s_waitcnt lgkmcnt(4)
  v_mfma_f32_32x32x16_bf16 v[72:87], v[64:67], v[180:183], v[72:87]
  s_add_u32 m0, s61, 32768
  ds_read_b128 v[192:195], v12 offset:0
  ds_read_b128 v[196:199], v13 offset:0
  ds_read_b64_tr_b16 v[56:57], v14 offset:2048
  ds_read_b64_tr_b16 v[58:59], v14 offset:2560
  buffer_load_dwordx4 v1, s[16:19], s74 offen lds
  s_waitcnt lgkmcnt(4)
  v_mfma_f32_32x32x16_bf16 v[72:87], v[48:51], v[184:187], v[72:87]
  s_add_u32 m0, s61, 40960
  ds_read_b64_tr_b16 v[64:65], v14 offset:4096
  ds_read_b64_tr_b16 v[66:67], v14 offset:4608
  s_add_u32 s76, s74, 57344
  buffer_load_dwordx4 v1, s[16:19], s76 offen lds
  s_waitcnt lgkmcnt(2)
  v_mfma_f32_32x32x16_bf16 v[72:87], v[56:59], v[188:191], v[72:87]
  ds_read_b64_tr_b16 v[48:49], v14 offset:6144
  ds_read_b64_tr_b16 v[50:51], v14 offset:6656
  s_waitcnt vmcnt(5)
  s_barrier
  s_waitcnt lgkmcnt(2)
  v_mfma_f32_32x32x16_bf16 v[72:87], v[64:67], v[192:195], v[72:87]
  s_add_u32 m0, s61, 155648
  v_add_u32 v14, 65536, v7
  ds_read_b128 v[200:203], v10 offset:49152
  ds_read_b128 v[204:207], v11 offset:49152
  ds_read_b64_tr_b16 v[56:57], v14 offset:0
  ds_read_b64_tr_b16 v[58:59], v14 offset:512
  s_mul_i32 s10, s74, 1344
  buffer_load_dwordx4 v3, s[20:23], s10 offen lds
  s_waitcnt lgkmcnt(4)
  v_mfma_f32_32x32x16_bf16 v[72:87], v[48:51], v[196:199], v[72:87]
  s_add_u32 m0, s61, 147456
  ds_read_b128 v[208:211], v12 offset:49152
  ds_read_b128 v[212:215], v13 offset:49152
  ds_read_b64_tr_b16 v[64:65], v14 offset:2048
  ds_read_b64_tr_b16 v[66:67], v14 offset:2560
  v_add_u32 v3, 896, v3
  s_mul_i32 s4, s68, 1344
  buffer_load_dwordx4 v3, s[20:23], s4 offen lds
  s_waitcnt lgkmcnt(4)
  v_mfma_f32_32x32x16_bf16 v[72:87], v[56:59], v[200:203], v[72:87]
  s_add_u32 m0, s61, 139264
  ds_read_b64_tr_b16 v[48:49], v14 offset:4096
  ds_read_b64_tr_b16 v[50:51], v14 offset:4608
  buffer_load_dwordx4 v3, s[20:23], s5 offen lds
  s_waitcnt lgkmcnt(2)
  v_mfma_f32_32x32x16_bf16 v[72:87], v[64:67], v[204:207], v[72:87]
  ds_read_b64_tr_b16 v[56:57], v14 offset:6144
  ds_read_b64_tr_b16 v[58:59], v14 offset:6656
  s_waitcnt vmcnt(5)
  s_barrier
  s_waitcnt lgkmcnt(2)
  v_mfma_f32_32x32x16_bf16 v[72:87], v[48:51], v[208:211], v[72:87]
  s_add_u32 m0, s61, 0
  v_add_u32 v14, 73728, v7
  ds_read_b128 v[216:219], v10 offset:16384
  ds_read_b128 v[220:223], v11 offset:16384
  ds_read_b64_tr_b16 v[64:65], v14 offset:0
  ds_read_b64_tr_b16 v[66:67], v14 offset:512
  buffer_load_dwordx4 v3, s[20:23], s6 offen lds
  s_waitcnt lgkmcnt(4)
  v_mfma_f32_32x32x16_bf16 v[72:87], v[56:59], v[212:215], v[72:87]
  ds_read_b128 v[224:227], v12 offset:16384
  ds_read_b128 v[228:231], v13 offset:16384
  ds_read_b64_tr_b16 v[48:49], v14 offset:2048
  ds_read_b64_tr_b16 v[50:51], v14 offset:2560
  s_waitcnt lgkmcnt(4)
  v_mfma_f32_32x32x16_bf16 v[72:87], v[64:67], v[216:219], v[72:87]
  s_add_u32 m0, s61, 8192
  ds_read_b64_tr_b16 v[56:57], v14 offset:4096
  ds_read_b64_tr_b16 v[58:59], v14 offset:4608
  buffer_load_dwordx4 v3, s[20:23], s7 offen lds
  s_waitcnt lgkmcnt(2)
  v_mfma_f32_32x32x16_bf16 v[72:87], v[48:51], v[220:223], v[72:87]
  ds_read_b64_tr_b16 v[64:65], v14 offset:6144
  ds_read_b64_tr_b16 v[66:67], v14 offset:6656
  s_waitcnt vmcnt(4)
  s_barrier
  s_waitcnt lgkmcnt(2)
  v_mfma_f32_32x32x16_bf16 v[72:87], v[56:59], v[224:227], v[72:87]
  v_add_u32 v14, 155648, v7
  ds_read_b128 v[232:235], v10 offset:32768
  ds_read_b128 v[236:239], v11 offset:32768
  ds_read_b64_tr_b16 v[48:49], v14 offset:0
  ds_read_b64_tr_b16 v[50:51], v14 offset:512
  s_cmp_lg_u32 s60, 0
  s_cbranch_scc1 Lpi_13
  buffer_load_dword v20, off, s[56:59], 0 sc1
Lpi_13:
  s_add_u32 m0, s61, 16384
  s_nop 0
  buffer_load_dwordx4 v3, s[20:23], s8 offen lds
  s_waitcnt lgkmcnt(4)
  v_mfma_f32_32x32x16_bf16 v[72:87], v[64:67], v[228:231], v[72:87]
  ds_read_b128 v[240:243], v12 offset:32768
  ds_read_b128 v[244:247], v13 offset:32768
  ds_read_b64_tr_b16 v[56:57], v14 offset:2048
  ds_read_b64_tr_b16 v[58:59], v14 offset:2560
  s_waitcnt lgkmcnt(4)
  v_mfma_f32_32x32x16_bf16 v[72:87], v[48:51], v[232:235], v[72:87]
  s_add_u32 m0, s61, 24576
  ds_read_b64_tr_b16 v[64:65], v14 offset:4096
  ds_read_b64_tr_b16 v[66:67], v14 offset:4608
  buffer_load_dwordx4 v3, s[20:23], s9 offen lds
  s_waitcnt lgkmcnt(2)
  v_mfma_f32_32x32x16_bf16 v[72:87], v[56:59], v[236:239], v[72:87]
  ds_read_b64_tr_b16 v[48:49], v14 offset:6144
  ds_read_b64_tr_b16 v[50:51], v14 offset:6656
  s_waitcnt vmcnt(2)
  s_barrier
  s_waitcnt lgkmcnt(2)
  v_mfma_f32_32x32x16_bf16 v[72:87], v[64:67], v[240:243], v[72:87]
  s_add_u32 m0, s61, 131072
  v_add_u32 v14, 147456, v7
  ds_read_b64_tr_b16 v[56:57], v14 offset:0
  ds_read_b64_tr_b16 v[58:59], v14 offset:512
  ds_read_b64_tr_b16 v[60:61], v14 offset:2048
  ds_read_b64_tr_b16 v[62:63], v14 offset:2560
  buffer_load_dwordx4 v3, s[20:23], s10 offen lds
  s_waitcnt lgkmcnt(4)
  v_mfma_f32_32x32x16_bf16 v[72:87], v[48:51], v[244:247], v[72:87]
  ds_read_b64_tr_b16 v[64:65], v14 offset:4096
  ds_read_b64_tr_b16 v[66:67], v14 offset:4608
  ds_read_b64_tr_b16 v[68:69], v14 offset:6144
  ds_read_b64_tr_b16 v[70:71], v14 offset:6656
  s_waitcnt lgkmcnt(4)
  v_mfma_f32_32x32x16_bf16 v[120:135], v[136:139], v[56:59], 0
  s_add_u32 m0, s61, 122880
  v_add_u32 v14, 139264, v7
  ds_read_b64_tr_b16 v[48:49], v14 offset:0
  ds_read_b64_tr_b16 v[50:51], v14 offset:512
  s_mul_i32 s4, s68, 1792
  buffer_load_dwordx4 v2, s[32:35], s4 offen lds
  v_mfma_f32_32x32x16_bf16 v[120:135], v[140:143], v[60:63], v[120:135]
  ds_read_b64_tr_b16 v[52:53], v14 offset:2048
  ds_read_b64_tr_b16 v[54:55], v14 offset:2560
  s_waitcnt lgkmcnt(4)
  v_mfma_f32_32x32x16_bf16 v[120:135], v[144:147], v[64:67], v[120:135]
  ds_read_b64_tr_b16 v[56:57], v14 offset:4096
  ds_read_b64_tr_b16 v[58:59], v14 offset:4608
  s_cmp_lg_u32 s60, 2
  s_cbranch_scc1 Lt_14
  v_lshlrev_b32 v253, 7, v0
  s_lshr_b32 s75, s2, 3
  s_lshr_b32 s76, s95, 1
  s_add_u32 s76, s76, 24
  s_min_u32 s76, s76, s75
  s_and_b32 s75, s2, 7
  s_lshl3_add_u32 s76, s76, s75
  s_mul_i32 s75, s76, 12544
  s_bfm_b64 exec, 49, 0
  buffer_load_dword v20, v253, s[40:43], s75 offen
  s_add_u32 s75, s75, 6272
  buffer_load_dword v20, v253, s[40:43], s75 offen
  s_mul_i32 s75, s76, 3200
  s_bfm_b64 exec, 25, 0
  buffer_load_dword v20, v253, s[28:31], s75 offen
  s_mov_b64 exec, -1
Lt_14:
  v_cvt_pk_bf16_f32 v22, v72, v73
  v_cvt_pk_bf16_f32 v23, v74, v75
  v_mfma_f32_32x32x16_bf16 v[120:135], v[148:151], v[68:71], v[120:135]
  ds_read_b64_tr_b16 v[60:61], v14 offset:6144
  ds_read_b64_tr_b16 v[62:63], v14 offset:6656
  v_cvt_pk_bf16_f32 v24, v76, v77
  v_cvt_pk_bf16_f32 v25, v78, v79
  v_cvt_pk_bf16_f32 v26, v80, v81
  v_cvt_pk_bf16_f32 v27, v82, v83
  v_cvt_pk_bf16_f32 v28, v84, v85
  v_cvt_pk_bf16_f32 v29, v86, v87
  s_mov_b32 exec_lo, 0
  v_mov_b32 v46, 0
  v_mov_b32 v47, 0
  s_mov_b32 exec_lo, -1
  s_waitcnt lgkmcnt(4)
  v_mfma_f32_32x32x16_bf16 v[120:135], v[152:155], v[48:51], v[120:135]
  s_add_u32 m0, s61, 114688
  v_add_u32 v14, 0, v7
  ds_read_b64_tr_b16 v[64:65], v14 offset:0
  ds_read_b64_tr_b16 v[66:67], v14 offset:512
  buffer_load_dwordx4 v2, s[36:39], s4 offen lds
  v_mfma_f32_32x32x16_bf16 v[88:103], v[40:43], v[22:25], 0
  v_mfma_f32_32x32x16_bf16 v[88:103], v[44:47], v[26:29], v[88:103]
  v_bfe_i32 v36, v0, 5, 1
  v_and_b32 v36, 0xf149f2ca, v36
  v_mfma_f32_32x32x16_bf16 v[120:135], v[156:159], v[52:55], v[120:135]
  ds_read_b64_tr_b16 v[68:69], v14 offset:2048
  ds_read_b64_tr_b16 v[70:71], v14 offset:2560
  s_waitcnt lgkmcnt(4)
  v_mfma_f32_32x32x16_bf16 v[120:135], v[160:163], v[56:59], v[120:135]
  s_add_u32 m0, s61, 106496
  ds_read_b64_tr_b16 v[48:49], v14 offset:4096
  ds_read_b64_tr_b16 v[50:51], v14 offset:4608
  s_mul_i32 s5, s69, 1792
  buffer_load_dwordx4 v2, s[32:35], s5 offen lds
  v_max3_f32 v30, v88, v89, v90
  v_min3_f32 v31, v88, v89, v90
  v_max3_f32 v30, v30, v91, v92
  v_min3_f32 v31, v31, v91, v92
  v_max3_f32 v30, v30, v93, v94
  v_mfma_f32_32x32x16_bf16 v[120:135], v[164:167], v[60:63], v[120:135]
  ds_read_b64_tr_b16 v[52:53], v14 offset:6144
  ds_read_b64_tr_b16 v[54:55], v14 offset:6656
  v_min3_f32 v31, v31, v93, v94
  v_max3_f32 v30, v30, v95, v96
  v_min3_f32 v31, v31, v95, v96
  v_max3_f32 v30, v30, v97, v98
  v_min3_f32 v31, v31, v97, v98
  v_max3_f32 v30, v30, v99, v100
  v_min3_f32 v31, v31, v99, v100
  v_max3_f32 v30, v30, v101, v102
  v_min3_f32 v31, v31, v101, v102
  s_waitcnt lgkmcnt(4)
  v_mfma_f32_32x32x16_bf16 v[120:135], v[168:171], v[64:67], v[120:135]
  s_add_u32 m0, s61, 98304
  v_add_u32 v14, 8192, v7
  ds_read_b64_tr_b16 v[56:57], v14 offset:0
  ds_read_b64_tr_b16 v[58:59], v14 offset:512
  buffer_load_dwordx4 v2, s[36:39], s5 offen lds
  v_max_f32 v30, v30, v103
  v_min_f32 v31, v31, v103
  v_mov_b32 v32, v30
  v_mov_b32 v33, v31
  s_nop 0
  v_permlane32_swap_b32 v30, v32
  v_permlane32_swap_b32 v31, v33
  v_mfma_f32_32x32x16_bf16 v[120:135], v[172:175], v[68:71], v[120:135]
  ds_read_b64_tr_b16 v[60:61], v14 offset:2048
  ds_read_b64_tr_b16 v[62:63], v14 offset:2560
  v_max_f32 v30, v30, v32
  v_min_f32 v31, v31, v33
  v_mul_f32 v34, s90, v30
  v_mul_f32 v35, s88, v31
  v_add_f32 v37, v35, v36
  v_add_f32 v36, v34, v36
  v_fma_f32 v72, v88, s88, v34
  v_fma_f32 v73, v89, s88, v34
  v_fma_f32 v88, v88, s90, v35
  s_waitcnt lgkmcnt(4)
  v_mfma_f32_32x32x16_bf16 v[120:135], v[176:179], v[48:51], v[120:135]
  s_add_u32 m0, s61, 90112
  ds_read_b64_tr_b16 v[64:65], v14 offset:4096
  ds_read_b64_tr_b16 v[66:67], v14 offset:4608
  s_mul_i32 s6, s70, 1792
  buffer_load_dwordx4 v2, s[32:35], s6 offen lds
  v_fma_f32 v89, v89, s90, v35
  v_fma_f32 v74, v90, s88, v34
  v_fma_f32 v75, v91, s88, v34
  v_fma_f32 v90, v90, s90, v35
  v_fma_f32 v91, v91, s90, v35
  v_fma_f32 v76, v92, s88, v34
  v_mfma_f32_32x32x16_bf16 v[120:135], v[180:183], v[52:55], v[120:135]
  ds_read_b64_tr_b16 v[68:69], v14 offset:6144
  ds_read_b64_tr_b16 v[70:71], v14 offset:6656
  v_fma_f32 v77, v93, s88, v34
  v_fma_f32 v92, v92, s90, v35
  v_fma_f32 v93, v93, s90, v35
  v_fma_f32 v78, v94, s88, v34
  v_fma_f32 v79, v95, s88, v34
  v_fma_f32 v94, v94, s90, v35
  v_fma_f32 v95, v95, s90, v35
  v_fma_f32 v80, v96, s88, v34
  v_fma_f32 v81, v97, s88, v34
  s_cmp_lg_u32 s60, 0
  s_cbranch_scc1 Lpc_15
  s_waitcnt vmcnt(8)
  v_readfirstlane_b32 s13, v20
  s_nop 0
  s_cmp_ge_u32 s13, 1
  s_cbranch_scc1 Lpc_15
  s_mov_b32 s93, 0
Lsp_16:
  buffer_load_dword v20, off, s[56:59], 0 sc1
  s_add_u32 s93, s93, 1
  s_waitcnt vmcnt(0)
  v_readfirstlane_b32 s13, v20
  s_nop 0
  s_cmp_ge_u32 s13, 1
  s_cbranch_scc1 Lpc_15
  s_cmp_lt_u32 s93, 20000
  s_cbranch_scc1 Lsp_16
Lpc_15:
  s_waitcnt vmcnt(5)
  s_barrier
  s_waitcnt lgkmcnt(4)
  v_mfma_f32_32x32x16_bf16 v[120:135], v[184:187], v[56:59], v[120:135]
  s_add_u32 m0, s61, 155648
  v_add_u32 v14, 16384, v7
  ds_read_b64_tr_b16 v[48:49], v14 offset:0
  ds_read_b64_tr_b16 v[50:51], v14 offset:512
  buffer_load_dwordx4 v2, s[36:39], s6 offen lds
  v_fma_f32 v96, v96, s90, v35
  v_fma_f32 v97, v97, s90, v35
  v_fma_f32 v82, v98, s88, v34
  v_fma_f32 v83, v99, s88, v34
  v_fma_f32 v98, v98, s90, v35
  v_fma_f32 v99, v99, s90, v35
  v_mfma_f32_32x32x16_bf16 v[120:135], v[188:191], v[60:63], v[120:135]
  ds_read_b64_tr_b16 v[52:53], v14 offset:2048
  ds_read_b64_tr_b16 v[54:55], v14 offset:2560
  v_fma_f32 v84, v100, s88, v36
  v_fma_f32 v85, v101, s88, v36
  v_fma_f32 v100, v100, s90, v37
  v_fma_f32 v101, v101, s90, v37
  v_fma_f32 v86, v102, s88, v36
  v_fma_f32 v87, v103, s88, v36
  v_fma_f32 v102, v102, s90, v37
  v_fma_f32 v103, v103, s90, v37
  s_waitcnt lgkmcnt(4)
  v_mfma_f32_32x32x16_bf16 v[120:135], v[192:195], v[64:67], v[120:135]
  s_add_u32 m0, s61, 147456
  ds_read_b64_tr_b16 v[56:57], v14 offset:4096
  ds_read_b64_tr_b16 v[58:59], v14 offset:4608
  s_mul_i32 s7, s71, 1792
  buffer_load_dwordx4 v2, s[32:35], s7 offen lds
  v_exp_f32 v72, v72
  v_exp_f32 v88, v88
  v_exp_f32 v73, v73
  v_mfma_f32_32x32x16_bf16 v[120:135], v[196:199], v[68:71], v[120:135]
  ds_read_b64_tr_b16 v[60:61], v14 offset:6144
  ds_read_b64_tr_b16 v[62:63], v14 offset:6656
  v_exp_f32 v89, v89
  v_exp_f32 v74, v74
  v_exp_f32 v90, v90
  v_exp_f32 v75, v75
  s_waitcnt lgkmcnt(4)
  v_mfma_f32_32x32x16_bf16 v[120:135], v[200:203], v[48:51], v[120:135]
  s_add_u32 m0, s61, 139264
  v_add_u32 v14, 24576, v7
  ds_read_b64_tr_b16 v[64:65], v14 offset:0
  ds_read_b64_tr_b16 v[66:67], v14 offset:512
  buffer_load_dwordx4 v2, s[36:39], s7 offen lds
  v_exp_f32 v91, v91
  v_exp_f32 v76, v76
  v_exp_f32 v92, v92
  v_mfma_f32_32x32x16_bf16 v[120:135], v[204:207], v[52:55], v[120:135]
  ds_read_b64_tr_b16 v[68:69], v14 offset:2048
  ds_read_b64_tr_b16 v[70:71], v14 offset:2560
  v_exp_f32 v77, v77
  v_exp_f32 v93, v93
  v_exp_f32 v78, v78
  v_exp_f32 v94, v94
  s_waitcnt lgkmcnt(4)
  v_mfma_f32_32x32x16_bf16 v[120:135], v[208:211], v[56:59], v[120:135]
  s_add_u32 m0, s61, 81920
  ds_read_b64_tr_b16 v[48:49], v14 offset:4096
  ds_read_b64_tr_b16 v[50:51], v14 offset:4608
  s_mul_i32 s8, s72, 1792
  buffer_load_dwordx4 v2, s[32:35], s8 offen lds
  v_exp_f32 v79, v79
  v_exp_f32 v95, v95
  v_exp_f32 v80, v80
  v_mfma_f32_32x32x16_bf16 v[120:135], v[212:215], v[60:63], v[120:135]
  ds_read_b64_tr_b16 v[52:53], v14 offset:6144
  ds_read_b64_tr_b16 v[54:55], v14 offset:6656
  v_exp_f32 v96, v96
  v_exp_f32 v81, v81
  v_exp_f32 v97, v97
  v_exp_f32 v82, v82
  s_waitcnt lgkmcnt(4)
  v_mfma_f32_32x32x16_bf16 v[120:135], v[216:219], v[64:67], v[120:135]
  s_add_u32 m0, s61, 73728
  v_add_u32 v14, 131072, v7
  ds_read_b64_tr_b16 v[56:57], v14 offset:0
  ds_read_b64_tr_b16 v[58:59], v14 offset:512
  buffer_load_dwordx4 v2, s[36:39], s8 offen lds
  v_exp_f32 v98, v98
  v_exp_f32 v83, v83
  v_exp_f32 v99, v99
  v_mfma_f32_32x32x16_bf16 v[120:135], v[220:223], v[68:71], v[120:135]
  ds_read_b64_tr_b16 v[60:61], v14 offset:2048
  ds_read_b64_tr_b16 v[62:63], v14 offset:2560
  v_exp_f32 v84, v84
  v_exp_f32 v100, v100
  v_exp_f32 v85, v85
  v_exp_f32 v101, v101
  s_waitcnt lgkmcnt(4)
  v_mfma_f32_32x32x16_bf16 v[120:135], v[224:227], v[48:51], v[120:135]
  s_add_u32 m0, s61, 65536
  ds_read_b64_tr_b16 v[64:65], v14 offset:4096
  ds_read_b64_tr_b16 v[66:67], v14 offset:4608
  s_mul_i32 s9, s73, 1792
  buffer_load_dwordx4 v2, s[32:35], s9 offen lds
  v_exp_f32 v86, v86
  v_exp_f32 v102, v102
  v_exp_f32 v87, v87
  v_mfma_f32_32x32x16_bf16 v[120:135], v[228:231], v[52:55], v[120:135]
  ds_read_b64_tr_b16 v[68:69], v14 offset:6144
  ds_read_b64_tr_b16 v[70:71], v14 offset:6656
  v_exp_f32 v103, v103
  v_add_f32 v22, v74, v72
  v_add_f32 v23, v75, v73
  v_add_f32 v24, v90, v88
  v_add_f32 v25, v91, v89
  v_add_f32 v22, v76, v22
  v_add_f32 v23, v77, v23
  v_add_f32 v24, v92, v24
  s_waitcnt vmcnt(9)
  s_barrier
  s_waitcnt lgkmcnt(4)
  v_mfma_f32_32x32x16_bf16 v[120:135], v[232:235], v[56:59], v[120:135]
  s_add_u32 m0, s61, 57344
  v_add_u32 v14, 122880, v6
  ds_read_b64_tr_b16 v[48:49], v14 offset:0
  ds_read_b64_tr_b16 v[50:51], v14 offset:512
  buffer_load_dwordx4 v2, s[36:39], s9 offen lds
  v_add_f32 v25, v93, v25
  v_add_f32 v22, v78, v22
  v_add_f32 v23, v79, v23
  v_add_f32 v24, v94, v24
  v_add_f32 v25, v95, v25
  v_add_f32 v22, v80, v22
  v_mfma_f32_32x32x16_bf16 v[120:135], v[236:239], v[60:63], v[120:135]
  v_add_u32 v15, 114688, v6
  ds_read_b64_tr_b16 v[52:53], v15 offset:0
  ds_read_b64_tr_b16 v[54:55], v15 offset:512
  v_add_f32 v23, v81, v23
  v_add_f32 v24, v96, v24
  v_add_f32 v25, v97, v25
  v_add_f32 v22, v82, v22
  v_add_f32 v23, v83, v23
  v_add_f32 v24, v98, v24
  v_add_f32 v25, v99, v25
  v_add_f32 v22, v84, v22
  v_add_f32 v23, v85, v23
  s_waitcnt lgkmcnt(4)
  v_mfma_f32_32x32x16_bf16 v[120:135], v[240:243], v[64:67], v[120:135]
  ds_read_b64_tr_b16 v[56:57], v14 offset:2048
  ds_read_b64_tr_b16 v[58:59], v14 offset:2560
  v_add_f32 v24, v100, v24
  v_add_f32 v25, v101, v25
  v_add_f32 v22, v86, v22
  v_add_f32 v23, v87, v23
  v_add_f32 v24, v102, v24
  v_add_f32 v25, v103, v25
  v_add_f32 v22, v22, v23
  v_add_f32 v24, v24, v25
  v_mov_b32 v23, v22
  v_mfma_f32_32x32x16_bf16 v[120:135], v[244:247], v[68:71], v[120:135]
  ds_read_b64_tr_b16 v[60:61], v15 offset:2048
  ds_read_b64_tr_b16 v[62:63], v15 offset:2560
  v_mov_b32 v25, v24
  v_permlane32_swap_b32 v22, v23
  s_nop 0
  v_permlane32_swap_b32 v24, v25
  v_add_f32 v22, v22, v23
  v_add_f32 v24, v24, v25
  v_rcp_f32 v22, v22
  v_rcp_f32 v24, v24
  s_lshl_b32 s77, s61, 1
  v_add_u32 v248, s77, v5
  v_mul_f32 v72, v22, v72
  v_mul_f32 v73, v22, v73
  v_mul_f32 v88, v24, v88
  v_mul_f32 v89, v24, v89
  v_mul_f32 v74, v22, v74
  v_mul_f32 v75, v22, v75
  v_mul_f32 v90, v24, v90
  v_mul_f32 v91, v24, v91
  v_mul_f32 v76, v22, v76
  v_mul_f32 v77, v22, v77
  v_mul_f32 v92, v24, v92
  v_cvt_pk_bf16_f32 v120, v120, v121
  v_cvt_pk_bf16_f32 v121, v122, v123
  v_cvt_pk_bf16_f32 v122, v124, v125
  v_cvt_pk_bf16_f32 v123, v126, v127
  v_cvt_pk_bf16_f32 v124, v128, v129
  v_cvt_pk_bf16_f32 v125, v130, v131
  v_cvt_pk_bf16_f32 v126, v132, v133
  v_cvt_pk_bf16_f32 v127, v134, v135
  s_mov_b32 exec_lo, 0x10000000
  s_mov_b32 exec_hi, 0x10000000
  v_mov_b32 v120, 0x3f803f80
  v_mov_b32 v121, 0x3f803f80
  v_mov_b32 v122, 0x3f803f80
  v_mov_b32 v123, 0x3f803f80
  v_mov_b32 v124, 0x3f803f80
  v_mov_b32 v125, 0x3f803f80
  v_mov_b32 v126, 0x3f803f80
  v_mov_b32 v127, 0x3f803f80
  s_mov_b64 exec, -1
  ds_write_b128 v248, v[120:123] offset:32768
  ds_write_b128 v248, v[124:127] offset:33792
  s_waitcnt lgkmcnt(6)
  v_mfma_f32_32x32x16_bf16 v[104:119], v[48:51], v[136:139], 0
  s_add_u32 m0, s61, 49152
  ds_read_b64_tr_b16 v[64:65], v14 offset:4096
  ds_read_b64_tr_b16 v[66:67], v14 offset:4608
  s_mul_i32 s10, s74, 1792
  buffer_load_dwordx4 v2, s[32:35], s10 offen lds
  v_mul_f32 v93, v24, v93
  v_mul_f32 v78, v22, v78
  v_mul_f32 v79, v22, v79
  v_mul_f32 v94, v24, v94
  v_mul_f32 v95, v24, v95
  v_mul_f32 v80, v22, v80
  v_mfma_f32_32x32x16_bf16 v[120:135], v[52:55], v[136:139], 0
  ds_read_b64_tr_b16 v[68:69], v15 offset:4096
  ds_read_b64_tr_b16 v[70:71], v15 offset:4608
  v_mul_f32 v81, v22, v81
  v_mul_f32 v96, v24, v96
  v_mul_f32 v97, v24, v97
  v_mul_f32 v82, v22, v82
  v_mul_f32 v83, v22, v83
  v_mul_f32 v98, v24, v98
  v_mul_f32 v99, v24, v99
  v_mul_f32 v84, v22, v84
  v_mul_f32 v85, v22, v85
  s_waitcnt lgkmcnt(6)
  v_mfma_f32_32x32x16_bf16 v[104:119], v[56:59], v[140:143], v[104:119]
  ds_read_b64_tr_b16 v[48:49], v14 offset:6144
  ds_read_b64_tr_b16 v[50:51], v14 offset:6656
  v_mul_f32 v100, v24, v100
  v_mul_f32 v101, v24, v101
  v_mul_f32 v86, v22, v86
  v_mul_f32 v87, v22, v87
  v_mul_f32 v102, v24, v102
  v_mul_f32 v103, v24, v103
  v_cvt_pk_bf16_f32 v88, v88, v89
  v_cvt_pk_bf16_f32 v89, v90, v91
  v_cvt_pk_bf16_f32 v90, v92, v93
  v_mfma_f32_32x32x16_bf16 v[120:135], v[60:63], v[140:143], v[120:135]
  ds_read_b64_tr_b16 v[52:53], v15 offset:6144
  ds_read_b64_tr_b16 v[54:55], v15 offset:6656
  v_cvt_pk_bf16_f32 v91, v94, v95
  v_cvt_pk_bf16_f32 v92, v96, v97
  v_cvt_pk_bf16_f32 v93, v98, v99
  v_cvt_pk_bf16_f32 v94, v100, v101
  v_cvt_pk_bf16_f32 v95, v102, v103
  v_cvt_pk_bf16_f32 v96, v72, v73
  v_cvt_pk_bf16_f32 v97, v74, v75
  v_cvt_pk_bf16_f32 v98, v76, v77
  v_cvt_pk_bf16_f32 v99, v78, v79
  v_cvt_pk_bf16_f32 v100, v80, v81
  v_cvt_pk_bf16_f32 v101, v82, v83
  v_cvt_pk_bf16_f32 v102, v84, v85
  v_cvt_pk_bf16_f32 v103, v86, v87
  v_xor_b32 v30, 16, v19
  v_xor_b32 v31, 64, v19
  v_xor_b32 v32, 0x50, v19
  ds_write_b64 v19, v[96:97] offset:0
  ds_write_b64 v30, v[98:99] offset:0
  ds_write_b64 v19, v[100:101] offset:32
  s_waitcnt lgkmcnt(12)
  ds_write_b64 v30, v[102:103] offset:32
  s_waitcnt lgkmcnt(12)
  ds_write_b64 v31, v[88:89] offset:0
  s_waitcnt lgkmcnt(12)
  ds_write_b64 v32, v[90:91] offset:0
  s_waitcnt lgkmcnt(12)
  ds_write_b64 v31, v[92:93] offset:32
  s_waitcnt lgkmcnt(12)
  ds_write_b64 v32, v[94:95] offset:32
  v_xor_b32 v19, 16, v17
  s_waitcnt lgkmcnt(0)
  s_barrier
  v_mfma_f32_32x32x16_bf16 v[104:119], v[64:67], v[144:147], v[104:119]
  s_add_u32 m0, s61, 131072
  ds_read_b64_tr_b16 v[56:57], v17 offset:0
  ds_read_b64_tr_b16 v[58:59], v19 offset:1024
  ds_read_b128 v[60:63], v18 offset:32768
  buffer_load_dwordx4 v2, s[36:39], s10 offen lds
  v_mfma_f32_32x32x16_bf16 v[120:135], v[68:71], v[144:147], v[120:135]
  v_mfma_f32_32x32x16_bf16 v[104:119], v[48:51], v[148:151], v[104:119]
  ds_read_b64_tr_b16 v[64:65], v17 offset:2048
  ds_read_b64_tr_b16 v[66:67], v19 offset:3072
  ds_read_b128 v[68:71], v18 offset:33792
  v_mfma_f32_32x32x16_bf16 v[120:135], v[52:55], v[148:151], v[120:135]
  s_add_u32 m0, s61, 114688
  s_mov_b32 s75, 0
  buffer_load_dwordx4 v4, s[40:43], s75 offen lds
  s_waitcnt lgkmcnt(3)
  v_mfma_f32_32x32x16_bf16 v[72:87], v[56:59], v[60:63], 0
  ds_read_b64_tr_b16 v[48:49], v17 offset:4096
  ds_read_b64_tr_b16 v[50:51], v19 offset:5120
  ds_read_b128 v[52:55], v18 offset:34816
  s_waitcnt lgkmcnt(3)
  v_mfma_f32_32x32x16_bf16 v[72:87], v[64:67], v[68:71], v[72:87]
  ds_read_b64_tr_b16 v[56:57], v17 offset:6144
  ds_read_b64_tr_b16 v[58:59], v19 offset:7168
  ds_read_b128 v[60:63], v18 offset:35840
  s_waitcnt lgkmcnt(3)
  v_mfma_f32_32x32x16_bf16 v[72:87], v[48:51], v[52:55], v[72:87]
  s_add_u32 m0, s61, 122880
  ds_read_b64_tr_b16 v[64:65], v17 offset:8192
  ds_read_b64_tr_b16 v[66:67], v19 offset:9216
  ds_read_b128 v[68:71], v18 offset:36864
  s_mov_b32 s75, 57344
  buffer_load_dwordx4 v4, s[40:43], s75 offen lds
  s_waitcnt lgkmcnt(3)
  v_mfma_f32_32x32x16_bf16 v[72:87], v[56:59], v[60:63], v[72:87]
  ds_read_b64_tr_b16 v[48:49], v17 offset:10240
  ds_read_b64_tr_b16 v[50:51], v19 offset:11264
  ds_read_b128 v[52:55], v18 offset:37888
  s_waitcnt lgkmcnt(3)
  v_mfma_f32_32x32x16_bf16 v[72:87], v[64:67], v[68:71], v[72:87]
  ds_read_b64_tr_b16 v[56:57], v17 offset:12288
  ds_read_b64_tr_b16 v[58:59], v19 offset:13312
  ds_read_b128 v[60:63], v18 offset:38912
  s_waitcnt lgkmcnt(3)
  v_mfma_f32_32x32x16_bf16 v[72:87], v[48:51], v[52:55], v[72:87]
  ds_read_b64_tr_b16 v[64:65], v17 offset:14336
  ds_read_b64_tr_b16 v[66:67], v19 offset:15360
  ds_read_b128 v[68:71], v18 offset:39936
  s_waitcnt vmcnt(12)
  s_barrier
  s_waitcnt lgkmcnt(3)
  v_mfma_f32_32x32x16_bf16 v[72:87], v[56:59], v[60:63], v[72:87]
  v_add_u32 v14, 106496, v6
  ds_read_b64_tr_b16 v[48:49], v14 offset:0
  ds_read_b64_tr_b16 v[50:51], v14 offset:512
  v_add_u32 v15, 98304, v6
  ds_read_b64_tr_b16 v[52:53], v15 offset:0
  ds_read_b64_tr_b16 v[54:55], v15 offset:512
  s_waitcnt lgkmcnt(4)
  v_mfma_f32_32x32x16_bf16 v[72:87], v[64:67], v[68:71], v[72:87]
  ds_read_b64_tr_b16 v[56:57], v14 offset:2048
  ds_read_b64_tr_b16 v[58:59], v14 offset:2560
  ds_read_b64_tr_b16 v[60:61], v15 offset:2048
  ds_read_b64_tr_b16 v[62:63], v15 offset:2560
  s_nop 7
  v_cvt_pk_bf16_f32 v22, v72, v73
  v_cvt_pk_bf16_f32 v23, v74, v75
  v_cvt_pk_bf16_f32 v24, v76, v77
  v_cvt_pk_bf16_f32 v25, v78, v79
  s_lshl_b32 s77, s64, 13
  s_add_u32 s77, s77, s94
  s_add_u32 s77, s77, s61
  buffer_store_dwordx4 v[22:25], v5, s[52:55], s77 offen sc1
  s_waitcnt lgkmcnt(4)
  v_mfma_f32_32x32x16_bf16 v[104:119], v[48:51], v[152:155], v[104:119]
  ds_read_b64_tr_b16 v[64:65], v14 offset:4096
  ds_read_b64_tr_b16 v[66:67], v14 offset:4608
  s_lshl_b32 s79, s64, 9
  s_add_u32 s89, s79, s94
  s_lshl_b32 s91, s65, 13
  s_add_u32 s91, s91, s79
  s_add_u32 s91, s91, 9699328
  v_mfma_f32_32x32x16_bf16 v[120:135], v[52:55], v[152:155], v[120:135]
  ds_read_b64_tr_b16 v[68:69], v15 offset:4096
  ds_read_b64_tr_b16 v[70:71], v15 offset:4608
  v_and_b32 v12, 15, v0
  s_lshl_b32 s79, s60, 4
  v_add_lshl_u32 v12, v12, s79, 2
  v_lshrrev_b32 v13, 4, v0
  v_lshl_add_u32 v1, v13, 13, v12
  s_waitcnt lgkmcnt(4)
  v_mfma_f32_32x32x16_bf16 v[104:119], v[56:59], v[156:159], v[104:119]
  ds_read_b64_tr_b16 v[48:49], v14 offset:6144
  ds_read_b64_tr_b16 v[50:51], v14 offset:6656
  v_mov_b32 v21, 0x3f80
  v_mov_b32 v251, 0x3f800000
  v_mfma_f32_32x32x16_bf16 v[120:135], v[60:63], v[156:159], v[120:135]
  ds_read_b64_tr_b16 v[52:53], v15 offset:6144
  ds_read_b64_tr_b16 v[54:55], v15 offset:6656
  s_waitcnt vmcnt(11)
  s_barrier
  s_waitcnt lgkmcnt(4)
  v_mfma_f32_32x32x16_bf16 v[104:119], v[64:67], v[160:163], v[104:119]
  s_add_u32 m0, s61, 0
  v_add_u32 v14, 90112, v6
  ds_read_b64_tr_b16 v[56:57], v14 offset:0
  ds_read_b64_tr_b16 v[58:59], v14 offset:512
  s_mov_b32 s75, 114688
  buffer_load_dwordx4 v4, s[40:43], s75 offen lds
  v_mfma_f32_32x32x16_bf16 v[120:135], v[68:71], v[160:163], v[120:135]
  s_add_u32 m0, s61, 8192
  v_add_u32 v15, 155648, v6
  ds_read_b64_tr_b16 v[60:61], v15 offset:0
  ds_read_b64_tr_b16 v[62:63], v15 offset:512
  s_mov_b32 s75, 172032
  buffer_load_dwordx4 v4, s[40:43], s75 offen lds
  s_waitcnt lgkmcnt(4)
  v_mfma_f32_32x32x16_bf16 v[104:119], v[48:51], v[164:167], v[104:119]
  s_add_u32 m0, s61, 16384
  ds_read_b64_tr_b16 v[64:65], v14 offset:2048
  ds_read_b64_tr_b16 v[66:67], v14 offset:2560
  s_mov_b32 s75, 229376
  buffer_load_dwordx4 v4, s[40:43], s75 offen lds
  v_mfma_f32_32x32x16_bf16 v[120:135], v[52:55], v[164:167], v[120:135]
  ds_read_b64_tr_b16 v[68:69], v15 offset:2048
  ds_read_b64_tr_b16 v[70:71], v15 offset:2560
  s_waitcnt lgkmcnt(4)
  v_mfma_f32_32x32x16_bf16 v[104:119], v[56:59], v[168:171], v[104:119]
  s_add_u32 m0, s61, 24576
  ds_read_b64_tr_b16 v[48:49], v14 offset:4096
  ds_read_b64_tr_b16 v[50:51], v14 offset:4608
  s_mov_b32 s75, 286720
  buffer_load_dwordx4 v4, s[40:43], s75 offen lds
  v_mfma_f32_32x32x16_bf16 v[120:135], v[60:63], v[168:171], v[120:135]
  s_add_u32 m0, s61, 32768
  ds_read_b64_tr_b16 v[52:53], v15 offset:4096
  ds_read_b64_tr_b16 v[54:55], v15 offset:4608
  s_mov_b32 s75, 344064
  buffer_load_dwordx4 v4, s[40:43], s75 offen lds
  s_waitcnt lgkmcnt(4)
  v_mfma_f32_32x32x16_bf16 v[104:119], v[64:67], v[172:175], v[104:119]
  s_add_u32 m0, s61, 40960
  ds_read_b64_tr_b16 v[56:57], v14 offset:6144
  ds_read_b64_tr_b16 v[58:59], v14 offset:6656
  s_mov_b32 s75, 401408
  buffer_load_dwordx4 v4, s[40:43], s75 offen lds
  v_mfma_f32_32x32x16_bf16 v[120:135], v[68:71], v[172:175], v[120:135]
  ds_read_b64_tr_b16 v[60:61], v15 offset:6144
  ds_read_b64_tr_b16 v[62:63], v15 offset:6656
  s_waitcnt vmcnt(6)
  s_barrier
  s_cmp_lg_u32 s60, 1
  s_cbranch_scc1 Lsig_17
  s_atomic_add s87, s[14:15], s92 offset:0
Lsig_17:
  s_waitcnt lgkmcnt(4)
  v_mfma_f32_32x32x16_bf16 v[104:119], v[48:51], v[176:179], v[104:119]
  s_add_u32 m0, s61, 106496
  v_add_u32 v14, 147456, v6
  ds_read_b64_tr_b16 v[64:65], v14 offset:0
  ds_read_b64_tr_b16 v[66:67], v14 offset:512
  s_mov_b32 s75, 458752
  buffer_load_dwordx4 v4, s[40:43], s75 offen lds
  v_mfma_f32_32x32x16_bf16 v[120:135], v[52:55], v[176:179], v[120:135]
  v_add_u32 v15, 139264, v6
  ds_read_b64_tr_b16 v[68:69], v15 offset:0
  ds_read_b64_tr_b16 v[70:71], v15 offset:512
  s_waitcnt lgkmcnt(4)
  v_mfma_f32_32x32x16_bf16 v[104:119], v[56:59], v[180:183], v[104:119]
  ds_read_b64_tr_b16 v[48:49], v14 offset:2048
  ds_read_b64_tr_b16 v[50:51], v14 offset:2560
  v_mfma_f32_32x32x16_bf16 v[120:135], v[60:63], v[180:183], v[120:135]
  ds_read_b64_tr_b16 v[52:53], v15 offset:2048
  ds_read_b64_tr_b16 v[54:55], v15 offset:2560
  s_waitcnt lgkmcnt(4)
  v_mfma_f32_32x32x16_bf16 v[104:119], v[64:67], v[184:187], v[104:119]
  s_add_u32 m0, s61, 98304
  ds_read_b64_tr_b16 v[56:57], v14 offset:4096
  ds_read_b64_tr_b16 v[58:59], v14 offset:4608
  s_mov_b32 s75, 516096
  buffer_load_dwordx4 v4, s[40:43], s75 offen lds
  v_mfma_f32_32x32x16_bf16 v[120:135], v[68:71], v[184:187], v[120:135]
  ds_read_b64_tr_b16 v[60:61], v15 offset:4096
  ds_read_b64_tr_b16 v[62:63], v15 offset:4608
  s_waitcnt lgkmcnt(4)
  v_mfma_f32_32x32x16_bf16 v[104:119], v[48:51], v[188:191], v[104:119]
  ds_read_b64_tr_b16 v[64:65], v14 offset:6144
  ds_read_b64_tr_b16 v[66:67], v14 offset:6656
  v_mfma_f32_32x32x16_bf16 v[120:135], v[52:55], v[188:191], v[120:135]
  ds_read_b64_tr_b16 v[68:69], v15 offset:6144
  ds_read_b64_tr_b16 v[70:71], v15 offset:6656
  s_barrier
  s_cmp_lg_u32 s60, 4
  s_cbranch_scc1 Lpi_18
  s_mov_b32 s13, 0
  s_atomic_add s13, s[14:15], s92 offset:0 glc
Lpi_18:
  s_cmp_lg_u32 s60, 0
  s_cbranch_scc1 Lpi_19
  s_mov_b32 s13, 0
  s_atomic_add s13, s[14:15], s85 offset:0 glc
Lpi_19:
  s_waitcnt lgkmcnt(4)
  v_mfma_f32_32x32x16_bf16 v[104:119], v[56:59], v[192:195], v[104:119]
  s_add_u32 m0, s61, 155648
  v_add_u32 v14, 81920, v6
  ds_read_b64_tr_b16 v[48:49], v14 offset:0
  ds_read_b64_tr_b16 v[50:51], v14 offset:512
  s_mov_b32 s75, 573440
  buffer_load_dwordx4 v4, s[40:43], s75 offen lds
  v_mfma_f32_32x32x16_bf16 v[120:135], v[60:63], v[192:195], v[120:135]
  v_add_u32 v15, 73728, v6
  ds_read_b64_tr_b16 v[52:53], v15 offset:0
  ds_read_b64_tr_b16 v[54:55], v15 offset:512
  s_waitcnt lgkmcnt(4)
  v_mfma_f32_32x32x16_bf16 v[104:119], v[64:67], v[196:199], v[104:119]
  ds_read_b64_tr_b16 v[56:57], v14 offset:2048
  ds_read_b64_tr_b16 v[58:59], v14 offset:2560
  v_mfma_f32_32x32x16_bf16 v[120:135], v[68:71], v[196:199], v[120:135]
  ds_read_b64_tr_b16 v[60:61], v15 offset:2048
  ds_read_b64_tr_b16 v[62:63], v15 offset:2560
  s_waitcnt lgkmcnt(4)
  v_mfma_f32_32x32x16_bf16 v[104:119], v[48:51], v[200:203], v[104:119]
  s_add_u32 m0, s61, 90112
  ds_read_b64_tr_b16 v[64:65], v14 offset:4096
  ds_read_b64_tr_b16 v[66:67], v14 offset:4608
  s_mov_b32 s75, 630784
  buffer_load_dwordx4 v4, s[40:43], s75 offen lds
  v_mfma_f32_32x32x16_bf16 v[120:135], v[52:55], v[200:203], v[120:135]
  ds_read_b64_tr_b16 v[68:69], v15 offset:4096
  ds_read_b64_tr_b16 v[70:71], v15 offset:4608
  s_waitcnt lgkmcnt(4)
  v_mfma_f32_32x32x16_bf16 v[104:119], v[56:59], v[204:207], v[104:119]
  ds_read_b64_tr_b16 v[48:49], v14 offset:6144
  ds_read_b64_tr_b16 v[50:51], v14 offset:6656
  v_mfma_f32_32x32x16_bf16 v[120:135], v[60:63], v[204:207], v[120:135]
  ds_read_b64_tr_b16 v[52:53], v15 offset:6144
  ds_read_b64_tr_b16 v[54:55], v15 offset:6656
  s_cmp_lg_u32 s60, 4
  s_cbranch_scc1 Lpc_20
  s_waitcnt lgkmcnt(0)
  s_cmp_ge_u32 s13, 16
  s_cbranch_scc1 Lpc_20
  s_mov_b32 s93, 0
Lsp_21:
  s_mov_b32 s13, 0
  s_atomic_add s13, s[14:15], s92 offset:0 glc
  s_add_u32 s93, s93, 1
  s_waitcnt lgkmcnt(0)
  s_cmp_ge_u32 s13, 16
  s_cbranch_scc1 Lpc_20
  s_cmp_lt_u32 s93, 20000
  s_cbranch_scc1 Lsp_21
Lpc_20:
  s_cmp_lg_u32 s60, 0
  s_cbranch_scc1 Lpc_22
  s_waitcnt lgkmcnt(0)
  s_cmp_ge_u32 s13, 10
  s_cbranch_scc1 Lpc_22
  s_mov_b32 s93, 0
Lsp_23:
  s_mov_b32 s13, 0
  s_atomic_add s13, s[14:15], s85 offset:0 glc
  s_add_u32 s93, s93, 1
  s_waitcnt lgkmcnt(0)
  s_cmp_ge_u32 s13, 10
  s_cbranch_scc1 Lpc_22
  s_cmp_lt_u32 s93, 20000
  s_cbranch_scc1 Lsp_23
Lpc_22:
  s_barrier
  buffer_load_dword v10, v1, s[52:55], s89 offen sc1
  s_add_u32 s89, s89, 32768
  buffer_load_dword v11, v1, s[52:55], s89 offen sc1
  s_add_u32 s89, s89, 32768
  buffer_load_dword v12, v1, s[52:55], s89 offen sc1
  s_add_u32 s89, s89, 32768
  buffer_load_dword v13, v1, s[52:55], s89 offen sc1
  s_waitcnt lgkmcnt(4)
  v_mfma_f32_32x32x16_bf16 v[104:119], v[64:67], v[208:211], v[104:119]
  v_add_u32 v14, 65536, v6
  ds_read_b64_tr_b16 v[56:57], v14 offset:0
  ds_read_b64_tr_b16 v[58:59], v14 offset:512
  s_mov_b32 s76, 0
  buffer_load_dwordx4 v[72:75], v16, s[52:55], s76 offen sc1
  v_mfma_f32_32x32x16_bf16 v[120:135], v[68:71], v[208:211], v[120:135]
  v_add_u32 v15, 57344, v6
  ds_read_b64_tr_b16 v[60:61], v15 offset:0
  ds_read_b64_tr_b16 v[62:63], v15 offset:512
  s_mov_b32 s76, 4096
  buffer_load_dwordx4 v[76:79], v16, s[52:55], s76 offen sc1
  s_waitcnt lgkmcnt(4)
  v_mfma_f32_32x32x16_bf16 v[104:119], v[48:51], v[212:215], v[104:119]
  ds_read_b64_tr_b16 v[64:65], v14 offset:2048
  ds_read_b64_tr_b16 v[66:67], v14 offset:2560
  s_mov_b32 s76, 8192
  buffer_load_dwordx4 v[80:83], v16, s[52:55], s76 offen sc1
  v_mfma_f32_32x32x16_bf16 v[120:135], v[52:55], v[212:215], v[120:135]
  ds_read_b64_tr_b16 v[68:69], v15 offset:2048
  ds_read_b64_tr_b16 v[70:71], v15 offset:2560
  s_waitcnt lgkmcnt(4)
  v_mfma_f32_32x32x16_bf16 v[104:119], v[56:59], v[216:219], v[104:119]
  ds_read_b64_tr_b16 v[48:49], v14 offset:4096
  ds_read_b64_tr_b16 v[50:51], v14 offset:4608
  s_mov_b32 s76, 12288
  buffer_load_dwordx4 v[84:87], v16, s[52:55], s76 offen sc1
  v_mfma_f32_32x32x16_bf16 v[120:135], v[60:63], v[216:219], v[120:135]
  ds_read_b64_tr_b16 v[52:53], v15 offset:4096
  ds_read_b64_tr_b16 v[54:55], v15 offset:4608
  s_mov_b32 s76, 16384
  buffer_load_dwordx4 v[88:91], v16, s[52:55], s76 offen sc1
  s_waitcnt lgkmcnt(4)
  v_mfma_f32_32x32x16_bf16 v[104:119], v[64:67], v[220:223], v[104:119]
  ds_read_b64_tr_b16 v[56:57], v14 offset:6144
  ds_read_b64_tr_b16 v[58:59], v14 offset:6656
  s_mov_b32 s76, 20480
  buffer_load_dwordx4 v[92:95], v16, s[52:55], s76 offen sc1
  v_mfma_f32_32x32x16_bf16 v[120:135], v[68:71], v[220:223], v[120:135]
  ds_read_b64_tr_b16 v[60:61], v15 offset:6144
  ds_read_b64_tr_b16 v[62:63], v15 offset:6656
  s_waitcnt vmcnt(9)
  v_dot2_f32_bf16 v17, v10, v21, 0
  v_dot2_f32_bf16 v18, v10, v251, 0
  s_waitcnt vmcnt(8)
  v_dot2_f32_bf16 v17, v11, v21, v17
  v_dot2_f32_bf16 v18, v11, v251, v18
  s_waitcnt vmcnt(7)
  v_dot2_f32_bf16 v17, v12, v21, v17
  v_dot2_f32_bf16 v18, v12, v251, v18
  s_waitcnt vmcnt(6)
  v_dot2_f32_bf16 v17, v13, v21, v17
  v_dot2_f32_bf16 v18, v13, v251, v18
  s_nop 2
  v_permlane32_swap_b32 v17, v18
  v_add_f32 v17, v17, v18
  v_mov_b32 v18, v17
  s_nop 1
  v_permlane16_swap_b32 v17, v18
  v_add_f32 v17, v17, v18
  v_mov_b32 v18, v17
  s_nop 1
  v_permlane32_swap_b32 v17, v18
  v_cvt_pk_bf16_f32 v17, v17, v18
  s_and_b32 s77, s64, 3
  s_cmp_eq_u32 s77, 3
  s_cselect_b32 s77, 48, 0xf0
  s_cmp_eq_u32 s60, 7
  s_cselect_b32 vcc_lo, s77, 0
  s_mov_b32 vcc_hi, 0
  v_mov_b32 v18, 0x3f803f80
  v_cndmask_b32 v17, v17, v18, vcc
  s_mov_b64 exec, 0xffff
  buffer_store_dword v17, v1, s[52:55], s91 offen sc1
  s_mov_b64 exec, -1
  s_barrier
  s_waitcnt lgkmcnt(4)
  v_mfma_f32_32x32x16_bf16 v[104:119], v[48:51], v[224:227], v[104:119]
  v_add_u32 v14, 49152, v6
  ds_read_b64_tr_b16 v[64:65], v14 offset:0
  ds_read_b64_tr_b16 v[66:67], v14 offset:512
  s_mov_b32 s76, 24576
  buffer_load_dwordx4 v[96:99], v16, s[52:55], s76 offen sc1
  v_mfma_f32_32x32x16_bf16 v[120:135], v[52:55], v[224:227], v[120:135]
  v_add_u32 v15, 131072, v6
  ds_read_b64_tr_b16 v[68:69], v15 offset:0
  ds_read_b64_tr_b16 v[70:71], v15 offset:512
  s_waitcnt lgkmcnt(4)
  v_mfma_f32_32x32x16_bf16 v[104:119], v[56:59], v[228:231], v[104:119]
  ds_read_b64_tr_b16 v[48:49], v14 offset:2048
  ds_read_b64_tr_b16 v[50:51], v14 offset:2560
  s_mov_b32 s76, 28672
  buffer_load_dwordx4 v[100:103], v16, s[52:55], s76 offen sc1
  v_mfma_f32_32x32x16_bf16 v[120:135], v[60:63], v[228:231], v[120:135]
  ds_read_b64_tr_b16 v[52:53], v15 offset:2048
  ds_read_b64_tr_b16 v[54:55], v15 offset:2560
  s_waitcnt lgkmcnt(4)
  v_mfma_f32_32x32x16_bf16 v[104:119], v[64:67], v[232:235], v[104:119]
  s_add_u32 m0, s61, 147456
  ds_read_b64_tr_b16 v[56:57], v14 offset:4096
  ds_read_b64_tr_b16 v[58:59], v14 offset:4608
  s_mov_b32 s75, 688128
  buffer_load_dwordx4 v4, s[40:43], s75 offen lds
  v_mfma_f32_32x32x16_bf16 v[120:135], v[68:71], v[232:235], v[120:135]
  ds_read_b64_tr_b16 v[60:61], v15 offset:4096
  ds_read_b64_tr_b16 v[62:63], v15 offset:4608
  s_waitcnt lgkmcnt(4)
  v_mfma_f32_32x32x16_bf16 v[104:119], v[48:51], v[236:239], v[104:119]
  s_add_u32 m0, s61, 139264
  ds_read_b64_tr_b16 v[64:65], v14 offset:6144
  ds_read_b64_tr_b16 v[66:67], v14 offset:6656
  s_mov_b32 s75, 745472
  buffer_load_dwordx4 v4, s[40:43], s75 offen lds
  v_mfma_f32_32x32x16_bf16 v[120:135], v[52:55], v[236:239], v[120:135]
  ds_read_b64_tr_b16 v[68:69], v15 offset:6144
  ds_read_b64_tr_b16 v[70:71], v15 offset:6656
  s_waitcnt lgkmcnt(4)
  v_mfma_f32_32x32x16_bf16 v[104:119], v[56:59], v[240:243], v[104:119]
  s_add_u32 m0, s61, 81920
  s_mov_b32 s75, 802816
  buffer_load_dwordx4 v4, s[40:43], s75 offen lds
  v_mfma_f32_32x32x16_bf16 v[120:135], v[60:63], v[240:243], v[120:135]
  s_waitcnt lgkmcnt(0)
  v_mfma_f32_32x32x16_bf16 v[104:119], v[64:67], v[244:247], v[104:119]
  s_add_u32 m0, s61, 73728
  s_mov_b32 s75, 860160
  buffer_load_dwordx4 v4, s[40:43], s75 offen lds
  v_mfma_f32_32x32x16_bf16 v[120:135], v[68:71], v[244:247], v[120:135]
  s_waitcnt vmcnt(6)
  s_barrier
  s_cmp_lg_u32 s60, 2
  s_cbranch_scc1 Lpi_24
  s_mov_b32 s13, 0
  s_atomic_add s13, s[14:15], s85 offset:128 glc
Lpi_24:
  s_cmp_lg_u32 s60, 1
  s_cbranch_scc1 Lsig_25
  s_atomic_add s87, s[14:15], s92 offset:1024
Lsig_25:
  v_add_u32 v14, 65536, v8
  ds_read_b64_tr_b16 v[48:49], v14 offset:49152
  ds_read_b64_tr_b16 v[50:51], v14 offset:50176
  v_add_u32 v15, 65536, v9
  ds_read_b64_tr_b16 v[52:53], v15 offset:49152
  ds_read_b64_tr_b16 v[54:55], v15 offset:50176
  ds_read_b64_tr_b16 v[56:57], v14 offset:57344
  ds_read_b64_tr_b16 v[58:59], v14 offset:58368
  ds_read_b64_tr_b16 v[60:61], v15 offset:57344
  ds_read_b64_tr_b16 v[62:63], v15 offset:58368
  s_add_u32 m0, s61, 131072
  s_mov_b32 s75, 917504
  buffer_load_dwordx4 v4, s[40:43], s75 offen lds
  s_add_u32 m0, s61, 65536
  s_mov_b32 s75, 974848
  buffer_load_dwordx4 v4, s[40:43], s75 offen lds
  s_add_u32 m0, s61, 57344
  s_mov_b32 s75, 1032192
  buffer_load_dwordx4 v4, s[40:43], s75 offen lds
  v_pk_mul_f32 v[104:105], v[104:105], s[90:91] op_sel_hi:[1,0]
  v_pk_mul_f32 v[106:107], v[106:107], s[90:91] op_sel_hi:[1,0]
  v_pk_mul_f32 v[108:109], v[108:109], s[90:91] op_sel_hi:[1,0]
  v_pk_mul_f32 v[110:111], v[110:111], s[90:91] op_sel_hi:[1,0]
  v_exp_f32 v104, v104
  v_exp_f32 v105, v105
  v_exp_f32 v106, v106
  v_exp_f32 v107, v107
  v_exp_f32 v108, v108
  v_exp_f32 v109, v109
  v_exp_f32 v110, v110
  v_exp_f32 v111, v111
  v_pk_add_f32 v[104:105], v[104:105], 1.0 op_sel_hi:[1,0]
  v_pk_add_f32 v[106:107], v[106:107], 1.0 op_sel_hi:[1,0]
  v_pk_add_f32 v[108:109], v[108:109], 1.0 op_sel_hi:[1,0]
  v_pk_add_f32 v[110:111], v[110:111], 1.0 op_sel_hi:[1,0]
  v_rcp_f32 v104, v104
  v_rcp_f32 v105, v105
  v_rcp_f32 v106, v106
  v_rcp_f32 v107, v107
  v_rcp_f32 v108, v108
  v_rcp_f32 v109, v109
  v_rcp_f32 v110, v110
  v_rcp_f32 v111, v111
  v_pk_mul_f32 v[120:121], v[120:121], v[104:105]
  v_pk_mul_f32 v[122:123], v[122:123], v[106:107]
  v_pk_mul_f32 v[124:125], v[124:125], v[108:109]
  v_pk_mul_f32 v[126:127], v[126:127], v[110:111]
  v_cvt_pk_bf16_f32 v104, v120, v121
  v_cvt_pk_bf16_f32 v105, v122, v123
  v_cvt_pk_bf16_f32 v106, v124, v125
  v_cvt_pk_bf16_f32 v107, v126, v127
  s_lshl_b32 s12, s66, 12
  s_add_u32 s12, s12, s80
  buffer_store_dwordx4 v[104:107], v5, s[52:55], s12 offen sc1
  v_pk_mul_f32 v[112:113], v[112:113], s[90:91] op_sel_hi:[1,0]
  v_pk_mul_f32 v[114:115], v[114:115], s[90:91] op_sel_hi:[1,0]
  v_pk_mul_f32 v[116:117], v[116:117], s[90:91] op_sel_hi:[1,0]
  v_pk_mul_f32 v[118:119], v[118:119], s[90:91] op_sel_hi:[1,0]
  v_exp_f32 v112, v112
  v_exp_f32 v113, v113
  v_exp_f32 v114, v114
  v_exp_f32 v115, v115
  v_exp_f32 v116, v116
  v_exp_f32 v117, v117
  v_exp_f32 v118, v118
  v_exp_f32 v119, v119
  v_pk_add_f32 v[112:113], v[112:113], 1.0 op_sel_hi:[1,0]
  v_pk_add_f32 v[114:115], v[114:115], 1.0 op_sel_hi:[1,0]
  v_pk_add_f32 v[116:117], v[116:117], 1.0 op_sel_hi:[1,0]
  v_pk_add_f32 v[118:119], v[118:119], 1.0 op_sel_hi:[1,0]
  v_rcp_f32 v112, v112
  v_rcp_f32 v113, v113
  v_rcp_f32 v114, v114
  v_rcp_f32 v115, v115
  v_rcp_f32 v116, v116
  v_rcp_f32 v117, v117
  v_rcp_f32 v118, v118
  v_rcp_f32 v119, v119
  v_pk_mul_f32 v[128:129], v[128:129], v[112:113]
  v_pk_mul_f32 v[130:131], v[130:131], v[114:115]
  v_pk_mul_f32 v[132:133], v[132:133], v[116:117]
  v_pk_mul_f32 v[134:135], v[134:135], v[118:119]
  v_cvt_pk_bf16_f32 v112, v128, v129
  v_cvt_pk_bf16_f32 v113, v130, v131
  v_cvt_pk_bf16_f32 v114, v132, v133
  v_cvt_pk_bf16_f32 v115, v134, v135
  buffer_store_dwordx4 v[112:115], v5, s[52:55], s12 offen offset:1024 sc1
  s_cmp_lg_u32 s60, 2
  s_cbranch_scc1 Lpc_26
  s_waitcnt lgkmcnt(0)
  s_cmp_ge_u32 s13, 6
  s_cbranch_scc1 Lpc_26
  s_mov_b32 s93, 0
Lsp_27:
  s_mov_b32 s13, 0
  s_atomic_add s13, s[14:15], s85 offset:128 glc
  s_add_u32 s93, s93, 1
  s_waitcnt lgkmcnt(0)
  s_cmp_ge_u32 s13, 6
  s_cbranch_scc1 Lpc_26
  s_cmp_lt_u32 s93, 20000
  s_cbranch_scc1 Lsp_27
Lpc_26:
  s_barrier
  s_waitcnt lgkmcnt(4)
  v_mfma_f32_32x32x16_bf16 v[136:151], v[48:51], v[72:75], 0
  ds_read_b64_tr_b16 v[64:65], v8 offset:0
  ds_read_b64_tr_b16 v[66:67], v8 offset:1024
  s_mov_b32 s76, 32768
  buffer_load_dwordx4 v[168:171], v16, s[52:55], s76 offen sc1
  v_mfma_f32_32x32x16_bf16 v[152:167], v[52:55], v[72:75], 0
  ds_read_b64_tr_b16 v[68:69], v9 offset:0
  ds_read_b64_tr_b16 v[70:71], v9 offset:1024
  s_mov_b32 s76, 36864
  buffer_load_dwordx4 v[172:175], v16, s[52:55], s76 offen sc1
  s_waitcnt lgkmcnt(4)
  v_mfma_f32_32x32x16_bf16 v[136:151], v[56:59], v[76:79], v[136:151]
  ds_read_b64_tr_b16 v[48:49], v8 offset:8192
  ds_read_b64_tr_b16 v[50:51], v8 offset:9216
  s_mov_b32 s76, 40960
  buffer_load_dwordx4 v[176:179], v16, s[52:55], s76 offen sc1
  v_mfma_f32_32x32x16_bf16 v[152:167], v[60:63], v[76:79], v[152:167]
  ds_read_b64_tr_b16 v[52:53], v9 offset:8192
  ds_read_b64_tr_b16 v[54:55], v9 offset:9216
  s_mov_b32 s76, 45056
  buffer_load_dwordx4 v[180:183], v16, s[52:55], s76 offen sc1
  s_waitcnt vmcnt(4)
  s_barrier
  s_cmp_lg_u32 s60, 1
  s_cbranch_scc1 Lsig_28
  s_atomic_add s87, s[14:15], s84 offset:384
Lsig_28:
  s_waitcnt lgkmcnt(4)
  v_mfma_f32_32x32x16_bf16 v[136:151], v[64:67], v[80:83], v[136:151]
  ds_read_b64_tr_b16 v[56:57], v8 offset:16384
  ds_read_b64_tr_b16 v[58:59], v8 offset:17408
  s_mov_b32 s76, 49152
  buffer_load_dwordx4 v[184:187], v16, s[52:55], s76 offen sc1
  v_mfma_f32_32x32x16_bf16 v[152:167], v[68:71], v[80:83], v[152:167]
  ds_read_b64_tr_b16 v[60:61], v9 offset:16384
  ds_read_b64_tr_b16 v[62:63], v9 offset:17408
  s_mov_b32 s76, 53248
  buffer_load_dwordx4 v[188:191], v16, s[52:55], s76 offen sc1
  s_waitcnt lgkmcnt(4)
  v_mfma_f32_32x32x16_bf16 v[136:151], v[48:51], v[84:87], v[136:151]
  s_add_u32 m0, s61, 122880
  ds_read_b64_tr_b16 v[64:65], v8 offset:24576
  ds_read_b64_tr_b16 v[66:67], v8 offset:25600
  s_mov_b32 s75, 1089536
  buffer_load_dwordx4 v4, s[40:43], s75 offen lds
  v_mfma_f32_32x32x16_bf16 v[152:167], v[52:55], v[84:87], v[152:167]
  ds_read_b64_tr_b16 v[68:69], v9 offset:24576
  ds_read_b64_tr_b16 v[70:71], v9 offset:25600
  s_barrier
  s_waitcnt lgkmcnt(4)
  v_mfma_f32_32x32x16_bf16 v[136:151], v[56:59], v[88:91], v[136:151]
  s_add_u32 m0, s61, 0
  ds_read_b64_tr_b16 v[48:49], v8 offset:32768
  ds_read_b64_tr_b16 v[50:51], v8 offset:33792
  s_mov_b32 s75, 1146880
  buffer_load_dwordx4 v4, s[40:43], s75 offen lds
  v_mfma_f32_32x32x16_bf16 v[152:167], v[60:63], v[88:91], v[152:167]
  s_add_u32 m0, s61, 8192
  ds_read_b64_tr_b16 v[52:53], v9 offset:32768
  ds_read_b64_tr_b16 v[54:55], v9 offset:33792
  s_mov_b32 s75, 1204224
  buffer_load_dwordx4 v4, s[40:43], s75 offen lds
  s_waitcnt lgkmcnt(4)
  v_mfma_f32_32x32x16_bf16 v[136:151], v[64:67], v[92:95], v[136:151]
  s_add_u32 m0, s61, 49152
  ds_read_b64_tr_b16 v[56:57], v8 offset:40960
  ds_read_b64_tr_b16 v[58:59], v8 offset:41984
  s_mov_b32 s75, 1261568
  buffer_load_dwordx4 v4, s[40:43], s75 offen lds
  v_mfma_f32_32x32x16_bf16 v[152:167], v[68:71], v[92:95], v[152:167]
  ds_read_b64_tr_b16 v[60:61], v9 offset:40960
  ds_read_b64_tr_b16 v[62:63], v9 offset:41984
  s_barrier
  s_cmp_lg_u32 s60, 0
  s_cbranch_scc1 Lpi_29
  s_mov_b32 s13, 0
  s_atomic_add s13, s[14:15], s85 offset:256 glc
Lpi_29:
  s_cmp_lg_u32 s60, 3
  s_cbranch_scc1 Lpi_30
  s_mov_b32 s13, 0
  s_atomic_add s13, s[14:15], s85 offset:384 glc
Lpi_30:
  s_waitcnt lgkmcnt(4)
  v_mfma_f32_32x32x16_bf16 v[136:151], v[48:51], v[96:99], v[136:151]
  s_add_u32 m0, s61, 16384
  ds_read_b64_tr_b16 v[64:65], v14 offset:40960
  ds_read_b64_tr_b16 v[66:67], v14 offset:41984
  s_mov_b32 s75, 1318912
  buffer_load_dwordx4 v4, s[40:43], s75 offen lds
  v_mfma_f32_32x32x16_bf16 v[152:167], v[52:55], v[96:99], v[152:167]
  s_add_u32 m0, s61, 24576
  ds_read_b64_tr_b16 v[68:69], v15 offset:40960
  ds_read_b64_tr_b16 v[70:71], v15 offset:41984
  s_mov_b32 s75, 1376256
  buffer_load_dwordx4 v4, s[40:43], s75 offen lds
  s_waitcnt lgkmcnt(4)
  v_mfma_f32_32x32x16_bf16 v[136:151], v[56:59], v[100:103], v[136:151]
  s_add_u32 m0, s61, 114688
  ds_read_b64_tr_b16 v[48:49], v14 offset:32768
  ds_read_b64_tr_b16 v[50:51], v14 offset:33792
  s_mov_b32 s75, 1433600
  buffer_load_dwordx4 v4, s[40:43], s75 offen lds
  v_mfma_f32_32x32x16_bf16 v[152:167], v[60:63], v[100:103], v[152:167]
  ds_read_b64_tr_b16 v[52:53], v15 offset:32768
  ds_read_b64_tr_b16 v[54:55], v15 offset:33792
  s_barrier
  s_waitcnt vmcnt(12) lgkmcnt(4)
  v_mfma_f32_32x32x16_bf16 v[136:151], v[64:67], v[168:171], v[136:151]
  s_add_u32 m0, s61, 32768
  v_add_u32 v6, 131072, v8
  ds_read_b64_tr_b16 v[56:57], v6 offset:24576
  ds_read_b64_tr_b16 v[58:59], v6 offset:25600
  s_mov_b32 s75, 1490944
  buffer_load_dwordx4 v4, s[40:43], s75 offen lds
  v_mfma_f32_32x32x16_bf16 v[152:167], v[68:71], v[168:171], v[152:167]
  v_add_u32 v7, 131072, v9
  ds_read_b64_tr_b16 v[60:61], v7 offset:24576
  ds_read_b64_tr_b16 v[62:63], v7 offset:25600
  s_waitcnt vmcnt(12) lgkmcnt(4)
  v_mfma_f32_32x32x16_bf16 v[136:151], v[48:51], v[172:175], v[136:151]
  s_add_u32 m0, s61, 40960
  ds_read_b64_tr_b16 v[64:65], v14 offset:24576
  ds_read_b64_tr_b16 v[66:67], v14 offset:25600
  s_mov_b32 s75, 1548288
  buffer_load_dwordx4 v4, s[40:43], s75 offen lds
  v_mfma_f32_32x32x16_bf16 v[152:167], v[52:55], v[172:175], v[152:167]
  ds_read_b64_tr_b16 v[68:69], v15 offset:24576
  ds_read_b64_tr_b16 v[70:71], v15 offset:25600
  s_cmp_lg_u32 s60, 0
  s_cbranch_scc1 Lpc_31
  s_waitcnt lgkmcnt(0)
  s_cmp_ge_u32 s13, 6
  s_cbranch_scc1 Lpc_31
  s_mov_b32 s93, 0
Lsp_32:
  s_mov_b32 s13, 0
  s_atomic_add s13, s[14:15], s85 offset:256 glc
  s_add_u32 s93, s93, 1
  s_waitcnt lgkmcnt(0)
  s_cmp_ge_u32 s13, 6
  s_cbranch_scc1 Lpc_31
  s_cmp_lt_u32 s93, 20000
  s_cbranch_scc1 Lsp_32
Lpc_31:
  s_cmp_lg_u32 s60, 3
  s_cbranch_scc1 Lpc_33
  s_waitcnt lgkmcnt(0)
  s_cmp_ge_u32 s13, 8
  s_cbranch_scc1 Lpc_33
  s_mov_b32 s93, 0
Lsp_34:
  s_mov_b32 s13, 0
  s_atomic_add s13, s[14:15], s85 offset:384 glc
  s_add_u32 s93, s93, 1
  s_waitcnt lgkmcnt(0)
  s_cmp_ge_u32 s13, 8
  s_cbranch_scc1 Lpc_33
  s_cmp_lt_u32 s93, 20000
  s_cbranch_scc1 Lsp_34
Lpc_33:
  s_barrier
  s_waitcnt vmcnt(12) lgkmcnt(4)
  v_mfma_f32_32x32x16_bf16 v[136:151], v[56:59], v[176:179], v[136:151]
  ds_read_b64_tr_b16 v[48:49], v6 offset:16384
  ds_read_b64_tr_b16 v[50:51], v6 offset:17408
  v_and_b32 v248, 31, v0
  v_lshlrev_b32 v248, 2, v248
  buffer_load_dword v252, v248, s[52:55], s96 offen sc1
  s_mov_b32 s76, 57344
  buffer_load_dwordx4 v[192:195], v16, s[52:55], s76 offen sc1
  v_mfma_f32_32x32x16_bf16 v[152:167], v[60:63], v[176:179], v[152:167]
  ds_read_b64_tr_b16 v[52:53], v7 offset:16384
  ds_read_b64_tr_b16 v[54:55], v7 offset:17408
  s_mov_b32 s76, 61440
  buffer_load_dwordx4 v[196:199], v16, s[52:55], s76 offen sc1
  s_waitcnt vmcnt(14) lgkmcnt(4)
  v_mfma_f32_32x32x16_bf16 v[136:151], v[64:67], v[180:183], v[136:151]
  ds_read_b64_tr_b16 v[56:57], v6 offset:8192
  ds_read_b64_tr_b16 v[58:59], v6 offset:9216
  s_mov_b32 s76, 65536
  buffer_load_dwordx4 v[200:203], v16, s[52:55], s76 offen sc1
  v_mfma_f32_32x32x16_bf16 v[152:167], v[68:71], v[180:183], v[152:167]
  ds_read_b64_tr_b16 v[60:61], v7 offset:8192
  ds_read_b64_tr_b16 v[62:63], v7 offset:9216
  s_barrier
  s_waitcnt vmcnt(14) lgkmcnt(4)
  v_mfma_f32_32x32x16_bf16 v[136:151], v[48:51], v[184:187], v[136:151]
  ds_read_b64_tr_b16 v[64:65], v14 offset:16384
  ds_read_b64_tr_b16 v[66:67], v14 offset:17408
  s_mov_b32 s76, 69632
  buffer_load_dwordx4 v[204:207], v16, s[52:55], s76 offen sc1
  v_mfma_f32_32x32x16_bf16 v[152:167], v[52:55], v[184:187], v[152:167]
  ds_read_b64_tr_b16 v[68:69], v15 offset:16384
  ds_read_b64_tr_b16 v[70:71], v15 offset:17408
  s_mov_b32 s76, 73728
  buffer_load_dwordx4 v[208:211], v16, s[52:55], s76 offen sc1
  s_waitcnt vmcnt(15) lgkmcnt(4)
  v_mfma_f32_32x32x16_bf16 v[136:151], v[56:59], v[188:191], v[136:151]
  ds_read_b64_tr_b16 v[48:49], v14 offset:8192
  ds_read_b64_tr_b16 v[50:51], v14 offset:9216
  s_mov_b32 s76, 77824
  buffer_load_dwordx4 v[212:215], v16, s[52:55], s76 offen sc1
  v_lshrrev_b32 v30, 5, v0
  v_and_b32 v31, 7, v0
  v_xor_b32 v30, v30, v31
  v_and_b32 v32, 31, v0
  v_lshl_or_b32 v30, v32, 4, v30
  v_lshlrev_b32 v30, 4, v30
  s_lshl_b32 s77, s63, 1
  s_add_u32 s77, s77, s62
  s_lshl_b32 s77, s77, 13
  v_add_u32 v22, s77, v30
  v_mfma_f32_32x32x16_bf16 v[152:167], v[60:63], v[188:191], v[152:167]
  ds_read_b64_tr_b16 v[52:53], v15 offset:8192
  ds_read_b64_tr_b16 v[54:55], v15 offset:9216
  v_xor_b32 v23, 32, v22
  v_xor_b32 v24, 64, v22
  v_xor_b32 v25, 96, v22
  v_lshrrev_b32 v30, 3, v0
  v_lshlrev_b32 v32, 1, v31
  v_xor_b32 v32, v32, v30
  v_lshl_or_b32 v32, v30, 4, v32
  v_lshlrev_b32 v32, 4, v32
  s_lshl_b32 s77, s61, 1
  v_add_u32 v26, s77, v32
  v_xor_b32 v27, 16, v26
  v_mul_u32_u24 v30, 896, v30
  s_barrier
  s_waitcnt vmcnt(5) lgkmcnt(4)
  v_mfma_f32_32x32x16_bf16 v[136:151], v[64:67], v[192:195], v[136:151]
  ds_read_b64_tr_b16 v[56:57], v6 offset:0
  ds_read_b64_tr_b16 v[58:59], v6 offset:1024
  s_mov_b32 s76, 81920
  buffer_load_dwordx4 v[216:219], v16, s[52:55], s76 offen sc1
  v_lshl_add_u32 v28, v31, 4, v30
  s_mul_i32 s77, s60, 7168
  s_add_u32 s86, s86, s77
  v_mfma_f32_32x32x16_bf16 v[152:167], v[68:71], v[192:195], v[152:167]
  ds_read_b64_tr_b16 v[60:61], v7 offset:0
  ds_read_b64_tr_b16 v[62:63], v7 offset:1024
  s_mov_b32 s76, 86016
  buffer_load_dwordx4 v[220:223], v16, s[52:55], s76 offen sc1
  s_waitcnt vmcnt(6) lgkmcnt(4)
  v_mfma_f32_32x32x16_bf16 v[136:151], v[48:51], v[196:199], v[136:151]
  ds_read_b64_tr_b16 v[64:65], v14 offset:0
  ds_read_b64_tr_b16 v[66:67], v14 offset:1024
  s_mov_b32 s76, 90112
  buffer_load_dwordx4 v[224:227], v16, s[52:55], s76 offen sc1
  v_mfma_f32_32x32x16_bf16 v[152:167], v[52:55], v[196:199], v[152:167]
  ds_read_b64_tr_b16 v[68:69], v15 offset:0
  ds_read_b64_tr_b16 v[70:71], v15 offset:1024
  s_mov_b32 s76, 94208
  buffer_load_dwordx4 v[228:231], v16, s[52:55], s76 offen sc1
  s_barrier
  s_waitcnt vmcnt(7) lgkmcnt(4)
  v_mfma_f32_32x32x16_bf16 v[136:151], v[56:59], v[200:203], v[136:151]
  ds_read_b64_tr_b16 v[48:49], v8 offset:57344
  ds_read_b64_tr_b16 v[50:51], v8 offset:58368
  s_mov_b32 s76, 98304
  buffer_load_dwordx4 v[232:235], v16, s[52:55], s76 offen sc1
  v_mfma_f32_32x32x16_bf16 v[152:167], v[60:63], v[200:203], v[152:167]
  ds_read_b64_tr_b16 v[52:53], v9 offset:57344
  ds_read_b64_tr_b16 v[54:55], v9 offset:58368
  s_waitcnt vmcnt(7) lgkmcnt(4)
  v_mfma_f32_32x32x16_bf16 v[136:151], v[64:67], v[204:207], v[136:151]
  ds_read_b64_tr_b16 v[56:57], v14 offset:57344
  ds_read_b64_tr_b16 v[58:59], v14 offset:58368
  s_mov_b32 s76, 102400
  buffer_load_dwordx4 v[236:239], v16, s[52:55], s76 offen sc1
  v_mfma_f32_32x32x16_bf16 v[152:167], v[68:71], v[204:207], v[152:167]
  ds_read_b64_tr_b16 v[60:61], v15 offset:57344
  ds_read_b64_tr_b16 v[62:63], v15 offset:58368
  s_barrier
  s_waitcnt vmcnt(7) lgkmcnt(4)
  v_mfma_f32_32x32x16_bf16 v[136:151], v[48:51], v[208:211], v[136:151]
  ds_read_b64_tr_b16 v[64:65], v8 offset:0
  ds_read_b64_tr_b16 v[66:67], v8 offset:1024
  s_mov_b32 s76, 106496
  buffer_load_dwordx4 v[240:243], v16, s[52:55], s76 offen sc1
  v_mfma_f32_32x32x16_bf16 v[152:167], v[52:55], v[208:211], v[152:167]
  ds_read_b64_tr_b16 v[68:69], v9 offset:0
  ds_read_b64_tr_b16 v[70:71], v9 offset:1024
  s_waitcnt vmcnt(7) lgkmcnt(4)
  v_mfma_f32_32x32x16_bf16 v[136:151], v[56:59], v[212:215], v[136:151]
  ds_read_b64_tr_b16 v[48:49], v8 offset:8192
  ds_read_b64_tr_b16 v[50:51], v8 offset:9216
  s_mov_b32 s76, 110592
  buffer_load_dwordx4 v[244:247], v16, s[52:55], s76 offen sc1
  v_mfma_f32_32x32x16_bf16 v[152:167], v[60:63], v[212:215], v[152:167]
  ds_read_b64_tr_b16 v[52:53], v9 offset:8192
  ds_read_b64_tr_b16 v[54:55], v9 offset:9216
  s_barrier
  s_waitcnt vmcnt(7) lgkmcnt(4)
  v_mfma_f32_32x32x16_bf16 v[136:151], v[64:67], v[216:219], v[136:151]
  s_add_u32 m0, s61, 155648
  ds_read_b64_tr_b16 v[56:57], v8 offset:49152
  ds_read_b64_tr_b16 v[58:59], v8 offset:50176
  s_mov_b32 s75, 0
  buffer_load_dwordx4 v4, s[28:31], s75 offen lds
  v_mfma_f32_32x32x16_bf16 v[152:167], v[68:71], v[216:219], v[152:167]
  s_add_u32 m0, s61, 147456
  ds_read_b64_tr_b16 v[60:61], v9 offset:49152
  ds_read_b64_tr_b16 v[62:63], v9 offset:50176
  s_mov_b32 s75, 50176
  buffer_load_dwordx4 v4, s[28:31], s75 offen lds
  s_waitcnt vmcnt(8) lgkmcnt(4)
  v_mfma_f32_32x32x16_bf16 v[136:151], v[48:51], v[220:223], v[136:151]
  s_add_u32 m0, s61, 139264
  ds_read_b64_tr_b16 v[64:65], v8 offset:16384
  ds_read_b64_tr_b16 v[66:67], v8 offset:17408
  s_mov_b32 s75, 200704
  buffer_load_dwordx4 v4, s[28:31], s75 offen lds
  v_mfma_f32_32x32x16_bf16 v[152:167], v[52:55], v[220:223], v[152:167]
  ds_read_b64_tr_b16 v[68:69], v9 offset:16384
  ds_read_b64_tr_b16 v[70:71], v9 offset:17408
  s_barrier
  s_waitcnt vmcnt(8) lgkmcnt(4)
  v_mfma_f32_32x32x16_bf16 v[136:151], v[56:59], v[224:227], v[136:151]
  s_add_u32 m0, s61, 131072
  ds_read_b64_tr_b16 v[48:49], v8 offset:24576
  ds_read_b64_tr_b16 v[50:51], v8 offset:25600
  s_mov_b32 s75, 250880
  buffer_load_dwordx4 v4, s[28:31], s75 offen lds
  v_mfma_f32_32x32x16_bf16 v[152:167], v[60:63], v[224:227], v[152:167]
  ds_read_b64_tr_b16 v[52:53], v9 offset:24576
  ds_read_b64_tr_b16 v[54:55], v9 offset:25600
  s_waitcnt vmcnt(8) lgkmcnt(4)
  v_mfma_f32_32x32x16_bf16 v[136:151], v[64:67], v[228:231], v[136:151]
  s_add_u32 m0, s61, 122880
  ds_read_b64_tr_b16 v[56:57], v14 offset:49152
  ds_read_b64_tr_b16 v[58:59], v14 offset:50176
  s_mov_b32 s75, 100352
  buffer_load_dwordx4 v4, s[28:31], s75 offen lds
  v_mfma_f32_32x32x16_bf16 v[152:167], v[68:71], v[228:231], v[152:167]
  ds_read_b64_tr_b16 v[60:61], v15 offset:49152
  ds_read_b64_tr_b16 v[62:63], v15 offset:50176
  s_barrier
  s_cmp_lg_u32 s60, 2
  s_cbranch_scc1 Lpi_35
  s_mov_b32 s13, 0
  s_atomic_add s13, s[14:15], s85 offset:512 glc
Lpi_35:
  s_waitcnt vmcnt(8) lgkmcnt(4)
  v_mfma_f32_32x32x16_bf16 v[136:151], v[48:51], v[232:235], v[136:151]
  s_add_u32 m0, s61, 106496
  ds_read_b64_tr_b16 v[64:65], v8 offset:32768
  ds_read_b64_tr_b16 v[66:67], v8 offset:33792
  s_mov_b32 s75, 150528
  buffer_load_dwordx4 v4, s[28:31], s75 offen lds
  v_mfma_f32_32x32x16_bf16 v[152:167], v[52:55], v[232:235], v[152:167]
  s_add_u32 m0, s61, 98304
  ds_read_b64_tr_b16 v[68:69], v9 offset:32768
  ds_read_b64_tr_b16 v[70:71], v9 offset:33792
  s_mov_b32 s75, 301056
  buffer_load_dwordx4 v4, s[28:31], s75 offen lds
  s_waitcnt vmcnt(9) lgkmcnt(4)
  v_mfma_f32_32x32x16_bf16 v[136:151], v[56:59], v[236:239], v[136:151]
  s_add_u32 m0, s61, 90112
  ds_read_b64_tr_b16 v[48:49], v8 offset:40960
  ds_read_b64_tr_b16 v[50:51], v8 offset:41984
  s_mov_b32 s75, 351232
  buffer_load_dwordx4 v4, s[28:31], s75 offen lds
  v_mfma_f32_32x32x16_bf16 v[152:167], v[60:63], v[236:239], v[152:167]
  ds_read_b64_tr_b16 v[52:53], v9 offset:40960
  ds_read_b64_tr_b16 v[54:55], v9 offset:41984
  s_cmp_lg_u32 s60, 2
  s_cbranch_scc1 Lpc_36
  s_waitcnt lgkmcnt(0)
  s_cmp_ge_u32 s13, 2
  s_cbranch_scc1 Lpc_36
  s_mov_b32 s93, 0
Lsp_37:
  s_mov_b32 s13, 0
  s_atomic_add s13, s[14:15], s85 offset:512 glc
  s_add_u32 s93, s93, 1
  s_waitcnt lgkmcnt(0)
  s_cmp_ge_u32 s13, 2
  s_cbranch_scc1 Lpc_36
  s_cmp_lt_u32 s93, 20000
  s_cbranch_scc1 Lsp_37
Lpc_36:
  s_waitcnt vmcnt(6)
  s_barrier
  s_cmp_lg_u32 s60, 3
  s_cbranch_scc1 Lpi_38
  s_mov_b32 s13, 0
  s_atomic_add s13, s[14:15], s85 offset:640 glc
Lpi_38:
  s_mov_b32 s76, 114688
  buffer_load_dwordx4 v[168:171], v16, s[52:55], s76 offen sc1
  s_waitcnt lgkmcnt(4)
  v_mfma_f32_32x32x16_bf16 v[136:151], v[64:67], v[240:243], v[136:151]
  s_lshr_b32 s77, s63, 1
  s_lshl_b32 s77, s77, 9
  v_subrev_u32 v8, s77, v8
  v_add_u32 v6, 131072, v8
  ds_read_b64_tr_b16 v[56:57], v6 offset:24576
  ds_read_b64_tr_b16 v[58:59], v6 offset:25600
  s_mov_b32 s76, 118784
  buffer_load_dwordx4 v[172:175], v16, s[52:55], s76 offen sc1
  v_mfma_f32_32x32x16_bf16 v[152:167], v[68:71], v[240:243], v[152:167]
  s_lshr_b32 s77, s63, 1
  s_lshl_b32 s77, s77, 9
  v_subrev_u32 v9, s77, v9
  v_add_u32 v7, 131072, v9
  ds_read_b64_tr_b16 v[60:61], v7 offset:24576
  ds_read_b64_tr_b16 v[62:63], v7 offset:25600
  s_mov_b32 s76, 131072
  buffer_load_dwordx4 v[176:179], v16, s[52:55], s76 offen sc1
  s_waitcnt lgkmcnt(4)
  v_mfma_f32_32x32x16_bf16 v[136:151], v[48:51], v[244:247], v[136:151]
  ds_read_b64_tr_b16 v[64:65], v6 offset:16384
  ds_read_b64_tr_b16 v[66:67], v6 offset:17408
  s_mov_b32 s76, 135168
  buffer_load_dwordx4 v[180:183], v16, s[52:55], s76 offen sc1
  v_mfma_f32_32x32x16_bf16 v[152:167], v[52:55], v[244:247], v[152:167]
  ds_read_b64_tr_b16 v[68:69], v7 offset:16384
  ds_read_b64_tr_b16 v[70:71], v7 offset:17408
  s_nop 4
  v_mul_f32 v136, v252, v136
  v_mul_f32 v137, v252, v137
  v_mul_f32 v138, v252, v138
  v_mul_f32 v139, v252, v139
  v_mul_f32 v140, v252, v140
  v_mul_f32 v141, v252, v141
  v_mul_f32 v142, v252, v142
  v_mul_f32 v143, v252, v143
  v_mul_f32 v144, v252, v144
  v_mul_f32 v145, v252, v145
  v_mul_f32 v146, v252, v146
  v_mul_f32 v147, v252, v147
  v_mul_f32 v148, v252, v148
  v_mul_f32 v149, v252, v149
  v_mul_f32 v150, v252, v150
  v_mul_f32 v151, v252, v151
  v_mul_f32 v152, v252, v152
  v_mul_f32 v153, v252, v153
  v_mul_f32 v154, v252, v154
  v_mul_f32 v155, v252, v155
  v_mul_f32 v156, v252, v156
  v_mul_f32 v157, v252, v157
  v_mul_f32 v158, v252, v158
  v_mul_f32 v159, v252, v159
  v_mul_f32 v160, v252, v160
  v_mul_f32 v161, v252, v161
  v_mul_f32 v162, v252, v162
  v_mul_f32 v163, v252, v163
  v_mul_f32 v164, v252, v164
  v_mul_f32 v165, v252, v165
  v_mul_f32 v166, v252, v166
  v_mul_f32 v167, v252, v167
  s_cmp_lg_u32 s60, 3
  s_cbranch_scc1 Lpc_39
  s_waitcnt lgkmcnt(0)
  s_cmp_ge_u32 s13, 2
  s_cbranch_scc1 Lpc_39
  s_mov_b32 s93, 0
Lsp_40:
  s_mov_b32 s13, 0
  s_atomic_add s13, s[14:15], s85 offset:640 glc
  s_add_u32 s93, s93, 1
  s_waitcnt lgkmcnt(0)
  s_cmp_ge_u32 s13, 2
  s_cbranch_scc1 Lpc_39
  s_cmp_lt_u32 s93, 20000
  s_cbranch_scc1 Lsp_40
Lpc_39:
  s_waitcnt vmcnt(4)
  s_barrier
  s_mov_b32 s76, 122880
  buffer_load_dwordx4 v[184:187], v16, s[52:55], s76 offen sc1
  s_waitcnt vmcnt(4) lgkmcnt(4)
  v_mfma_f32_32x32x16_bf16 v[136:151], v[56:59], v[168:171], v[136:151]
  ds_read_b64_tr_b16 v[48:49], v6 offset:8192
  ds_read_b64_tr_b16 v[50:51], v6 offset:9216
  s_mov_b32 s76, 126976
  buffer_load_dwordx4 v[188:191], v16, s[52:55], s76 offen sc1
  v_mfma_f32_32x32x16_bf16 v[152:167], v[60:63], v[168:171], v[152:167]
  ds_read_b64_tr_b16 v[52:53], v7 offset:8192
  ds_read_b64_tr_b16 v[54:55], v7 offset:9216
  s_mov_b32 s76, 139264
  buffer_load_dwordx4 v[192:195], v16, s[52:55], s76 offen sc1
  s_waitcnt vmcnt(5) lgkmcnt(4)
  v_mfma_f32_32x32x16_bf16 v[136:151], v[64:67], v[172:175], v[136:151]
  ds_read_b64_tr_b16 v[56:57], v6 offset:0
  ds_read_b64_tr_b16 v[58:59], v6 offset:1024
  s_mov_b32 s76, 143360
  buffer_load_dwordx4 v[196:199], v16, s[52:55], s76 offen sc1
  v_mfma_f32_32x32x16_bf16 v[152:167], v[68:71], v[172:175], v[152:167]
  ds_read_b64_tr_b16 v[60:61], v7 offset:0
  ds_read_b64_tr_b16 v[62:63], v7 offset:1024
  s_waitcnt vmcnt(5) lgkmcnt(4)
  v_mfma_f32_32x32x16_bf16 v[136:151], v[48:51], v[176:179], v[136:151]
  v_add_u32 v14, 65536, v8
  ds_read_b64_tr_b16 v[64:65], v14 offset:57344
  ds_read_b64_tr_b16 v[66:67], v14 offset:58368
  v_mfma_f32_32x32x16_bf16 v[152:167], v[52:55], v[176:179], v[152:167]
  v_add_u32 v15, 65536, v9
  ds_read_b64_tr_b16 v[68:69], v15 offset:57344
  ds_read_b64_tr_b16 v[70:71], v15 offset:58368
  s_waitcnt vmcnt(4) lgkmcnt(4)
  v_mfma_f32_32x32x16_bf16 v[136:151], v[56:59], v[180:183], v[136:151]
  ds_read_b64_tr_b16 v[48:49], v14 offset:40960
  ds_read_b64_tr_b16 v[50:51], v14 offset:41984
  v_mfma_f32_32x32x16_bf16 v[152:167], v[60:63], v[180:183], v[152:167]
  ds_read_b64_tr_b16 v[52:53], v15 offset:40960
  ds_read_b64_tr_b16 v[54:55], v15 offset:41984
  s_waitcnt vmcnt(3) lgkmcnt(4)
  v_mfma_f32_32x32x16_bf16 v[136:151], v[64:67], v[184:187], v[136:151]
  ds_read_b64_tr_b16 v[56:57], v14 offset:32768
  ds_read_b64_tr_b16 v[58:59], v14 offset:33792
  v_mfma_f32_32x32x16_bf16 v[152:167], v[68:71], v[184:187], v[152:167]
  ds_read_b64_tr_b16 v[60:61], v15 offset:32768
  ds_read_b64_tr_b16 v[62:63], v15 offset:33792
  s_waitcnt vmcnt(2) lgkmcnt(4)
  v_mfma_f32_32x32x16_bf16 v[136:151], v[48:51], v[188:191], v[136:151]
  ds_read_b64_tr_b16 v[64:65], v14 offset:24576
  ds_read_b64_tr_b16 v[66:67], v14 offset:25600
  v_mfma_f32_32x32x16_bf16 v[152:167], v[52:55], v[188:191], v[152:167]
  ds_read_b64_tr_b16 v[68:69], v15 offset:24576
  ds_read_b64_tr_b16 v[70:71], v15 offset:25600
  s_waitcnt vmcnt(1) lgkmcnt(4)
  v_mfma_f32_32x32x16_bf16 v[136:151], v[56:59], v[192:195], v[136:151]
  v_mfma_f32_32x32x16_bf16 v[152:167], v[60:63], v[192:195], v[152:167]
  s_waitcnt vmcnt(0) lgkmcnt(0)
  v_mfma_f32_32x32x16_bf16 v[136:151], v[64:67], v[196:199], v[136:151]
  v_mfma_f32_32x32x16_bf16 v[152:167], v[68:71], v[196:199], v[152:167]
  s_nop 10
  ds_write_b128 v22, v[136:139] offset:0
  ds_write_b128 v23, v[140:143] offset:0
  ds_write_b128 v24, v[144:147] offset:0
  ds_write_b128 v25, v[148:151] offset:0
  ds_write_b128 v22, v[152:155] offset:128
  ds_write_b128 v23, v[156:159] offset:128
  ds_write_b128 v24, v[160:163] offset:128
  ds_write_b128 v25, v[164:167] offset:128
  s_waitcnt lgkmcnt(0)
  s_barrier
  ds_read_b128 v[168:171], v26 offset:0
  ds_read_b128 v[172:175], v27 offset:0
  ds_read_b128 v[176:179], v26 offset:16384
  ds_read_b128 v[180:183], v27 offset:16384
  ds_read_b128 v[184:187], v26 offset:32768
  ds_read_b128 v[188:191], v27 offset:32768
  ds_read_b128 v[192:195], v26 offset:49152
  ds_read_b128 v[196:199], v27 offset:49152
  s_waitcnt lgkmcnt(4)
  v_pk_add_f32 v[168:169], v[168:169], v[176:177]
  v_pk_add_f32 v[170:171], v[170:171], v[178:179]
  v_pk_add_f32 v[172:173], v[172:173], v[180:181]
  v_pk_add_f32 v[174:175], v[174:175], v[182:183]
  s_waitcnt lgkmcnt(2)
  v_pk_add_f32 v[168:169], v[168:169], v[184:185]
  v_pk_add_f32 v[170:171], v[170:171], v[186:187]
  v_pk_add_f32 v[172:173], v[172:173], v[188:189]
  v_pk_add_f32 v[174:175], v[174:175], v[190:191]
  s_waitcnt lgkmcnt(0)
  v_pk_add_f32 v[168:169], v[168:169], v[192:193]
  v_pk_add_f32 v[170:171], v[170:171], v[194:195]
  v_pk_add_f32 v[172:173], v[172:173], v[196:197]
  v_pk_add_f32 v[174:175], v[174:175], v[198:199]
  v_cvt_pk_bf16_f32 v176, v168, v169
  v_cvt_pk_bf16_f32 v177, v170, v171
  v_cvt_pk_bf16_f32 v178, v172, v173
  v_cvt_pk_bf16_f32 v179, v174, v175
  buffer_store_dwordx4 v[176:179], v28, s[48:51], s86 offen
  s_endpgm
L_KV_end:
.fill (16384 - (. - L_far)) / 4, 4, 0xbf800000
L_Q:
  s_add_u32 m0, s61, 16384
  s_nop 0
  buffer_load_dwordx4 v1, s[16:19], s69 offen lds
  s_add_u32 m0, s61, 24576
  s_add_u32 s76, s69, 57344
  buffer_load_dwordx4 v1, s[16:19], s76 offen lds
  s_add_u32 m0, s61, 81920
  s_mul_i32 s5, s69, 1792
  buffer_load_dwordx4 v2, s[32:35], s5 offen lds
  s_mov_b32 s88, 0x3fb8aa3b
  s_mov_b32 s90, 0xbfb8aa3b
  s_lshl2_add_u32 s80, s64, s63
  s_mul_i32 s80, s80, 145
  s_lshl1_add_u32 s80, s62, s80
  s_lshl_b32 s80, s80, 10
  s_lshl_b32 s84, s64, 10
  s_add_u32 s14, s52, 9830400
  s_addc_u32 s15, s53, 0
  v_lshl_add_u32 v26, v22, 2, v23
  s_lshl_b32 s79, s63, 11
  v_lshl_add_u32 v26, v26, 7, s79
  v_lshlrev_b32 v24, 3, v24
  v_xad_u32 v8, v24, v25, v26
  v_xor_b32 v9, 64, v8
  s_lshr_b32 s79, s2, 3
  s_lshr_b32 s12, s95, 1
  s_add_u32 s12, s12, 24
  s_cmp_lt_u32 s79, 24
  s_cselect_b32 s79, s79, s12
  s_and_b32 s12, s79, 3
  s_lshr_b32 s79, s79, 2
  s_lshl_b32 s82, s79, 7
  v_add_u32 v4, s82, v4
  s_and_b32 s79, s2, 7
  s_waitcnt vmcnt(3)
  s_barrier
  v_add_u32 v14, 65536, v6
  ds_read_b128 v[136:139], v10 offset:0
  ds_read_b64_tr_b16 v[48:49], v14 offset:0
  ds_read_b64_tr_b16 v[50:51], v14 offset:512
  v_add_u32 v15, 73728, v6
  ds_read_b128 v[140:143], v11 offset:0
  ds_read_b64_tr_b16 v[52:53], v15 offset:0
  ds_read_b64_tr_b16 v[54:55], v15 offset:512
  ds_read_b128 v[144:147], v12 offset:0
  ds_read_b64_tr_b16 v[56:57], v14 offset:2048
  ds_read_b64_tr_b16 v[58:59], v14 offset:2560
  ds_read_b128 v[148:151], v13 offset:0
  ds_read_b64_tr_b16 v[60:61], v15 offset:2048
  ds_read_b64_tr_b16 v[62:63], v15 offset:2560
  s_waitcnt lgkmcnt(6)
  v_mfma_f32_32x32x16_bf16 v[72:87], v[48:51], v[136:139], 0
  s_add_u32 m0, s61, 90112
  ds_read_b64_tr_b16 v[64:65], v14 offset:4096
  ds_read_b64_tr_b16 v[66:67], v14 offset:4608
  buffer_load_dwordx4 v2, s[36:39], s5 offen lds
  s_lshl2_add_u32 s79, s79, s12
  v_mfma_f32_32x32x16_bf16 v[88:103], v[52:55], v[136:139], 0
  s_add_u32 m0, s61, 32768
  ds_read_b64_tr_b16 v[68:69], v15 offset:4096
  ds_read_b64_tr_b16 v[70:71], v15 offset:4608
  buffer_load_dwordx4 v1, s[16:19], s70 offen lds
  s_mul_i32 s86, s79, 57344
  s_waitcnt lgkmcnt(4)
  v_mfma_f32_32x32x16_bf16 v[72:87], v[56:59], v[140:143], v[72:87]
  s_add_u32 m0, s61, 40960
  ds_read_b64_tr_b16 v[48:49], v14 offset:6144
  ds_read_b64_tr_b16 v[50:51], v14 offset:6656
  s_add_u32 s76, s70, 57344
  buffer_load_dwordx4 v1, s[16:19], s76 offen lds
  s_add_u32 s86, s86, s82
  v_mfma_f32_32x32x16_bf16 v[88:103], v[60:63], v[140:143], v[88:103]
  s_add_u32 m0, s61, 98304
  ds_read_b64_tr_b16 v[52:53], v15 offset:6144
  ds_read_b64_tr_b16 v[54:55], v15 offset:6656
  s_mul_i32 s6, s70, 1792
  buffer_load_dwordx4 v2, s[32:35], s6 offen lds
  s_lshr_b32 s85, s79, 1
  s_waitcnt vmcnt(3)
  s_barrier
  s_waitcnt lgkmcnt(4)
  v_mfma_f32_32x32x16_bf16 v[72:87], v[64:67], v[144:147], v[72:87]
  s_add_u32 m0, s61, 106496
  v_add_u32 v14, 81920, v6
  ds_read_b128 v[152:155], v10 offset:16384
  ds_read_b64_tr_b16 v[56:57], v14 offset:0
  ds_read_b64_tr_b16 v[58:59], v14 offset:512
  buffer_load_dwordx4 v2, s[36:39], s6 offen lds
  s_lshl_b32 s85, s85, 10
  v_mfma_f32_32x32x16_bf16 v[88:103], v[68:71], v[144:147], v[88:103]
  s_add_u32 m0, s61, 0
  v_add_u32 v15, 90112, v6
  ds_read_b128 v[156:159], v11 offset:16384
  ds_read_b64_tr_b16 v[60:61], v15 offset:0
  ds_read_b64_tr_b16 v[62:63], v15 offset:512
  buffer_load_dwordx4 v1, s[16:19], s71 offen lds
  s_lshl1_add_u32 s79, s79, s62
  s_waitcnt lgkmcnt(6)
  v_mfma_f32_32x32x16_bf16 v[72:87], v[48:51], v[148:151], v[72:87]
  ds_read_b128 v[160:163], v12 offset:16384
  ds_read_b64_tr_b16 v[64:65], v14 offset:2048
  ds_read_b64_tr_b16 v[66:67], v14 offset:2560
  s_lshl_b32 s96, s79, 7
  s_add_u32 s96, s96, 9764864
  s_mul_i32 s81, s79, 145
  s_add_u32 s81, s81, s63
  v_mfma_f32_32x32x16_bf16 v[88:103], v[52:55], v[148:151], v[88:103]
  s_add_u32 m0, s61, 8192
  ds_read_b128 v[164:167], v13 offset:16384
  ds_read_b64_tr_b16 v[68:69], v15 offset:2048
  ds_read_b64_tr_b16 v[70:71], v15 offset:2560
  s_add_u32 s76, s71, 57344
  buffer_load_dwordx4 v1, s[16:19], s76 offen lds
  s_lshl_b32 s81, s81, 10
  s_waitcnt lgkmcnt(6)
  v_mfma_f32_32x32x16_bf16 v[72:87], v[56:59], v[152:155], v[72:87]
  s_add_u32 m0, s61, 114688
  ds_read_b64_tr_b16 v[48:49], v14 offset:4096
  ds_read_b64_tr_b16 v[50:51], v14 offset:4608
  s_mul_i32 s7, s71, 1792
  buffer_load_dwordx4 v2, s[32:35], s7 offen lds
  v_add_u32 v16, s81, v5
  v_mfma_f32_32x32x16_bf16 v[88:103], v[60:63], v[152:155], v[88:103]
  ds_read_b64_tr_b16 v[52:53], v15 offset:4096
  ds_read_b64_tr_b16 v[54:55], v15 offset:4608
  s_waitcnt lgkmcnt(4)
  v_mfma_f32_32x32x16_bf16 v[72:87], v[64:67], v[156:159], v[72:87]
  s_add_u32 m0, s61, 122880
  ds_read_b64_tr_b16 v[56:57], v14 offset:6144
  ds_read_b64_tr_b16 v[58:59], v14 offset:6656
  buffer_load_dwordx4 v2, s[36:39], s7 offen lds
  v_mfma_f32_32x32x16_bf16 v[88:103], v[68:71], v[156:159], v[88:103]
  ds_read_b64_tr_b16 v[60:61], v15 offset:6144
  ds_read_b64_tr_b16 v[62:63], v15 offset:6656
  s_waitcnt vmcnt(4)
  s_barrier
  s_waitcnt lgkmcnt(4)
  v_mfma_f32_32x32x16_bf16 v[72:87], v[48:51], v[160:163], v[72:87]
  s_add_u32 m0, s61, 16384
  v_add_u32 v14, 98304, v6
  ds_read_b128 v[168:171], v10 offset:32768
  ds_read_b64_tr_b16 v[64:65], v14 offset:0
  ds_read_b64_tr_b16 v[66:67], v14 offset:512
  buffer_load_dwordx4 v1, s[16:19], s72 offen lds
  v_mfma_f32_32x32x16_bf16 v[88:103], v[52:55], v[160:163], v[88:103]
  s_add_u32 m0, s61, 24576
  v_add_u32 v15, 106496, v6
  ds_read_b128 v[172:175], v11 offset:32768
  ds_read_b64_tr_b16 v[68:69], v15 offset:0
  ds_read_b64_tr_b16 v[70:71], v15 offset:512
  s_add_u32 s76, s72, 57344
  buffer_load_dwordx4 v1, s[16:19], s76 offen lds
  s_waitcnt lgkmcnt(6)
  v_mfma_f32_32x32x16_bf16 v[72:87], v[56:59], v[164:167], v[72:87]
  ds_read_b128 v[176:179], v12 offset:32768
  ds_read_b64_tr_b16 v[48:49], v14 offset:2048
  ds_read_b64_tr_b16 v[50:51], v14 offset:2560
  s_cmp_lg_u32 s60, 3
  s_cbranch_scc1 Lt_41
  v_lshlrev_b32 v253, 7, v0
  s_lshr_b32 s75, s2, 3
  s_lshr_b32 s76, s95, 1
  s_add_u32 s76, s76, 24
  s_min_u32 s76, s76, s75
  s_and_b32 s75, s2, 7
  s_lshl3_add_u32 s76, s76, s75
  s_sub_u32 s76, s76, 128
  s_mul_i32 s75, s76, 12544
  s_bfm_b64 exec, 49, 0
  buffer_load_dword v20, v253, s[20:23], s75 offen
  s_add_u32 s75, s75, 6272
  buffer_load_dword v20, v253, s[20:23], s75 offen
  s_mov_b64 exec, -1
Lt_41:
  v_mfma_f32_32x32x16_bf16 v[88:103], v[60:63], v[164:167], v[88:103]
  s_add_u32 m0, s61, 65536
  ds_read_b128 v[180:183], v13 offset:32768
  ds_read_b64_tr_b16 v[52:53], v15 offset:2048
  ds_read_b64_tr_b16 v[54:55], v15 offset:2560
  s_mul_i32 s8, s72, 1792
  buffer_load_dwordx4 v2, s[32:35], s8 offen lds
  s_waitcnt lgkmcnt(6)
  v_mfma_f32_32x32x16_bf16 v[72:87], v[64:67], v[168:171], v[72:87]
  s_add_u32 m0, s61, 73728
  ds_read_b64_tr_b16 v[56:57], v14 offset:4096
  ds_read_b64_tr_b16 v[58:59], v14 offset:4608
  buffer_load_dwordx4 v2, s[36:39], s8 offen lds
  v_mfma_f32_32x32x16_bf16 v[88:103], v[68:71], v[168:171], v[88:103]
  s_add_u32 m0, s61, 49152
  ds_read_b64_tr_b16 v[60:61], v15 offset:4096
  ds_read_b64_tr_b16 v[62:63], v15 offset:4608
  buffer_load_dwordx4 v1, s[16:19], s73 offen lds
  s_waitcnt lgkmcnt(4)
  v_mfma_f32_32x32x16_bf16 v[72:87], v[48:51], v[172:175], v[72:87]
  s_add_u32 m0, s61, 57344
  ds_read_b64_tr_b16 v[64:65], v14 offset:6144
  ds_read_b64_tr_b16 v[66:67], v14 offset:6656
  s_add_u32 s76, s73, 57344
  buffer_load_dwordx4 v1, s[16:19], s76 offen lds
  v_mfma_f32_32x32x16_bf16 v[88:103], v[52:55], v[172:175], v[88:103]
  ds_read_b64_tr_b16 v[68:69], v15 offset:6144
  ds_read_b64_tr_b16 v[70:71], v15 offset:6656
  s_waitcnt vmcnt(6)
  s_barrier
  s_waitcnt lgkmcnt(4)
  v_mfma_f32_32x32x16_bf16 v[72:87], v[56:59], v[176:179], v[72:87]
  s_add_u32 m0, s61, 81920
  v_add_u32 v14, 114688, v6
  ds_read_b128 v[184:187], v10 offset:0
  ds_read_b64_tr_b16 v[48:49], v14 offset:0
  ds_read_b64_tr_b16 v[50:51], v14 offset:512
  s_mul_i32 s9, s73, 1792
  buffer_load_dwordx4 v2, s[32:35], s9 offen lds
  v_mfma_f32_32x32x16_bf16 v[88:103], v[60:63], v[176:179], v[88:103]
  s_add_u32 m0, s61, 90112
  v_add_u32 v15, 122880, v6
  ds_read_b128 v[188:191], v11 offset:0
  ds_read_b64_tr_b16 v[52:53], v15 offset:0
  ds_read_b64_tr_b16 v[54:55], v15 offset:512
  buffer_load_dwordx4 v2, s[36:39], s9 offen lds
  s_waitcnt lgkmcnt(6)
  v_mfma_f32_32x32x16_bf16 v[72:87], v[64:67], v[180:183], v[72:87]
  ds_read_b128 v[192:195], v12 offset:0
  ds_read_b64_tr_b16 v[56:57], v14 offset:2048
  ds_read_b64_tr_b16 v[58:59], v14 offset:2560
  v_mfma_f32_32x32x16_bf16 v[88:103], v[68:71], v[180:183], v[88:103]
  s_add_u32 m0, s61, 32768
  ds_read_b128 v[196:199], v13 offset:0
  ds_read_b64_tr_b16 v[60:61], v15 offset:2048
  ds_read_b64_tr_b16 v[62:63], v15 offset:2560
  buffer_load_dwordx4 v1, s[16:19], s74 offen lds
  s_waitcnt lgkmcnt(6)
  v_mfma_f32_32x32x16_bf16 v[72:87], v[48:51], v[184:187], v[72:87]
  s_add_u32 m0, s61, 40960
  ds_read_b64_tr_b16 v[64:65], v14 offset:4096
  ds_read_b64_tr_b16 v[66:67], v14 offset:4608
  s_add_u32 s76, s74, 57344
  buffer_load_dwordx4 v1, s[16:19], s76 offen lds
  v_mfma_f32_32x32x16_bf16 v[88:103], v[52:55], v[184:187], v[88:103]
  ds_read_b64_tr_b16 v[68:69], v15 offset:4096
  ds_read_b64_tr_b16 v[70:71], v15 offset:4608
  s_waitcnt lgkmcnt(4)
  v_mfma_f32_32x32x16_bf16 v[72:87], v[56:59], v[188:191], v[72:87]
  s_add_u32 m0, s61, 155648
  ds_read_b64_tr_b16 v[48:49], v14 offset:6144
  ds_read_b64_tr_b16 v[50:51], v14 offset:6656
  s_mul_i32 s10, s74, 1792
  buffer_load_dwordx4 v2, s[32:35], s10 offen lds
  v_mfma_f32_32x32x16_bf16 v[88:103], v[60:63], v[188:191], v[88:103]
  ds_read_b64_tr_b16 v[52:53], v15 offset:6144
  ds_read_b64_tr_b16 v[54:55], v15 offset:6656
  s_waitcnt vmcnt(7)
  s_barrier
  s_waitcnt lgkmcnt(4)
  v_mfma_f32_32x32x16_bf16 v[72:87], v[64:67], v[192:195], v[72:87]
  s_add_u32 m0, s61, 147456
  v_add_u32 v14, 65536, v6
  ds_read_b128 v[200:203], v10 offset:16384
  ds_read_b64_tr_b16 v[56:57], v14 offset:0
  ds_read_b64_tr_b16 v[58:59], v14 offset:512
  buffer_load_dwordx4 v2, s[36:39], s10 offen lds
  v_mfma_f32_32x32x16_bf16 v[88:103], v[68:71], v[192:195], v[88:103]
  v_add_u32 v15, 73728, v6
  ds_read_b128 v[204:207], v11 offset:16384
  ds_read_b64_tr_b16 v[60:61], v15 offset:0
  ds_read_b64_tr_b16 v[62:63], v15 offset:512
  s_waitcnt lgkmcnt(6)
  v_mfma_f32_32x32x16_bf16 v[72:87], v[48:51], v[196:199], v[72:87]
  s_add_u32 m0, s61, 139264
  ds_read_b128 v[208:211], v12 offset:16384
  ds_read_b64_tr_b16 v[64:65], v14 offset:2048
  ds_read_b64_tr_b16 v[66:67], v14 offset:2560
  v_add_u32 v2, 1024, v2
  s_mul_i32 s4, s68, 1792
  buffer_load_dwordx4 v2, s[32:35], s4 offen lds
  v_mfma_f32_32x32x16_bf16 v[88:103], v[52:55], v[196:199], v[88:103]
  ds_read_b128 v[212:215], v13 offset:16384
  ds_read_b64_tr_b16 v[68:69], v15 offset:2048
  ds_read_b64_tr_b16 v[70:71], v15 offset:2560
  s_waitcnt lgkmcnt(6)
  v_mfma_f32_32x32x16_bf16 v[72:87], v[56:59], v[200:203], v[72:87]
  s_add_u32 m0, s61, 131072
  ds_read_b64_tr_b16 v[48:49], v14 offset:4096
  ds_read_b64_tr_b16 v[50:51], v14 offset:4608
  buffer_load_dwordx4 v2, s[36:39], s4 offen lds
  v_mfma_f32_32x32x16_bf16 v[88:103], v[60:63], v[200:203], v[88:103]
  ds_read_b64_tr_b16 v[52:53], v15 offset:4096
  ds_read_b64_tr_b16 v[54:55], v15 offset:4608
  s_waitcnt lgkmcnt(4)
  v_mfma_f32_32x32x16_bf16 v[72:87], v[64:67], v[204:207], v[72:87]
  s_add_u32 m0, s61, 106496
  ds_read_b64_tr_b16 v[56:57], v14 offset:6144
  ds_read_b64_tr_b16 v[58:59], v14 offset:6656
  buffer_load_dwordx4 v2, s[32:35], s5 offen lds
  v_mfma_f32_32x32x16_bf16 v[88:103], v[68:71], v[204:207], v[88:103]
  ds_read_b64_tr_b16 v[60:61], v15 offset:6144
  ds_read_b64_tr_b16 v[62:63], v15 offset:6656
  s_waitcnt vmcnt(7)
  s_barrier
  s_waitcnt lgkmcnt(4)
  v_mfma_f32_32x32x16_bf16 v[72:87], v[48:51], v[208:211], v[72:87]
  s_add_u32 m0, s61, 122880
  v_add_u32 v14, 81920, v6
  ds_read_b128 v[216:219], v10 offset:49152
  ds_read_b64_tr_b16 v[64:65], v14 offset:0
  ds_read_b64_tr_b16 v[66:67], v14 offset:512
  buffer_load_dwordx4 v2, s[36:39], s5 offen lds
  v_mfma_f32_32x32x16_bf16 v[88:103], v[52:55], v[208:211], v[88:103]
  v_add_u32 v15, 90112, v6
  ds_read_b128 v[220:223], v11 offset:49152
  ds_read_b64_tr_b16 v[68:69], v15 offset:0
  ds_read_b64_tr_b16 v[70:71], v15 offset:512
  s_waitcnt lgkmcnt(6)
  v_mfma_f32_32x32x16_bf16 v[72:87], v[56:59], v[212:215], v[72:87]
  s_add_u32 m0, s61, 114688
  ds_read_b128 v[224:227], v12 offset:49152
  ds_read_b64_tr_b16 v[48:49], v14 offset:2048
  ds_read_b64_tr_b16 v[50:51], v14 offset:2560
  buffer_load_dwordx4 v2, s[32:35], s6 offen lds
  v_mfma_f32_32x32x16_bf16 v[88:103], v[60:63], v[212:215], v[88:103]
  ds_read_b128 v[228:231], v13 offset:49152
  ds_read_b64_tr_b16 v[52:53], v15 offset:2048
  ds_read_b64_tr_b16 v[54:55], v15 offset:2560
  s_waitcnt lgkmcnt(6)
  v_mfma_f32_32x32x16_bf16 v[72:87], v[64:67], v[216:219], v[72:87]
  s_add_u32 m0, s61, 98304
  ds_read_b64_tr_b16 v[56:57], v14 offset:4096
  ds_read_b64_tr_b16 v[58:59], v14 offset:4608
  buffer_load_dwordx4 v2, s[36:39], s6 offen lds
  v_mfma_f32_32x32x16_bf16 v[88:103], v[68:71], v[216:219], v[88:103]
  ds_read_b64_tr_b16 v[60:61], v15 offset:4096
  ds_read_b64_tr_b16 v[62:63], v15 offset:4608
  s_waitcnt lgkmcnt(4)
  v_mfma_f32_32x32x16_bf16 v[72:87], v[48:51], v[220:223], v[72:87]
  s_add_u32 m0, s61, 24576
  ds_read_b64_tr_b16 v[64:65], v14 offset:6144
  ds_read_b64_tr_b16 v[66:67], v14 offset:6656
  buffer_load_dwordx4 v2, s[32:35], s7 offen lds
  v_mfma_f32_32x32x16_bf16 v[88:103], v[52:55], v[220:223], v[88:103]
  ds_read_b64_tr_b16 v[68:69], v15 offset:6144
  ds_read_b64_tr_b16 v[70:71], v15 offset:6656
  s_waitcnt vmcnt(7)
  s_barrier
  s_waitcnt lgkmcnt(4)
  v_mfma_f32_32x32x16_bf16 v[72:87], v[56:59], v[224:227], v[72:87]
  v_add_u32 v14, 155648, v6
  ds_read_b128 v[232:235], v10 offset:32768
  ds_read_b64_tr_b16 v[48:49], v14 offset:0
  ds_read_b64_tr_b16 v[50:51], v14 offset:512
  s_cmp_lg_u32 s60, 0
  s_cbranch_scc1 Lpi_42
  buffer_load_dword v20, off, s[56:59], 0 sc1
Lpi_42:
  s_add_u32 m0, s61, 73728
  s_nop 0
  buffer_load_dwordx4 v2, s[36:39], s7 offen lds
  v_mfma_f32_32x32x16_bf16 v[88:103], v[60:63], v[224:227], v[88:103]
  v_add_u32 v15, 147456, v6
  ds_read_b128 v[236:239], v11 offset:32768
  ds_read_b64_tr_b16 v[52:53], v15 offset:0
  ds_read_b64_tr_b16 v[54:55], v15 offset:512
  s_waitcnt lgkmcnt(6)
  v_mfma_f32_32x32x16_bf16 v[72:87], v[64:67], v[228:231], v[72:87]
  s_add_u32 m0, s61, 65536
  ds_read_b128 v[240:243], v12 offset:32768
  ds_read_b64_tr_b16 v[56:57], v14 offset:2048
  ds_read_b64_tr_b16 v[58:59], v14 offset:2560
  buffer_load_dwordx4 v2, s[32:35], s8 offen lds
  v_mfma_f32_32x32x16_bf16 v[88:103], v[68:71], v[228:231], v[88:103]
  ds_read_b128 v[244:247], v13 offset:32768
  ds_read_b64_tr_b16 v[60:61], v15 offset:2048
  ds_read_b64_tr_b16 v[62:63], v15 offset:2560
  s_waitcnt lgkmcnt(6)
  v_mfma_f32_32x32x16_bf16 v[72:87], v[48:51], v[232:235], v[72:87]
  s_add_u32 m0, s61, 57344
  ds_read_b64_tr_b16 v[64:65], v14 offset:4096
  ds_read_b64_tr_b16 v[66:67], v14 offset:4608
  buffer_load_dwordx4 v2, s[36:39], s8 offen lds
  v_mfma_f32_32x32x16_bf16 v[88:103], v[52:55], v[232:235], v[88:103]
  ds_read_b64_tr_b16 v[68:69], v15 offset:4096
  ds_read_b64_tr_b16 v[70:71], v15 offset:4608
  s_waitcnt lgkmcnt(4)
  v_mfma_f32_32x32x16_bf16 v[72:87], v[56:59], v[236:239], v[72:87]
  s_add_u32 m0, s61, 49152
  ds_read_b64_tr_b16 v[48:49], v14 offset:6144
  ds_read_b64_tr_b16 v[50:51], v14 offset:6656
  buffer_load_dwordx4 v2, s[32:35], s9 offen lds
  v_mfma_f32_32x32x16_bf16 v[88:103], v[60:63], v[236:239], v[88:103]
  ds_read_b64_tr_b16 v[52:53], v15 offset:6144
  ds_read_b64_tr_b16 v[54:55], v15 offset:6656
  s_waitcnt vmcnt(9)
  s_barrier
  s_waitcnt lgkmcnt(4)
  v_mfma_f32_32x32x16_bf16 v[72:87], v[64:67], v[240:243], v[72:87]
  s_add_u32 m0, s61, 90112
  v_add_u32 v14, 139264, v6
  ds_read_b64_tr_b16 v[56:57], v14 offset:0
  ds_read_b64_tr_b16 v[58:59], v14 offset:512
  buffer_load_dwordx4 v2, s[36:39], s9 offen lds
  v_mfma_f32_32x32x16_bf16 v[88:103], v[68:71], v[240:243], v[88:103]
  v_add_u32 v15, 131072, v6
  ds_read_b64_tr_b16 v[60:61], v15 offset:0
  ds_read_b64_tr_b16 v[62:63], v15 offset:512
  s_waitcnt lgkmcnt(4)
  v_mfma_f32_32x32x16_bf16 v[72:87], v[48:51], v[244:247], v[72:87]
  s_add_u32 m0, s61, 81920
  ds_read_b64_tr_b16 v[64:65], v14 offset:2048
  ds_read_b64_tr_b16 v[66:67], v14 offset:2560
  buffer_load_dwordx4 v2, s[32:35], s10 offen lds
  v_mfma_f32_32x32x16_bf16 v[88:103], v[52:55], v[244:247], v[88:103]
  ds_read_b64_tr_b16 v[68:69], v15 offset:2048
  ds_read_b64_tr_b16 v[70:71], v15 offset:2560
  s_waitcnt lgkmcnt(4)
  v_mfma_f32_32x32x16_bf16 v[104:119], v[56:59], v[136:139], 0
  ds_read_b64_tr_b16 v[48:49], v14 offset:4096
  ds_read_b64_tr_b16 v[50:51], v14 offset:4608
  v_mfma_f32_32x32x16_bf16 v[120:135], v[60:63], v[136:139], 0
  s_add_u32 m0, s61, 40960
  ds_read_b64_tr_b16 v[52:53], v15 offset:4096
  ds_read_b64_tr_b16 v[54:55], v15 offset:4608
  buffer_load_dwordx4 v2, s[36:39], s10 offen lds
  s_waitcnt lgkmcnt(4)
  v_mfma_f32_32x32x16_bf16 v[104:119], v[64:67], v[140:143], v[104:119]
  ds_read_b64_tr_b16 v[56:57], v14 offset:6144
  ds_read_b64_tr_b16 v[58:59], v14 offset:6656
  v_mul_f32 v72, s90, v72
  v_mul_f32 v73, s90, v73
  v_mfma_f32_32x32x16_bf16 v[120:135], v[68:71], v[140:143], v[120:135]
  ds_read_b64_tr_b16 v[60:61], v15 offset:6144
  ds_read_b64_tr_b16 v[62:63], v15 offset:6656
  v_mul_f32 v74, s90, v74
  v_mul_f32 v75, s90, v75
  v_mul_f32 v76, s90, v76
  v_mul_f32 v77, s90, v77
  v_mul_f32 v78, s90, v78
  s_cmp_lg_u32 s60, 0
  s_cbranch_scc1 Lpc_43
  s_waitcnt vmcnt(7)
  v_readfirstlane_b32 s13, v20
  s_nop 0
  s_cmp_ge_u32 s13, 1
  s_cbranch_scc1 Lpc_43
  s_mov_b32 s93, 0
Lsp_44:
  buffer_load_dword v20, off, s[56:59], 0 sc1
  s_add_u32 s93, s93, 1
  s_waitcnt vmcnt(0)
  v_readfirstlane_b32 s13, v20
  s_nop 0
  s_cmp_ge_u32 s13, 1
  s_cbranch_scc1 Lpc_43
  s_cmp_lt_u32 s93, 20000
  s_cbranch_scc1 Lsp_44
Lpc_43:
  s_waitcnt vmcnt(10)
  s_barrier
  s_waitcnt lgkmcnt(4)
  v_mfma_f32_32x32x16_bf16 v[104:119], v[48:51], v[144:147], v[104:119]
  s_add_u32 m0, s61, 155648
  v_add_u32 v14, 106496, v6
  ds_read_b64_tr_b16 v[64:65], v14 offset:0
  ds_read_b64_tr_b16 v[66:67], v14 offset:512
  v_add_u32 v2, 768, v2
  buffer_load_dwordx4 v2, s[32:35], s4 offen lds
  v_mul_f32 v79, s90, v79
  v_mfma_f32_32x32x16_bf16 v[120:135], v[52:55], v[144:147], v[120:135]
  v_add_u32 v15, 122880, v6
  ds_read_b64_tr_b16 v[68:69], v15 offset:0
  ds_read_b64_tr_b16 v[70:71], v15 offset:512
  v_exp_f32 v72, v72
  v_exp_f32 v73, v73
  s_waitcnt lgkmcnt(4)
  v_mfma_f32_32x32x16_bf16 v[104:119], v[56:59], v[148:151], v[104:119]
  s_add_u32 m0, s61, 147456
  ds_read_b64_tr_b16 v[48:49], v14 offset:2048
  ds_read_b64_tr_b16 v[50:51], v14 offset:2560
  buffer_load_dwordx4 v2, s[36:39], s4 offen lds
  v_exp_f32 v74, v74
  v_mfma_f32_32x32x16_bf16 v[120:135], v[60:63], v[148:151], v[120:135]
  ds_read_b64_tr_b16 v[52:53], v15 offset:2048
  ds_read_b64_tr_b16 v[54:55], v15 offset:2560
  v_exp_f32 v75, v75
  v_exp_f32 v76, v76
  s_waitcnt lgkmcnt(4)
  v_mfma_f32_32x32x16_bf16 v[104:119], v[64:67], v[152:155], v[104:119]
  ds_read_b64_tr_b16 v[56:57], v14 offset:4096
  ds_read_b64_tr_b16 v[58:59], v14 offset:4608
  v_exp_f32 v77, v77
  v_exp_f32 v78, v78
  v_mfma_f32_32x32x16_bf16 v[120:135], v[68:71], v[152:155], v[120:135]
  s_add_u32 m0, s61, 32768
  ds_read_b64_tr_b16 v[60:61], v15 offset:4096
  ds_read_b64_tr_b16 v[62:63], v15 offset:4608
  buffer_load_dwordx4 v2, s[32:35], s5 offen lds
  v_exp_f32 v79, v79
  s_waitcnt lgkmcnt(4)
  v_mfma_f32_32x32x16_bf16 v[104:119], v[48:51], v[156:159], v[104:119]
  ds_read_b64_tr_b16 v[64:65], v14 offset:6144
  ds_read_b64_tr_b16 v[66:67], v14 offset:6656
  v_add_f32 v72, 1.0, v72
  v_add_f32 v73, 1.0, v73
  v_add_f32 v74, 1.0, v74
  v_add_f32 v75, 1.0, v75
  v_add_f32 v76, 1.0, v76
  v_mfma_f32_32x32x16_bf16 v[120:135], v[52:55], v[156:159], v[120:135]
  ds_read_b64_tr_b16 v[68:69], v15 offset:6144
  ds_read_b64_tr_b16 v[70:71], v15 offset:6656
  v_add_f32 v77, 1.0, v77
  v_add_f32 v78, 1.0, v78
  v_add_f32 v79, 1.0, v79
  v_rcp_f32 v72, v72
  s_waitcnt vmcnt(11)
  s_barrier
  s_waitcnt lgkmcnt(4)
  v_mfma_f32_32x32x16_bf16 v[104:119], v[56:59], v[160:163], v[104:119]
  s_add_u32 m0, s61, 139264
  v_add_u32 v14, 114688, v6
  ds_read_b64_tr_b16 v[48:49], v14 offset:0
  ds_read_b64_tr_b16 v[50:51], v14 offset:512
  buffer_load_dwordx4 v2, s[36:39], s5 offen lds
  v_rcp_f32 v73, v73
  v_mfma_f32_32x32x16_bf16 v[120:135], v[60:63], v[160:163], v[120:135]
  v_add_u32 v15, 98304, v6
  ds_read_b64_tr_b16 v[52:53], v15 offset:0
  ds_read_b64_tr_b16 v[54:55], v15 offset:512
  v_rcp_f32 v74, v74
  v_rcp_f32 v75, v75
  s_waitcnt lgkmcnt(4)
  v_mfma_f32_32x32x16_bf16 v[104:119], v[64:67], v[164:167], v[104:119]
  s_add_u32 m0, s61, 131072
  ds_read_b64_tr_b16 v[56:57], v14 offset:2048
  ds_read_b64_tr_b16 v[58:59], v14 offset:2560
  buffer_load_dwordx4 v2, s[32:35], s6 offen lds
  v_rcp_f32 v76, v76
  v_mfma_f32_32x32x16_bf16 v[120:135], v[68:71], v[164:167], v[120:135]
  ds_read_b64_tr_b16 v[60:61], v15 offset:2048
  ds_read_b64_tr_b16 v[62:63], v15 offset:2560
  v_rcp_f32 v77, v77
  v_rcp_f32 v78, v78
  s_waitcnt lgkmcnt(4)
  v_mfma_f32_32x32x16_bf16 v[104:119], v[48:51], v[168:171], v[104:119]
  ds_read_b64_tr_b16 v[64:65], v14 offset:4096
  ds_read_b64_tr_b16 v[66:67], v14 offset:4608
  v_rcp_f32 v79, v79
  v_mul_f32 v88, v72, v88
  v_mul_f32 v89, v73, v89
  v_mul_f32 v90, v74, v90
  v_mfma_f32_32x32x16_bf16 v[120:135], v[52:55], v[168:171], v[120:135]
  s_add_u32 m0, s61, 16384
  ds_read_b64_tr_b16 v[68:69], v15 offset:4096
  ds_read_b64_tr_b16 v[70:71], v15 offset:4608
  buffer_load_dwordx4 v2, s[36:39], s6 offen lds
  v_mul_f32 v91, v75, v91
  v_mul_f32 v92, v76, v92
  s_waitcnt lgkmcnt(4)
  v_mfma_f32_32x32x16_bf16 v[104:119], v[56:59], v[172:175], v[104:119]
  ds_read_b64_tr_b16 v[48:49], v14 offset:6144
  ds_read_b64_tr_b16 v[50:51], v14 offset:6656
  v_mul_f32 v93, v77, v93
  v_mul_f32 v94, v78, v94
  v_mul_f32 v95, v79, v95
  v_cvt_pk_bf16_f32 v72, v88, v89
  v_cvt_pk_bf16_f32 v73, v90, v91
  v_mfma_f32_32x32x16_bf16 v[120:135], v[60:63], v[172:175], v[120:135]
  ds_read_b64_tr_b16 v[52:53], v15 offset:6144
  ds_read_b64_tr_b16 v[54:55], v15 offset:6656
  v_cvt_pk_bf16_f32 v74, v92, v93
  v_cvt_pk_bf16_f32 v75, v94, v95
  s_lshl_b32 s12, s66, 12
  s_add_u32 s12, s12, s80
  s_waitcnt vmcnt(12)
  s_barrier
  s_waitcnt lgkmcnt(4)
  v_mfma_f32_32x32x16_bf16 v[104:119], v[64:67], v[176:179], v[104:119]
  s_add_u32 m0, s61, 122880
  v_add_u32 v14, 24576, v6
  ds_read_b64_tr_b16 v[56:57], v14 offset:0
  ds_read_b64_tr_b16 v[58:59], v14 offset:512
  buffer_load_dwordx4 v2, s[32:35], s7 offen lds
  buffer_store_dwordx4 v[72:75], v5, s[52:55], s12 offen sc1
  v_mfma_f32_32x32x16_bf16 v[120:135], v[68:71], v[176:179], v[120:135]
  v_add_u32 v15, 73728, v6
  ds_read_b64_tr_b16 v[60:61], v15 offset:0
  ds_read_b64_tr_b16 v[62:63], v15 offset:512
  v_mul_f32 v80, s90, v80
  v_mul_f32 v81, s90, v81
  v_mul_f32 v82, s90, v82
  v_mul_f32 v83, s90, v83
  v_mul_f32 v84, s90, v84
  s_waitcnt lgkmcnt(4)
  v_mfma_f32_32x32x16_bf16 v[104:119], v[48:51], v[180:183], v[104:119]
  s_add_u32 m0, s61, 106496
  ds_read_b64_tr_b16 v[64:65], v14 offset:2048
  ds_read_b64_tr_b16 v[66:67], v14 offset:2560
  buffer_load_dwordx4 v2, s[36:39], s7 offen lds
  v_mul_f32 v85, s90, v85
  v_mul_f32 v86, s90, v86
  v_mfma_f32_32x32x16_bf16 v[120:135], v[52:55], v[180:183], v[120:135]
  ds_read_b64_tr_b16 v[68:69], v15 offset:2048
  ds_read_b64_tr_b16 v[70:71], v15 offset:2560
  v_mul_f32 v87, s90, v87
  v_exp_f32 v80, v80
  v_exp_f32 v81, v81
  s_waitcnt lgkmcnt(4)
  v_mfma_f32_32x32x16_bf16 v[104:119], v[56:59], v[184:187], v[104:119]
  ds_read_b64_tr_b16 v[48:49], v14 offset:4096
  ds_read_b64_tr_b16 v[50:51], v14 offset:4608
  v_exp_f32 v82, v82
  v_exp_f32 v83, v83
  v_mfma_f32_32x32x16_bf16 v[120:135], v[60:63], v[184:187], v[120:135]
  s_add_u32 m0, s61, 8192
  ds_read_b64_tr_b16 v[52:53], v15 offset:4096
  ds_read_b64_tr_b16 v[54:55], v15 offset:4608
  buffer_load_dwordx4 v2, s[32:35], s8 offen lds
  v_exp_f32 v84, v84
  s_waitcnt lgkmcnt(4)
  v_mfma_f32_32x32x16_bf16 v[104:119], v[64:67], v[188:191], v[104:119]
  ds_read_b64_tr_b16 v[56:57], v14 offset:6144
  ds_read_b64_tr_b16 v[58:59], v14 offset:6656
  v_exp_f32 v85, v85
  v_exp_f32 v86, v86
  v_mfma_f32_32x32x16_bf16 v[120:135], v[68:71], v[188:191], v[120:135]
  ds_read_b64_tr_b16 v[60:61], v15 offset:6144
  ds_read_b64_tr_b16 v[62:63], v15 offset:6656
  v_exp_f32 v87, v87
  v_add_f32 v80, 1.0, v80
  v_add_f32 v81, 1.0, v81
  v_add_f32 v82, 1.0, v82
  s_waitcnt vmcnt(14)
  s_barrier
  s_waitcnt lgkmcnt(4)
  v_mfma_f32_32x32x16_bf16 v[104:119], v[48:51], v[192:195], v[104:119]
  s_add_u32 m0, s61, 114688
  v_add_u32 v14, 65536, v6
  ds_read_b64_tr_b16 v[64:65], v14 offset:0
  ds_read_b64_tr_b16 v[66:67], v14 offset:512
  buffer_load_dwordx4 v2, s[36:39], s8 offen lds
  v_add_f32 v83, 1.0, v83
  v_add_f32 v84, 1.0, v84
  v_mfma_f32_32x32x16_bf16 v[120:135], v[52:55], v[192:195], v[120:135]
  v_add_u32 v15, 57344, v6
  ds_read_b64_tr_b16 v[68:69], v15 offset:0
  ds_read_b64_tr_b16 v[70:71], v15 offset:512
  v_add_f32 v85, 1.0, v85
  v_add_f32 v86, 1.0, v86
  v_add_f32 v87, 1.0, v87
  v_rcp_f32 v80, v80
  s_waitcnt lgkmcnt(4)
  v_mfma_f32_32x32x16_bf16 v[104:119], v[56:59], v[196:199], v[104:119]
  s_add_u32 m0, s61, 98304
  ds_read_b64_tr_b16 v[48:49], v14 offset:2048
  ds_read_b64_tr_b16 v[50:51], v14 offset:2560
  buffer_load_dwordx4 v2, s[32:35], s9 offen lds
  v_rcp_f32 v81, v81
  v_mfma_f32_32x32x16_bf16 v[120:135], v[60:63], v[196:199], v[120:135]
  ds_read_b64_tr_b16 v[52:53], v15 offset:2048
  ds_read_b64_tr_b16 v[54:55], v15 offset:2560
  v_rcp_f32 v82, v82
  v_rcp_f32 v83, v83
  s_waitcnt lgkmcnt(4)
  v_mfma_f32_32x32x16_bf16 v[104:119], v[64:67], v[200:203], v[104:119]
  ds_read_b64_tr_b16 v[56:57], v14 offset:4096
  ds_read_b64_tr_b16 v[58:59], v14 offset:4608
  v_rcp_f32 v84, v84
  v_rcp_f32 v85, v85
  v_mfma_f32_32x32x16_bf16 v[120:135], v[68:71], v[200:203], v[120:135]
  s_add_u32 m0, s61, 0
  ds_read_b64_tr_b16 v[60:61], v15 offset:4096
  ds_read_b64_tr_b16 v[62:63], v15 offset:4608
  buffer_load_dwordx4 v2, s[36:39], s9 offen lds
  v_rcp_f32 v86, v86
  s_waitcnt lgkmcnt(4)
  v_mfma_f32_32x32x16_bf16 v[104:119], v[48:51], v[204:207], v[104:119]
  ds_read_b64_tr_b16 v[64:65], v14 offset:6144
  ds_read_b64_tr_b16 v[66:67], v14 offset:6656
  v_rcp_f32 v87, v87
  v_mul_f32 v96, v80, v96
  v_mul_f32 v97, v81, v97
  v_mul_f32 v98, v82, v98
  v_mfma_f32_32x32x16_bf16 v[120:135], v[52:55], v[204:207], v[120:135]
  ds_read_b64_tr_b16 v[68:69], v15 offset:6144
  ds_read_b64_tr_b16 v[70:71], v15 offset:6656
  v_mul_f32 v99, v83, v99
  v_mul_f32 v100, v84, v100
  v_mul_f32 v101, v85, v101
  v_mul_f32 v102, v86, v102
  v_mul_f32 v103, v87, v103
  s_waitcnt vmcnt(15)
  s_barrier
  s_waitcnt lgkmcnt(4)
  v_mfma_f32_32x32x16_bf16 v[104:119], v[56:59], v[208:211], v[104:119]
  s_add_u32 m0, s61, 73728
  v_add_u32 v14, 49152, v6
  ds_read_b64_tr_b16 v[48:49], v14 offset:0
  ds_read_b64_tr_b16 v[50:51], v14 offset:512
  buffer_load_dwordx4 v2, s[32:35], s10 offen lds
  v_cvt_pk_bf16_f32 v80, v96, v97
  v_cvt_pk_bf16_f32 v81, v98, v99
  v_mfma_f32_32x32x16_bf16 v[120:135], v[60:63], v[208:211], v[120:135]
  v_add_u32 v15, 90112, v6
  ds_read_b64_tr_b16 v[52:53], v15 offset:0
  ds_read_b64_tr_b16 v[54:55], v15 offset:512
  v_cvt_pk_bf16_f32 v82, v100, v101
  v_cvt_pk_bf16_f32 v83, v102, v103
  buffer_store_dwordx4 v[80:83], v5, s[52:55], s12 offen offset:1024 sc1
  s_waitcnt lgkmcnt(4)
  v_mfma_f32_32x32x16_bf16 v[104:119], v[64:67], v[212:215], v[104:119]
  ds_read_b64_tr_b16 v[56:57], v14 offset:2048
  ds_read_b64_tr_b16 v[58:59], v14 offset:2560
  v_mfma_f32_32x32x16_bf16 v[120:135], v[68:71], v[212:215], v[120:135]
  ds_read_b64_tr_b16 v[60:61], v15 offset:2048
  ds_read_b64_tr_b16 v[62:63], v15 offset:2560
  s_waitcnt lgkmcnt(4)
  v_mfma_f32_32x32x16_bf16 v[104:119], v[48:51], v[216:219], v[104:119]
  s_add_u32 m0, s61, 24576
  ds_read_b64_tr_b16 v[64:65], v14 offset:4096
  ds_read_b64_tr_b16 v[66:67], v14 offset:4608
  buffer_load_dwordx4 v2, s[36:39], s10 offen lds
  v_mfma_f32_32x32x16_bf16 v[120:135], v[52:55], v[216:219], v[120:135]
  ds_read_b64_tr_b16 v[68:69], v15 offset:4096
  ds_read_b64_tr_b16 v[70:71], v15 offset:4608
  s_waitcnt lgkmcnt(4)
  v_mfma_f32_32x32x16_bf16 v[104:119], v[56:59], v[220:223], v[104:119]
  ds_read_b64_tr_b16 v[48:49], v14 offset:6144
  ds_read_b64_tr_b16 v[50:51], v14 offset:6656
  v_mfma_f32_32x32x16_bf16 v[120:135], v[60:63], v[220:223], v[120:135]
  ds_read_b64_tr_b16 v[52:53], v15 offset:6144
  ds_read_b64_tr_b16 v[54:55], v15 offset:6656
  s_waitcnt vmcnt(16)
  s_barrier
  s_waitcnt lgkmcnt(4)
  v_mfma_f32_32x32x16_bf16 v[104:119], v[64:67], v[224:227], v[104:119]
  s_add_u32 m0, s61, 57344
  v_add_u32 v14, 81920, v6
  ds_read_b64_tr_b16 v[56:57], v14 offset:0
  ds_read_b64_tr_b16 v[58:59], v14 offset:512
  s_mov_b32 s75, 0
  buffer_load_dwordx4 v4, s[40:43], s75 offen lds
  v_mfma_f32_32x32x16_bf16 v[120:135], v[68:71], v[224:227], v[120:135]
  v_add_u32 v15, 40960, v6
  ds_read_b64_tr_b16 v[60:61], v15 offset:0
  ds_read_b64_tr_b16 v[62:63], v15 offset:512
  s_waitcnt lgkmcnt(4)
  v_mfma_f32_32x32x16_bf16 v[104:119], v[48:51], v[228:231], v[104:119]
  ds_read_b64_tr_b16 v[64:65], v14 offset:2048
  ds_read_b64_tr_b16 v[66:67], v14 offset:2560
  v_mfma_f32_32x32x16_bf16 v[120:135], v[52:55], v[228:231], v[120:135]
  ds_read_b64_tr_b16 v[68:69], v15 offset:2048
  ds_read_b64_tr_b16 v[70:71], v15 offset:2560
  s_waitcnt lgkmcnt(4)
  v_mfma_f32_32x32x16_bf16 v[104:119], v[56:59], v[232:235], v[104:119]
  s_add_u32 m0, s61, 65536
  ds_read_b64_tr_b16 v[48:49], v14 offset:4096
  ds_read_b64_tr_b16 v[50:51], v14 offset:4608
  s_mov_b32 s75, 57344
  buffer_load_dwordx4 v4, s[40:43], s75 offen lds
  v_mfma_f32_32x32x16_bf16 v[120:135], v[60:63], v[232:235], v[120:135]
  ds_read_b64_tr_b16 v[52:53], v15 offset:4096
  ds_read_b64_tr_b16 v[54:55], v15 offset:4608
  s_waitcnt lgkmcnt(4)
  v_mfma_f32_32x32x16_bf16 v[104:119], v[64:67], v[236:239], v[104:119]
  ds_read_b64_tr_b16 v[56:57], v14 offset:6144
  ds_read_b64_tr_b16 v[58:59], v14 offset:6656
  v_mfma_f32_32x32x16_bf16 v[120:135], v[68:71], v[236:239], v[120:135]
  ds_read_b64_tr_b16 v[60:61], v15 offset:6144
  ds_read_b64_tr_b16 v[62:63], v15 offset:6656
  s_waitcnt vmcnt(16)
  s_barrier
  s_waitcnt lgkmcnt(4)
  v_mfma_f32_32x32x16_bf16 v[104:119], v[48:51], v[240:243], v[104:119]
  s_add_u32 m0, s61, 49152
  v_add_u32 v14, 155648, v6
  ds_read_b64_tr_b16 v[64:65], v14 offset:0
  ds_read_b64_tr_b16 v[66:67], v14 offset:512
  s_mov_b32 s75, 114688
  buffer_load_dwordx4 v4, s[40:43], s75 offen lds
  v_mfma_f32_32x32x16_bf16 v[120:135], v[52:55], v[240:243], v[120:135]
  v_add_u32 v15, 147456, v6
  ds_read_b64_tr_b16 v[68:69], v15 offset:0
  ds_read_b64_tr_b16 v[70:71], v15 offset:512
  s_waitcnt lgkmcnt(4)
  v_mfma_f32_32x32x16_bf16 v[104:119], v[56:59], v[244:247], v[104:119]
  ds_read_b64_tr_b16 v[48:49], v14 offset:2048
  ds_read_b64_tr_b16 v[50:51], v14 offset:2560
  v_mfma_f32_32x32x16_bf16 v[120:135], v[60:63], v[244:247], v[120:135]
  ds_read_b64_tr_b16 v[52:53], v15 offset:2048
  ds_read_b64_tr_b16 v[54:55], v15 offset:2560
  s_waitcnt lgkmcnt(4)
  v_mfma_f32_32x32x16_bf16 v[72:87], v[64:67], v[136:139], 0
  s_add_u32 m0, s61, 90112
  ds_read_b64_tr_b16 v[56:57], v14 offset:4096
  ds_read_b64_tr_b16 v[58:59], v14 offset:4608
  s_mov_b32 s75, 172032
  buffer_load_dwordx4 v4, s[40:43], s75 offen lds
  v_mfma_f32_32x32x16_bf16 v[88:103], v[68:71], v[136:139], 0
  ds_read_b64_tr_b16 v[60:61], v15 offset:4096
  ds_read_b64_tr_b16 v[62:63], v15 offset:4608
  v_mul_f32 v104, s90, v104
  s_waitcnt lgkmcnt(4)
  v_mfma_f32_32x32x16_bf16 v[72:87], v[48:51], v[140:143], v[72:87]
  ds_read_b64_tr_b16 v[64:65], v14 offset:6144
  ds_read_b64_tr_b16 v[66:67], v14 offset:6656
  v_mul_f32 v105, s90, v105
  v_mul_f32 v106, s90, v106
  v_mul_f32 v107, s90, v107
  v_mul_f32 v108, s90, v108
  v_mul_f32 v109, s90, v109
  v_mul_f32 v110, s90, v110
  v_mul_f32 v111, s90, v111
  v_mfma_f32_32x32x16_bf16 v[88:103], v[52:55], v[140:143], v[88:103]
  ds_read_b64_tr_b16 v[68:69], v15 offset:6144
  ds_read_b64_tr_b16 v[70:71], v15 offset:6656
  v_exp_f32 v104, v104
  v_exp_f32 v105, v105
  v_exp_f32 v106, v106
  s_waitcnt vmcnt(5)
  s_barrier
  s_cmp_lg_u32 s60, 1
  s_cbranch_scc1 Lsig_45
  s_atomic_add s87, s[14:15], s84 offset:0
Lsig_45:
  s_waitcnt lgkmcnt(4)
  v_mfma_f32_32x32x16_bf16 v[72:87], v[56:59], v[144:147], v[72:87]
  s_add_u32 m0, s61, 40960
  v_add_u32 v14, 32768, v6
  ds_read_b64_tr_b16 v[48:49], v14 offset:0
  ds_read_b64_tr_b16 v[50:51], v14 offset:512
  s_mov_b32 s75, 229376
  buffer_load_dwordx4 v4, s[40:43], s75 offen lds
  v_exp_f32 v107, v107
  v_exp_f32 v108, v108
  v_mfma_f32_32x32x16_bf16 v[88:103], v[60:63], v[144:147], v[88:103]
  v_add_u32 v15, 139264, v6
  ds_read_b64_tr_b16 v[52:53], v15 offset:0
  ds_read_b64_tr_b16 v[54:55], v15 offset:512
  v_exp_f32 v109, v109
  v_exp_f32 v110, v110
  v_exp_f32 v111, v111
  v_add_f32 v104, 1.0, v104
  s_waitcnt lgkmcnt(4)
  v_mfma_f32_32x32x16_bf16 v[72:87], v[64:67], v[148:151], v[72:87]
  ds_read_b64_tr_b16 v[56:57], v14 offset:2048
  ds_read_b64_tr_b16 v[58:59], v14 offset:2560
  v_add_f32 v105, 1.0, v105
  v_add_f32 v106, 1.0, v106
  v_add_f32 v107, 1.0, v107
  v_add_f32 v108, 1.0, v108
  v_add_f32 v109, 1.0, v109
  v_add_f32 v110, 1.0, v110
  v_add_f32 v111, 1.0, v111
  v_mfma_f32_32x32x16_bf16 v[88:103], v[68:71], v[148:151], v[88:103]
  ds_read_b64_tr_b16 v[60:61], v15 offset:2048
  ds_read_b64_tr_b16 v[62:63], v15 offset:2560
  v_rcp_f32 v104, v104
  v_rcp_f32 v105, v105
  v_rcp_f32 v106, v106
  s_waitcnt lgkmcnt(4)
  v_mfma_f32_32x32x16_bf16 v[72:87], v[48:51], v[152:155], v[72:87]
  s_add_u32 m0, s61, 81920
  ds_read_b64_tr_b16 v[64:65], v14 offset:4096
  ds_read_b64_tr_b16 v[66:67], v14 offset:4608
  s_mov_b32 s75, 286720
  buffer_load_dwordx4 v4, s[40:43], s75 offen lds
  v_rcp_f32 v107, v107
  v_rcp_f32 v108, v108
  v_mfma_f32_32x32x16_bf16 v[88:103], v[52:55], v[152:155], v[88:103]
  ds_read_b64_tr_b16 v[68:69], v15 offset:4096
  ds_read_b64_tr_b16 v[70:71], v15 offset:4608
  v_rcp_f32 v109, v109
  v_rcp_f32 v110, v110
  v_rcp_f32 v111, v111
  v_mul_f32 v120, v104, v120
  s_waitcnt lgkmcnt(4)
  v_mfma_f32_32x32x16_bf16 v[72:87], v[56:59], v[156:159], v[72:87]
  ds_read_b64_tr_b16 v[48:49], v14 offset:6144
  ds_read_b64_tr_b16 v[50:51], v14 offset:6656
  v_mul_f32 v121, v105, v121
  v_mul_f32 v122, v106, v122
  v_mul_f32 v123, v107, v123
  v_mul_f32 v124, v108, v124
  v_mul_f32 v125, v109, v125
  v_mul_f32 v126, v110, v126
  v_mul_f32 v127, v111, v127
  v_mfma_f32_32x32x16_bf16 v[88:103], v[60:63], v[156:159], v[88:103]
  ds_read_b64_tr_b16 v[52:53], v15 offset:6144
  ds_read_b64_tr_b16 v[54:55], v15 offset:6656
  v_cvt_pk_bf16_f32 v104, v120, v121
  v_cvt_pk_bf16_f32 v105, v122, v123
  v_cvt_pk_bf16_f32 v106, v124, v125
  v_cvt_pk_bf16_f32 v107, v126, v127
  s_lshl_b32 s12, s66, 12
  s_add_u32 s12, s12, s80
  s_add_u32 s12, s12, 32768
  s_barrier
  s_cmp_lg_u32 s60, 0
  s_cbranch_scc1 Lpi_46
  s_mov_b32 s13, 0
  s_atomic_add s13, s[14:15], s85 offset:0 glc
Lpi_46:
  s_waitcnt lgkmcnt(4)
  v_mfma_f32_32x32x16_bf16 v[72:87], v[64:67], v[160:163], v[72:87]
  s_add_u32 m0, s61, 147456
  v_add_u32 v14, 131072, v6
  ds_read_b64_tr_b16 v[56:57], v14 offset:0
  ds_read_b64_tr_b16 v[58:59], v14 offset:512
  s_mov_b32 s75, 344064
  buffer_load_dwordx4 v4, s[40:43], s75 offen lds
  buffer_store_dwordx4 v[104:107], v5, s[52:55], s12 offen sc1
  v_mul_f32 v112, s90, v112
  v_mul_f32 v113, s90, v113
  v_mfma_f32_32x32x16_bf16 v[88:103], v[68:71], v[160:163], v[88:103]
  v_add_u32 v15, 16384, v6
  ds_read_b64_tr_b16 v[60:61], v15 offset:0
  ds_read_b64_tr_b16 v[62:63], v15 offset:512
  v_mul_f32 v114, s90, v114
  v_mul_f32 v115, s90, v115
  v_mul_f32 v116, s90, v116
  v_mul_f32 v117, s90, v117
  v_mul_f32 v118, s90, v118
  v_mul_f32 v119, s90, v119
  s_waitcnt lgkmcnt(4)
  v_mfma_f32_32x32x16_bf16 v[72:87], v[48:51], v[164:167], v[72:87]
  ds_read_b64_tr_b16 v[64:65], v14 offset:2048
  ds_read_b64_tr_b16 v[66:67], v14 offset:2560
  v_exp_f32 v112, v112
  v_exp_f32 v113, v113
  v_exp_f32 v114, v114
  v_mfma_f32_32x32x16_bf16 v[88:103], v[52:55], v[164:167], v[88:103]
  ds_read_b64_tr_b16 v[68:69], v15 offset:2048
  ds_read_b64_tr_b16 v[70:71], v15 offset:2560
  v_exp_f32 v115, v115
  v_exp_f32 v116, v116
  v_exp_f32 v117, v117
  s_waitcnt lgkmcnt(4)
  v_mfma_f32_32x32x16_bf16 v[72:87], v[56:59], v[168:171], v[72:87]
  s_add_u32 m0, s61, 155648
  ds_read_b64_tr_b16 v[48:49], v14 offset:4096
  ds_read_b64_tr_b16 v[50:51], v14 offset:4608
  s_mov_b32 s75, 401408
  buffer_load_dwordx4 v4, s[40:43], s75 offen lds
  v_exp_f32 v118, v118
  v_exp_f32 v119, v119
  v_mfma_f32_32x32x16_bf16 v[88:103], v[60:63], v[168:171], v[88:103]
  ds_read_b64_tr_b16 v[52:53], v15 offset:4096
  ds_read_b64_tr_b16 v[54:55], v15 offset:4608
  v_add_f32 v112, 1.0, v112
  v_add_f32 v113, 1.0, v113
  v_add_f32 v114, 1.0, v114
  v_add_f32 v115, 1.0, v115
  v_add_f32 v116, 1.0, v116
  v_add_f32 v117, 1.0, v117
  v_add_f32 v118, 1.0, v118
  s_waitcnt lgkmcnt(4)
  v_mfma_f32_32x32x16_bf16 v[72:87], v[64:67], v[172:175], v[72:87]
  ds_read_b64_tr_b16 v[56:57], v14 offset:6144
  ds_read_b64_tr_b16 v[58:59], v14 offset:6656
  v_add_f32 v119, 1.0, v119
  v_rcp_f32 v112, v112
  v_rcp_f32 v113, v113
  v_rcp_f32 v114, v114
  v_mfma_f32_32x32x16_bf16 v[88:103], v[68:71], v[172:175], v[88:103]
  ds_read_b64_tr_b16 v[60:61], v15 offset:6144
  ds_read_b64_tr_b16 v[62:63], v15 offset:6656
  v_rcp_f32 v115, v115
  v_rcp_f32 v116, v116
  v_rcp_f32 v117, v117
  s_barrier
  s_waitcnt lgkmcnt(4)
  v_mfma_f32_32x32x16_bf16 v[72:87], v[48:51], v[176:179], v[72:87]
  s_add_u32 m0, s61, 139264
  v_add_u32 v14, 122880, v6
  ds_read_b64_tr_b16 v[64:65], v14 offset:0
  ds_read_b64_tr_b16 v[66:67], v14 offset:512
  s_mov_b32 s75, 458752
  buffer_load_dwordx4 v4, s[40:43], s75 offen lds
  v_rcp_f32 v118, v118
  v_rcp_f32 v119, v119
  v_mfma_f32_32x32x16_bf16 v[88:103], v[52:55], v[176:179], v[88:103]
  v_add_u32 v15, 106496, v6
  ds_read_b64_tr_b16 v[68:69], v15 offset:0
  ds_read_b64_tr_b16 v[70:71], v15 offset:512
  v_mul_f32 v128, v112, v128
  v_mul_f32 v129, v113, v129
  v_mul_f32 v130, v114, v130
  v_mul_f32 v131, v115, v131
  v_mul_f32 v132, v116, v132
  v_mul_f32 v133, v117, v133
  v_mul_f32 v134, v118, v134
  s_waitcnt lgkmcnt(4)
  v_mfma_f32_32x32x16_bf16 v[72:87], v[56:59], v[180:183], v[72:87]
  ds_read_b64_tr_b16 v[48:49], v14 offset:2048
  ds_read_b64_tr_b16 v[50:51], v14 offset:2560
  v_mul_f32 v135, v119, v135
  v_cvt_pk_bf16_f32 v112, v128, v129
  v_cvt_pk_bf16_f32 v113, v130, v131
  v_cvt_pk_bf16_f32 v114, v132, v133
  v_cvt_pk_bf16_f32 v115, v134, v135
  buffer_store_dwordx4 v[112:115], v5, s[52:55], s12 offen offset:1024 sc1
  v_mfma_f32_32x32x16_bf16 v[88:103], v[60:63], v[180:183], v[88:103]
  ds_read_b64_tr_b16 v[52:53], v15 offset:2048
  ds_read_b64_tr_b16 v[54:55], v15 offset:2560
  s_waitcnt lgkmcnt(4)
  v_mfma_f32_32x32x16_bf16 v[72:87], v[64:67], v[184:187], v[72:87]
  s_add_u32 m0, s61, 32768
  ds_read_b64_tr_b16 v[56:57], v14 offset:4096
  ds_read_b64_tr_b16 v[58:59], v14 offset:4608
  s_mov_b32 s75, 516096
  buffer_load_dwordx4 v4, s[40:43], s75 offen lds
  v_mfma_f32_32x32x16_bf16 v[88:103], v[68:71], v[184:187], v[88:103]
  ds_read_b64_tr_b16 v[60:61], v15 offset:4096
  ds_read_b64_tr_b16 v[62:63], v15 offset:4608
  s_waitcnt lgkmcnt(4)
  v_mfma_f32_32x32x16_bf16 v[72:87], v[48:51], v[188:191], v[72:87]
  ds_read_b64_tr_b16 v[64:65], v14 offset:6144
  ds_read_b64_tr_b16 v[66:67], v14 offset:6656
  v_mfma_f32_32x32x16_bf16 v[88:103], v[52:55], v[188:191], v[88:103]
  ds_read_b64_tr_b16 v[68:69], v15 offset:6144
  ds_read_b64_tr_b16 v[70:71], v15 offset:6656
  s_cmp_lg_u32 s60, 0
  s_cbranch_scc1 Lpc_47
  s_waitcnt lgkmcnt(0)
  s_cmp_ge_u32 s13, 10
  s_cbranch_scc1 Lpc_47
  s_mov_b32 s93, 0
Lsp_48:
  s_mov_b32 s13, 0
  s_atomic_add s13, s[14:15], s85 offset:0 glc
  s_add_u32 s93, s93, 1
  s_waitcnt lgkmcnt(0)
  s_cmp_ge_u32 s13, 10
  s_cbranch_scc1 Lpc_47
  s_cmp_lt_u32 s93, 20000
  s_cbranch_scc1 Lsp_48
Lpc_47:
  s_barrier
  s_waitcnt lgkmcnt(4)
  v_mfma_f32_32x32x16_bf16 v[72:87], v[56:59], v[192:195], v[72:87]
  v_add_u32 v14, 8192, v6
  ds_read_b64_tr_b16 v[48:49], v14 offset:0
  ds_read_b64_tr_b16 v[50:51], v14 offset:512
  s_mov_b32 s76, 0
  buffer_load_dwordx4 v[22:25], v16, s[52:55], s76 offen sc1
  v_mfma_f32_32x32x16_bf16 v[88:103], v[60:63], v[192:195], v[88:103]
  v_add_u32 v15, 114688, v6
  ds_read_b64_tr_b16 v[52:53], v15 offset:0
  ds_read_b64_tr_b16 v[54:55], v15 offset:512
  s_waitcnt lgkmcnt(4)
  v_mfma_f32_32x32x16_bf16 v[72:87], v[64:67], v[196:199], v[72:87]
  ds_read_b64_tr_b16 v[56:57], v14 offset:2048
  ds_read_b64_tr_b16 v[58:59], v14 offset:2560
  s_mov_b32 s76, 4096
  buffer_load_dwordx4 v[26:29], v16, s[52:55], s76 offen sc1
  v_mfma_f32_32x32x16_bf16 v[88:103], v[68:71], v[196:199], v[88:103]
  ds_read_b64_tr_b16 v[60:61], v15 offset:2048
  ds_read_b64_tr_b16 v[62:63], v15 offset:2560
  s_waitcnt lgkmcnt(4)
  v_mfma_f32_32x32x16_bf16 v[72:87], v[48:51], v[200:203], v[72:87]
  ds_read_b64_tr_b16 v[64:65], v14 offset:4096
  ds_read_b64_tr_b16 v[66:67], v14 offset:4608
  s_mov_b32 s76, 8192
  buffer_load_dwordx4 v[30:33], v16, s[52:55], s76 offen sc1
  v_mfma_f32_32x32x16_bf16 v[88:103], v[52:55], v[200:203], v[88:103]
  ds_read_b64_tr_b16 v[68:69], v15 offset:4096
  ds_read_b64_tr_b16 v[70:71], v15 offset:4608
  s_waitcnt lgkmcnt(4)
  v_mfma_f32_32x32x16_bf16 v[72:87], v[56:59], v[204:207], v[72:87]
  ds_read_b64_tr_b16 v[48:49], v14 offset:6144
  ds_read_b64_tr_b16 v[50:51], v14 offset:6656
  s_mov_b32 s76, 12288
  buffer_load_dwordx4 v[34:37], v16, s[52:55], s76 offen sc1
  v_mfma_f32_32x32x16_bf16 v[88:103], v[60:63], v[204:207], v[88:103]
  ds_read_b64_tr_b16 v[52:53], v15 offset:6144
  ds_read_b64_tr_b16 v[54:55], v15 offset:6656
  s_waitcnt vmcnt(5)
  s_barrier
  s_cmp_lg_u32 s60, 1
  s_cbranch_scc1 Lsig_49
  s_atomic_add s87, s[14:15], s84 offset:128
Lsig_49:
  s_waitcnt lgkmcnt(4)
  v_mfma_f32_32x32x16_bf16 v[72:87], v[64:67], v[208:211], v[72:87]
  v_add_u32 v14, 98304, v6
  ds_read_b64_tr_b16 v[56:57], v14 offset:0
  ds_read_b64_tr_b16 v[58:59], v14 offset:512
  s_mov_b32 s76, 16384
  buffer_load_dwordx4 v[38:41], v16, s[52:55], s76 offen sc1
  v_mfma_f32_32x32x16_bf16 v[88:103], v[68:71], v[208:211], v[88:103]
  v_add_u32 v15, 0, v6
  ds_read_b64_tr_b16 v[60:61], v15 offset:0
  ds_read_b64_tr_b16 v[62:63], v15 offset:512
  s_waitcnt lgkmcnt(4)
  v_mfma_f32_32x32x16_bf16 v[72:87], v[48:51], v[212:215], v[72:87]
  ds_read_b64_tr_b16 v[64:65], v14 offset:2048
  ds_read_b64_tr_b16 v[66:67], v14 offset:2560
  s_mov_b32 s76, 20480
  buffer_load_dwordx4 v[42:45], v16, s[52:55], s76 offen sc1
  v_mfma_f32_32x32x16_bf16 v[88:103], v[52:55], v[212:215], v[88:103]
  ds_read_b64_tr_b16 v[68:69], v15 offset:2048
  ds_read_b64_tr_b16 v[70:71], v15 offset:2560
  s_waitcnt lgkmcnt(4)
  v_mfma_f32_32x32x16_bf16 v[72:87], v[56:59], v[216:219], v[72:87]
  ds_read_b64_tr_b16 v[48:49], v14 offset:4096
  ds_read_b64_tr_b16 v[50:51], v14 offset:4608
  s_mov_b32 s76, 24576
  buffer_load_dwordx4 v[104:107], v16, s[52:55], s76 offen sc1
  v_mfma_f32_32x32x16_bf16 v[88:103], v[60:63], v[216:219], v[88:103]
  ds_read_b64_tr_b16 v[52:53], v15 offset:4096
  ds_read_b64_tr_b16 v[54:55], v15 offset:4608
  s_waitcnt lgkmcnt(4)
  v_mfma_f32_32x32x16_bf16 v[72:87], v[64:67], v[220:223], v[72:87]
  ds_read_b64_tr_b16 v[56:57], v14 offset:6144
  ds_read_b64_tr_b16 v[58:59], v14 offset:6656
  s_mov_b32 s76, 28672
  buffer_load_dwordx4 v[108:111], v16, s[52:55], s76 offen sc1
  v_mfma_f32_32x32x16_bf16 v[88:103], v[68:71], v[220:223], v[88:103]
  ds_read_b64_tr_b16 v[60:61], v15 offset:6144
  ds_read_b64_tr_b16 v[62:63], v15 offset:6656
  s_barrier
  s_waitcnt lgkmcnt(4)
  v_mfma_f32_32x32x16_bf16 v[72:87], v[48:51], v[224:227], v[72:87]
  s_add_u32 m0, s61, 131072
  v_add_u32 v14, 73728, v6
  ds_read_b64_tr_b16 v[64:65], v14 offset:0
  ds_read_b64_tr_b16 v[66:67], v14 offset:512
  s_mov_b32 s75, 573440
  buffer_load_dwordx4 v4, s[40:43], s75 offen lds
  v_mfma_f32_32x32x16_bf16 v[88:103], v[52:55], v[224:227], v[88:103]
  v_add_u32 v15, 24576, v6
  ds_read_b64_tr_b16 v[68:69], v15 offset:0
  ds_read_b64_tr_b16 v[70:71], v15 offset:512
  s_waitcnt lgkmcnt(4)
  v_mfma_f32_32x32x16_bf16 v[72:87], v[56:59], v[228:231], v[72:87]
  ds_read_b64_tr_b16 v[48:49], v14 offset:2048
  ds_read_b64_tr_b16 v[50:51], v14 offset:2560
  v_mfma_f32_32x32x16_bf16 v[88:103], v[60:63], v[228:231], v[88:103]
  s_add_u32 m0, s61, 122880
  ds_read_b64_tr_b16 v[52:53], v15 offset:2048
  ds_read_b64_tr_b16 v[54:55], v15 offset:2560
  s_mov_b32 s75, 630784
  buffer_load_dwordx4 v4, s[40:43], s75 offen lds
  s_waitcnt lgkmcnt(4)
  v_mfma_f32_32x32x16_bf16 v[72:87], v[64:67], v[232:235], v[72:87]
  ds_read_b64_tr_b16 v[56:57], v14 offset:4096
  ds_read_b64_tr_b16 v[58:59], v14 offset:4608
  v_mfma_f32_32x32x16_bf16 v[88:103], v[68:71], v[232:235], v[88:103]
  ds_read_b64_tr_b16 v[60:61], v15 offset:4096
  ds_read_b64_tr_b16 v[62:63], v15 offset:4608
  s_waitcnt lgkmcnt(4)
  v_mfma_f32_32x32x16_bf16 v[72:87], v[48:51], v[236:239], v[72:87]
  s_add_u32 m0, s61, 114688
  ds_read_b64_tr_b16 v[64:65], v14 offset:6144
  ds_read_b64_tr_b16 v[66:67], v14 offset:6656
  s_mov_b32 s75, 688128
  buffer_load_dwordx4 v4, s[40:43], s75 offen lds
  v_mfma_f32_32x32x16_bf16 v[88:103], v[52:55], v[236:239], v[88:103]
  ds_read_b64_tr_b16 v[68:69], v15 offset:6144
  ds_read_b64_tr_b16 v[70:71], v15 offset:6656
  s_waitcnt lgkmcnt(4)
  v_mfma_f32_32x32x16_bf16 v[72:87], v[56:59], v[240:243], v[72:87]
  v_mfma_f32_32x32x16_bf16 v[88:103], v[60:63], v[240:243], v[88:103]
  s_add_u32 m0, s61, 106496
  s_mov_b32 s75, 745472
  buffer_load_dwordx4 v4, s[40:43], s75 offen lds
  s_waitcnt lgkmcnt(0)
  v_mfma_f32_32x32x16_bf16 v[72:87], v[64:67], v[244:247], v[72:87]
  v_mfma_f32_32x32x16_bf16 v[88:103], v[68:71], v[244:247], v[88:103]
  s_barrier
  s_cmp_lg_u32 s60, 2
  s_cbranch_scc1 Lpi_50
  s_mov_b32 s13, 0
  s_atomic_add s13, s[14:15], s85 offset:128 glc
Lpi_50:
  ds_read_b64_tr_b16 v[48:49], v8 offset:57344
  ds_read_b64_tr_b16 v[50:51], v8 offset:58368
  ds_read_b64_tr_b16 v[52:53], v9 offset:57344
  ds_read_b64_tr_b16 v[54:55], v9 offset:58368
  v_add_u32 v14, 65536, v8
  ds_read_b64_tr_b16 v[56:57], v14 offset:0
  ds_read_b64_tr_b16 v[58:59], v14 offset:1024
  v_add_u32 v15, 65536, v9
  ds_read_b64_tr_b16 v[60:61], v15 offset:0
  ds_read_b64_tr_b16 v[62:63], v15 offset:1024
  s_add_u32 m0, s61, 98304
  s_mov_b32 s75, 802816
  buffer_load_dwordx4 v4, s[40:43], s75 offen lds
  s_add_u32 m0, s61, 73728
  s_mov_b32 s75, 860160
  buffer_load_dwordx4 v4, s[40:43], s75 offen lds
  s_add_u32 m0, s61, 24576
  s_mov_b32 s75, 917504
  buffer_load_dwordx4 v4, s[40:43], s75 offen lds
  v_pk_mul_f32 v[72:73], v[72:73], s[90:91] op_sel_hi:[1,0]
  v_pk_mul_f32 v[74:75], v[74:75], s[90:91] op_sel_hi:[1,0]
  v_pk_mul_f32 v[76:77], v[76:77], s[90:91] op_sel_hi:[1,0]
  v_pk_mul_f32 v[78:79], v[78:79], s[90:91] op_sel_hi:[1,0]
  v_exp_f32 v72, v72
  v_exp_f32 v73, v73
  v_exp_f32 v74, v74
  v_exp_f32 v75, v75
  v_exp_f32 v76, v76
  v_exp_f32 v77, v77
  v_exp_f32 v78, v78
  v_exp_f32 v79, v79
  v_pk_add_f32 v[72:73], v[72:73], 1.0 op_sel_hi:[1,0]
  v_pk_add_f32 v[74:75], v[74:75], 1.0 op_sel_hi:[1,0]
  v_pk_add_f32 v[76:77], v[76:77], 1.0 op_sel_hi:[1,0]
  v_pk_add_f32 v[78:79], v[78:79], 1.0 op_sel_hi:[1,0]
  v_rcp_f32 v72, v72
  v_rcp_f32 v73, v73
  v_rcp_f32 v74, v74
  v_rcp_f32 v75, v75
  v_rcp_f32 v76, v76
  v_rcp_f32 v77, v77
  v_rcp_f32 v78, v78
  v_rcp_f32 v79, v79
  v_pk_mul_f32 v[88:89], v[88:89], v[72:73]
  v_pk_mul_f32 v[90:91], v[90:91], v[74:75]
  v_pk_mul_f32 v[92:93], v[92:93], v[76:77]
  v_pk_mul_f32 v[94:95], v[94:95], v[78:79]
  v_cvt_pk_bf16_f32 v72, v88, v89
  v_cvt_pk_bf16_f32 v73, v90, v91
  v_cvt_pk_bf16_f32 v74, v92, v93
  v_cvt_pk_bf16_f32 v75, v94, v95
  s_lshl_b32 s12, s66, 12
  s_add_u32 s12, s12, s80
  s_add_u32 s12, s12, 57344
  buffer_store_dwordx4 v[72:75], v5, s[52:55], s12 offen sc1
  v_pk_mul_f32 v[80:81], v[80:81], s[90:91] op_sel_hi:[1,0]
  v_pk_mul_f32 v[82:83], v[82:83], s[90:91] op_sel_hi:[1,0]
  v_pk_mul_f32 v[84:85], v[84:85], s[90:91] op_sel_hi:[1,0]
  v_pk_mul_f32 v[86:87], v[86:87], s[90:91] op_sel_hi:[1,0]
  v_exp_f32 v80, v80
  v_exp_f32 v81, v81
  v_exp_f32 v82, v82
  v_exp_f32 v83, v83
  v_exp_f32 v84, v84
  v_exp_f32 v85, v85
  v_exp_f32 v86, v86
  v_exp_f32 v87, v87
  v_pk_add_f32 v[80:81], v[80:81], 1.0 op_sel_hi:[1,0]
  v_pk_add_f32 v[82:83], v[82:83], 1.0 op_sel_hi:[1,0]
  v_pk_add_f32 v[84:85], v[84:85], 1.0 op_sel_hi:[1,0]
  v_pk_add_f32 v[86:87], v[86:87], 1.0 op_sel_hi:[1,0]
  v_rcp_f32 v80, v80
  v_rcp_f32 v81, v81
  v_rcp_f32 v82, v82
  v_rcp_f32 v83, v83
  v_rcp_f32 v84, v84
  v_rcp_f32 v85, v85
  v_rcp_f32 v86, v86
  v_rcp_f32 v87, v87
  v_pk_mul_f32 v[96:97], v[96:97], v[80:81]
  v_pk_mul_f32 v[98:99], v[98:99], v[82:83]
  v_pk_mul_f32 v[100:101], v[100:101], v[84:85]
  v_pk_mul_f32 v[102:103], v[102:103], v[86:87]
  v_cvt_pk_bf16_f32 v80, v96, v97
  v_cvt_pk_bf16_f32 v81, v98, v99
  v_cvt_pk_bf16_f32 v82, v100, v101
  v_cvt_pk_bf16_f32 v83, v102, v103
  buffer_store_dwordx4 v[80:83], v5, s[52:55], s12 offen offset:1024 sc1
  s_cmp_lg_u32 s60, 2
  s_cbranch_scc1 Lpc_51
  s_waitcnt lgkmcnt(0)
  s_cmp_ge_u32 s13, 6
  s_cbranch_scc1 Lpc_51
  s_mov_b32 s93, 0
Lsp_52:
  s_mov_b32 s13, 0
  s_atomic_add s13, s[14:15], s85 offset:128 glc
  s_add_u32 s93, s93, 1
  s_waitcnt lgkmcnt(0)
  s_cmp_ge_u32 s13, 6
  s_cbranch_scc1 Lpc_51
  s_cmp_lt_u32 s93, 20000
  s_cbranch_scc1 Lsp_52
Lpc_51:
  s_barrier
  s_waitcnt vmcnt(16) lgkmcnt(4)
  v_mfma_f32_32x32x16_bf16 v[136:151], v[48:51], v[22:25], 0
  ds_read_b64_tr_b16 v[64:65], v8 offset:49152
  ds_read_b64_tr_b16 v[66:67], v8 offset:50176
  s_mov_b32 s76, 32768
  buffer_load_dwordx4 v[112:115], v16, s[52:55], s76 offen sc1
  v_mfma_f32_32x32x16_bf16 v[152:167], v[52:55], v[22:25], 0
  ds_read_b64_tr_b16 v[68:69], v9 offset:49152
  ds_read_b64_tr_b16 v[70:71], v9 offset:50176
  s_mov_b32 s76, 36864
  buffer_load_dwordx4 v[116:119], v16, s[52:55], s76 offen sc1
  s_waitcnt vmcnt(17) lgkmcnt(4)
  v_mfma_f32_32x32x16_bf16 v[136:151], v[56:59], v[26:29], v[136:151]
  ds_read_b64_tr_b16 v[48:49], v14 offset:24576
  ds_read_b64_tr_b16 v[50:51], v14 offset:25600
  s_mov_b32 s76, 40960
  buffer_load_dwordx4 v[120:123], v16, s[52:55], s76 offen sc1
  v_mfma_f32_32x32x16_bf16 v[152:167], v[60:63], v[26:29], v[152:167]
  ds_read_b64_tr_b16 v[52:53], v15 offset:24576
  ds_read_b64_tr_b16 v[54:55], v15 offset:25600
  s_mov_b32 s76, 45056
  buffer_load_dwordx4 v[124:127], v16, s[52:55], s76 offen sc1
  s_waitcnt vmcnt(4)
  s_barrier
  s_cmp_lg_u32 s60, 1
  s_cbranch_scc1 Lsig_53
  s_atomic_add s87, s[14:15], s84 offset:256
Lsig_53:
  s_waitcnt lgkmcnt(4)
  v_mfma_f32_32x32x16_bf16 v[136:151], v[64:67], v[30:33], v[136:151]
  ds_read_b64_tr_b16 v[56:57], v8 offset:40960
  ds_read_b64_tr_b16 v[58:59], v8 offset:41984
  s_mov_b32 s76, 49152
  buffer_load_dwordx4 v[128:131], v16, s[52:55], s76 offen sc1
  v_mfma_f32_32x32x16_bf16 v[152:167], v[68:71], v[30:33], v[152:167]
  ds_read_b64_tr_b16 v[60:61], v9 offset:40960
  ds_read_b64_tr_b16 v[62:63], v9 offset:41984
  s_mov_b32 s76, 53248
  buffer_load_dwordx4 v[132:135], v16, s[52:55], s76 offen sc1
  s_waitcnt lgkmcnt(4)
  v_mfma_f32_32x32x16_bf16 v[136:151], v[48:51], v[34:37], v[136:151]
  s_add_u32 m0, s61, 65536
  ds_read_b64_tr_b16 v[64:65], v14 offset:16384
  ds_read_b64_tr_b16 v[66:67], v14 offset:17408
  s_mov_b32 s75, 974848
  buffer_load_dwordx4 v4, s[40:43], s75 offen lds
  v_mfma_f32_32x32x16_bf16 v[152:167], v[52:55], v[34:37], v[152:167]
  ds_read_b64_tr_b16 v[68:69], v15 offset:16384
  ds_read_b64_tr_b16 v[70:71], v15 offset:17408
  s_barrier
  s_waitcnt lgkmcnt(4)
  v_mfma_f32_32x32x16_bf16 v[136:151], v[56:59], v[38:41], v[136:151]
  s_add_u32 m0, s61, 90112
  v_add_u32 v6, 131072, v8
  ds_read_b64_tr_b16 v[48:49], v6 offset:16384
  ds_read_b64_tr_b16 v[50:51], v6 offset:17408
  s_mov_b32 s75, 1032192
  buffer_load_dwordx4 v4, s[40:43], s75 offen lds
  v_mfma_f32_32x32x16_bf16 v[152:167], v[60:63], v[38:41], v[152:167]
  s_add_u32 m0, s61, 57344
  v_add_u32 v7, 131072, v9
  ds_read_b64_tr_b16 v[52:53], v7 offset:16384
  ds_read_b64_tr_b16 v[54:55], v7 offset:17408
  s_mov_b32 s75, 1089536
  buffer_load_dwordx4 v4, s[40:43], s75 offen lds
  s_waitcnt lgkmcnt(4)
  v_mfma_f32_32x32x16_bf16 v[136:151], v[64:67], v[42:45], v[136:151]
  s_add_u32 m0, s61, 0
  ds_read_b64_tr_b16 v[56:57], v6 offset:24576
  ds_read_b64_tr_b16 v[58:59], v6 offset:25600
  s_mov_b32 s75, 1146880
  buffer_load_dwordx4 v4, s[40:43], s75 offen lds
  v_mfma_f32_32x32x16_bf16 v[152:167], v[68:71], v[42:45], v[152:167]
  ds_read_b64_tr_b16 v[60:61], v7 offset:24576
  ds_read_b64_tr_b16 v[62:63], v7 offset:25600
  s_barrier
  s_cmp_lg_u32 s60, 0
  s_cbranch_scc1 Lpi_54
  s_mov_b32 s13, 0
  s_atomic_add s13, s[14:15], s85 offset:256 glc
Lpi_54:
  s_waitcnt lgkmcnt(4)
  v_mfma_f32_32x32x16_bf16 v[136:151], v[48:51], v[104:107], v[136:151]
  s_add_u32 m0, s61, 8192
  ds_read_b64_tr_b16 v[64:65], v6 offset:8192
  ds_read_b64_tr_b16 v[66:67], v6 offset:9216
  s_mov_b32 s75, 1204224
  buffer_load_dwordx4 v4, s[40:43], s75 offen lds
  v_mfma_f32_32x32x16_bf16 v[152:167], v[52:55], v[104:107], v[152:167]
  s_add_u32 m0, s61, 16384
  ds_read_b64_tr_b16 v[68:69], v7 offset:8192
  ds_read_b64_tr_b16 v[70:71], v7 offset:9216
  s_mov_b32 s75, 1261568
  buffer_load_dwordx4 v4, s[40:43], s75 offen lds
  s_waitcnt lgkmcnt(4)
  v_mfma_f32_32x32x16_bf16 v[136:151], v[56:59], v[108:111], v[136:151]
  s_add_u32 m0, s61, 40960
  ds_read_b64_tr_b16 v[48:49], v8 offset:32768
  ds_read_b64_tr_b16 v[50:51], v8 offset:33792
  s_mov_b32 s75, 1318912
  buffer_load_dwordx4 v4, s[40:43], s75 offen lds
  v_mfma_f32_32x32x16_bf16 v[152:167], v[60:63], v[108:111], v[152:167]
  s_add_u32 m0, s61, 49152
  ds_read_b64_tr_b16 v[52:53], v9 offset:32768
  ds_read_b64_tr_b16 v[54:55], v9 offset:33792
  s_mov_b32 s75, 1376256
  buffer_load_dwordx4 v4, s[40:43], s75 offen lds
  s_barrier
  s_waitcnt vmcnt(13) lgkmcnt(4)
  v_mfma_f32_32x32x16_bf16 v[136:151], v[64:67], v[112:115], v[136:151]
  s_add_u32 m0, s61, 81920
  ds_read_b64_tr_b16 v[56:57], v6 offset:0
  ds_read_b64_tr_b16 v[58:59], v6 offset:1024
  s_mov_b32 s75, 1433600
  buffer_load_dwordx4 v4, s[40:43], s75 offen lds
  v_mfma_f32_32x32x16_bf16 v[152:167], v[68:71], v[112:115], v[152:167]
  s_add_u32 m0, s61, 147456
  ds_read_b64_tr_b16 v[60:61], v7 offset:0
  ds_read_b64_tr_b16 v[62:63], v7 offset:1024
  s_mov_b32 s75, 1490944
  buffer_load_dwordx4 v4, s[40:43], s75 offen lds
  s_waitcnt vmcnt(14) lgkmcnt(4)
  v_mfma_f32_32x32x16_bf16 v[136:151], v[48:51], v[116:119], v[136:151]
  s_add_u32 m0, s61, 155648
  ds_read_b64_tr_b16 v[64:65], v14 offset:57344
  ds_read_b64_tr_b16 v[66:67], v14 offset:58368
  s_mov_b32 s75, 1548288
  buffer_load_dwordx4 v4, s[40:43], s75 offen lds
  v_mfma_f32_32x32x16_bf16 v[152:167], v[52:55], v[116:119], v[152:167]
  ds_read_b64_tr_b16 v[68:69], v15 offset:57344
  ds_read_b64_tr_b16 v[70:71], v15 offset:58368
  s_cmp_lg_u32 s60, 0
  s_cbranch_scc1 Lpc_55
  s_waitcnt lgkmcnt(0)
  s_cmp_ge_u32 s13, 6
  s_cbranch_scc1 Lpc_55
  s_mov_b32 s93, 0
Lsp_56:
  s_mov_b32 s13, 0
  s_atomic_add s13, s[14:15], s85 offset:256 glc
  s_add_u32 s93, s93, 1
  s_waitcnt lgkmcnt(0)
  s_cmp_ge_u32 s13, 6
  s_cbranch_scc1 Lpc_55
  s_cmp_lt_u32 s93, 20000
  s_cbranch_scc1 Lsp_56
Lpc_55:
  s_barrier
  s_cmp_lg_u32 s60, 3
  s_cbranch_scc1 Lpi_57
  s_mov_b32 s13, 0
  s_atomic_add s13, s[14:15], s85 offset:384 glc
Lpi_57:
  s_waitcnt vmcnt(14) lgkmcnt(4)
  v_mfma_f32_32x32x16_bf16 v[136:151], v[56:59], v[120:123], v[136:151]
  ds_read_b64_tr_b16 v[48:49], v14 offset:49152
  ds_read_b64_tr_b16 v[50:51], v14 offset:50176
  v_and_b32 v248, 31, v0
  v_lshlrev_b32 v248, 2, v248
  buffer_load_dword v252, v248, s[52:55], s96 offen sc1
  s_mov_b32 s76, 57344
  buffer_load_dwordx4 v[168:171], v16, s[52:55], s76 offen sc1
  v_mfma_f32_32x32x16_bf16 v[152:167], v[60:63], v[120:123], v[152:167]
  ds_read_b64_tr_b16 v[52:53], v15 offset:49152
  ds_read_b64_tr_b16 v[54:55], v15 offset:50176
  s_mov_b32 s76, 61440
  buffer_load_dwordx4 v[172:175], v16, s[52:55], s76 offen sc1
  s_waitcnt vmcnt(16) lgkmcnt(4)
  v_mfma_f32_32x32x16_bf16 v[136:151], v[64:67], v[124:127], v[136:151]
  ds_read_b64_tr_b16 v[56:57], v14 offset:40960
  ds_read_b64_tr_b16 v[58:59], v14 offset:41984
  s_mov_b32 s76, 65536
  buffer_load_dwordx4 v[176:179], v16, s[52:55], s76 offen sc1
  v_mfma_f32_32x32x16_bf16 v[152:167], v[68:71], v[124:127], v[152:167]
  ds_read_b64_tr_b16 v[60:61], v15 offset:40960
  ds_read_b64_tr_b16 v[62:63], v15 offset:41984
  s_barrier
  s_waitcnt vmcnt(16) lgkmcnt(4)
  v_mfma_f32_32x32x16_bf16 v[136:151], v[48:51], v[128:131], v[136:151]
  ds_read_b64_tr_b16 v[64:65], v14 offset:32768
  ds_read_b64_tr_b16 v[66:67], v14 offset:33792
  s_mov_b32 s76, 69632
  buffer_load_dwordx4 v[180:183], v16, s[52:55], s76 offen sc1
  v_mfma_f32_32x32x16_bf16 v[152:167], v[52:55], v[128:131], v[152:167]
  ds_read_b64_tr_b16 v[68:69], v15 offset:32768
  ds_read_b64_tr_b16 v[70:71], v15 offset:33792
  s_mov_b32 s76, 73728
  buffer_load_dwordx4 v[184:187], v16, s[52:55], s76 offen sc1
  s_waitcnt vmcnt(17) lgkmcnt(4)
  v_mfma_f32_32x32x16_bf16 v[136:151], v[56:59], v[132:135], v[136:151]
  ds_read_b64_tr_b16 v[48:49], v14 offset:8192
  ds_read_b64_tr_b16 v[50:51], v14 offset:9216
  s_mov_b32 s76, 77824
  buffer_load_dwordx4 v[188:191], v16, s[52:55], s76 offen sc1
  v_lshrrev_b32 v30, 5, v0
  v_and_b32 v31, 7, v0
  v_xor_b32 v30, v30, v31
  v_and_b32 v32, 31, v0
  v_lshl_or_b32 v30, v32, 4, v30
  v_lshlrev_b32 v30, 4, v30
  s_lshl_b32 s77, s63, 1
  s_add_u32 s77, s77, s62
  s_lshl_b32 s77, s77, 13
  v_add_u32 v22, s77, v30
  v_xor_b32 v23, 32, v22
  v_xor_b32 v24, 64, v22
  v_mfma_f32_32x32x16_bf16 v[152:167], v[60:63], v[132:135], v[152:167]
  ds_read_b64_tr_b16 v[52:53], v15 offset:8192
  ds_read_b64_tr_b16 v[54:55], v15 offset:9216
  v_xor_b32 v25, 96, v22
  v_lshrrev_b32 v30, 3, v0
  v_lshlrev_b32 v32, 1, v31
  v_xor_b32 v32, v32, v30
  v_lshl_or_b32 v32, v30, 4, v32
  v_lshlrev_b32 v32, 4, v32
  s_lshl_b32 s77, s61, 1
  v_add_u32 v26, s77, v32
  v_xor_b32 v27, 16, v26
  v_mul_u32_u24 v30, 896, v30
  v_lshl_add_u32 v28, v31, 4, v30
  s_mul_i32 s77, s60, 7168
  s_add_u32 s86, s86, s77
  s_cmp_lg_u32 s60, 3
  s_cbranch_scc1 Lpc_58
  s_waitcnt lgkmcnt(0)
  s_cmp_ge_u32 s13, 8
  s_cbranch_scc1 Lpc_58
  s_mov_b32 s93, 0
Lsp_59:
  s_mov_b32 s13, 0
  s_atomic_add s13, s[14:15], s85 offset:384 glc
  s_add_u32 s93, s93, 1
  s_waitcnt lgkmcnt(0)
  s_cmp_ge_u32 s13, 8
  s_cbranch_scc1 Lpc_58
  s_cmp_lt_u32 s93, 20000
  s_cbranch_scc1 Lsp_59
Lpc_58:
  s_waitcnt vmcnt(17)
  s_barrier
  s_waitcnt vmcnt(5) lgkmcnt(4)
  v_mfma_f32_32x32x16_bf16 v[136:151], v[64:67], v[168:171], v[136:151]
  ds_read_b64_tr_b16 v[56:57], v8 offset:24576
  ds_read_b64_tr_b16 v[58:59], v8 offset:25600
  s_mov_b32 s76, 81920
  buffer_load_dwordx4 v[192:195], v16, s[52:55], s76 offen sc1
  v_mfma_f32_32x32x16_bf16 v[152:167], v[68:71], v[168:171], v[152:167]
  ds_read_b64_tr_b16 v[60:61], v9 offset:24576
  ds_read_b64_tr_b16 v[62:63], v9 offset:25600
  s_mov_b32 s76, 86016
  buffer_load_dwordx4 v[196:199], v16, s[52:55], s76 offen sc1
  s_waitcnt vmcnt(6) lgkmcnt(4)
  v_mfma_f32_32x32x16_bf16 v[136:151], v[48:51], v[172:175], v[136:151]
  ds_read_b64_tr_b16 v[64:65], v14 offset:0
  ds_read_b64_tr_b16 v[66:67], v14 offset:1024
  s_mov_b32 s76, 90112
  buffer_load_dwordx4 v[200:203], v16, s[52:55], s76 offen sc1
  v_mfma_f32_32x32x16_bf16 v[152:167], v[52:55], v[172:175], v[152:167]
  ds_read_b64_tr_b16 v[68:69], v15 offset:0
  ds_read_b64_tr_b16 v[70:71], v15 offset:1024
  s_mov_b32 s76, 94208
  buffer_load_dwordx4 v[204:207], v16, s[52:55], s76 offen sc1
  s_barrier
  s_waitcnt vmcnt(7) lgkmcnt(4)
  v_mfma_f32_32x32x16_bf16 v[136:151], v[56:59], v[176:179], v[136:151]
  ds_read_b64_tr_b16 v[48:49], v14 offset:24576
  ds_read_b64_tr_b16 v[50:51], v14 offset:25600
  s_mov_b32 s76, 98304
  buffer_load_dwordx4 v[208:211], v16, s[52:55], s76 offen sc1
  v_mfma_f32_32x32x16_bf16 v[152:167], v[60:63], v[176:179], v[152:167]
  ds_read_b64_tr_b16 v[52:53], v15 offset:24576
  ds_read_b64_tr_b16 v[54:55], v15 offset:25600
  s_waitcnt vmcnt(7) lgkmcnt(4)
  v_mfma_f32_32x32x16_bf16 v[136:151], v[64:67], v[180:183], v[136:151]
  ds_read_b64_tr_b16 v[56:57], v8 offset:57344
  ds_read_b64_tr_b16 v[58:59], v8 offset:58368
  s_mov_b32 s76, 102400
  buffer_load_dwordx4 v[212:215], v16, s[52:55], s76 offen sc1
  v_mfma_f32_32x32x16_bf16 v[152:167], v[68:71], v[180:183], v[152:167]
  ds_read_b64_tr_b16 v[60:61], v9 offset:57344
  ds_read_b64_tr_b16 v[62:63], v9 offset:58368
  s_barrier
  s_waitcnt vmcnt(7) lgkmcnt(4)
  v_mfma_f32_32x32x16_bf16 v[136:151], v[48:51], v[184:187], v[136:151]
  ds_read_b64_tr_b16 v[64:65], v8 offset:0
  ds_read_b64_tr_b16 v[66:67], v8 offset:1024
  s_mov_b32 s76, 106496
  buffer_load_dwordx4 v[216:219], v16, s[52:55], s76 offen sc1
  v_mfma_f32_32x32x16_bf16 v[152:167], v[52:55], v[184:187], v[152:167]
  ds_read_b64_tr_b16 v[68:69], v9 offset:0
  ds_read_b64_tr_b16 v[70:71], v9 offset:1024
  s_waitcnt vmcnt(7) lgkmcnt(4)
  v_mfma_f32_32x32x16_bf16 v[136:151], v[56:59], v[188:191], v[136:151]
  ds_read_b64_tr_b16 v[48:49], v8 offset:8192
  ds_read_b64_tr_b16 v[50:51], v8 offset:9216
  s_mov_b32 s76, 110592
  buffer_load_dwordx4 v[220:223], v16, s[52:55], s76 offen sc1
  v_mfma_f32_32x32x16_bf16 v[152:167], v[60:63], v[188:191], v[152:167]
  ds_read_b64_tr_b16 v[52:53], v9 offset:8192
  ds_read_b64_tr_b16 v[54:55], v9 offset:9216
  s_barrier
  s_waitcnt vmcnt(7) lgkmcnt(4)
  v_mfma_f32_32x32x16_bf16 v[136:151], v[64:67], v[192:195], v[136:151]
  s_add_u32 m0, s61, 139264
  ds_read_b64_tr_b16 v[56:57], v8 offset:16384
  ds_read_b64_tr_b16 v[58:59], v8 offset:17408
  s_mov_b32 s75, 0
  buffer_load_dwordx4 v4, s[28:31], s75 offen lds
  v_mfma_f32_32x32x16_bf16 v[152:167], v[68:71], v[192:195], v[152:167]
  s_add_u32 m0, s61, 131072
  ds_read_b64_tr_b16 v[60:61], v9 offset:16384
  ds_read_b64_tr_b16 v[62:63], v9 offset:17408
  s_mov_b32 s75, 50176
  buffer_load_dwordx4 v4, s[28:31], s75 offen lds
  s_waitcnt vmcnt(8) lgkmcnt(4)
  v_mfma_f32_32x32x16_bf16 v[136:151], v[48:51], v[196:199], v[136:151]
  s_add_u32 m0, s61, 122880
  ds_read_b64_tr_b16 v[64:65], v8 offset:40960
  ds_read_b64_tr_b16 v[66:67], v8 offset:41984
  s_mov_b32 s75, 200704
  buffer_load_dwordx4 v4, s[28:31], s75 offen lds
  v_mfma_f32_32x32x16_bf16 v[152:167], v[52:55], v[196:199], v[152:167]
  ds_read_b64_tr_b16 v[68:69], v9 offset:40960
  ds_read_b64_tr_b16 v[70:71], v9 offset:41984
  s_barrier
  s_waitcnt vmcnt(8) lgkmcnt(4)
  v_mfma_f32_32x32x16_bf16 v[136:151], v[56:59], v[200:203], v[136:151]
  s_add_u32 m0, s61, 114688
  ds_read_b64_tr_b16 v[48:49], v8 offset:49152
  ds_read_b64_tr_b16 v[50:51], v8 offset:50176
  s_mov_b32 s75, 250880
  buffer_load_dwordx4 v4, s[28:31], s75 offen lds
  v_mfma_f32_32x32x16_bf16 v[152:167], v[60:63], v[200:203], v[152:167]
  ds_read_b64_tr_b16 v[52:53], v9 offset:49152
  ds_read_b64_tr_b16 v[54:55], v9 offset:50176
  s_waitcnt vmcnt(8) lgkmcnt(4)
  v_mfma_f32_32x32x16_bf16 v[136:151], v[64:67], v[204:207], v[136:151]
  s_add_u32 m0, s61, 106496
  ds_read_b64_tr_b16 v[56:57], v14 offset:16384
  ds_read_b64_tr_b16 v[58:59], v14 offset:17408
  s_mov_b32 s75, 100352
  buffer_load_dwordx4 v4, s[28:31], s75 offen lds
  v_mfma_f32_32x32x16_bf16 v[152:167], v[68:71], v[204:207], v[152:167]
  ds_read_b64_tr_b16 v[60:61], v15 offset:16384
  ds_read_b64_tr_b16 v[62:63], v15 offset:17408
  s_barrier
  s_cmp_lg_u32 s60, 2
  s_cbranch_scc1 Lpi_60
  s_mov_b32 s13, 0
  s_atomic_add s13, s[14:15], s85 offset:512 glc
Lpi_60:
  s_waitcnt vmcnt(8) lgkmcnt(4)
  v_mfma_f32_32x32x16_bf16 v[136:151], v[48:51], v[208:211], v[136:151]
  s_add_u32 m0, s61, 98304
  ds_read_b64_tr_b16 v[64:65], v6 offset:16384
  ds_read_b64_tr_b16 v[66:67], v6 offset:17408
  s_mov_b32 s75, 150528
  buffer_load_dwordx4 v4, s[28:31], s75 offen lds
  v_mfma_f32_32x32x16_bf16 v[152:167], v[52:55], v[208:211], v[152:167]
  s_add_u32 m0, s61, 90112
  ds_read_b64_tr_b16 v[68:69], v7 offset:16384
  ds_read_b64_tr_b16 v[70:71], v7 offset:17408
  s_mov_b32 s75, 301056
  buffer_load_dwordx4 v4, s[28:31], s75 offen lds
  s_waitcnt vmcnt(9) lgkmcnt(4)
  v_mfma_f32_32x32x16_bf16 v[136:151], v[56:59], v[212:215], v[136:151]
  s_add_u32 m0, s61, 73728
  ds_read_b64_tr_b16 v[48:49], v6 offset:24576
  ds_read_b64_tr_b16 v[50:51], v6 offset:25600
  s_mov_b32 s75, 351232
  buffer_load_dwordx4 v4, s[28:31], s75 offen lds
  v_mfma_f32_32x32x16_bf16 v[152:167], v[60:63], v[212:215], v[152:167]
  ds_read_b64_tr_b16 v[52:53], v7 offset:24576
  ds_read_b64_tr_b16 v[54:55], v7 offset:25600
  s_cmp_lg_u32 s60, 2
  s_cbranch_scc1 Lpc_61
  s_waitcnt lgkmcnt(0)
  s_cmp_ge_u32 s13, 2
  s_cbranch_scc1 Lpc_61
  s_mov_b32 s93, 0
Lsp_62:
  s_mov_b32 s13, 0
  s_atomic_add s13, s[14:15], s85 offset:512 glc
  s_add_u32 s93, s93, 1
  s_waitcnt lgkmcnt(0)
  s_cmp_ge_u32 s13, 2
  s_cbranch_scc1 Lpc_61
  s_cmp_lt_u32 s93, 20000
  s_cbranch_scc1 Lsp_62
Lpc_61:
  s_waitcnt vmcnt(6)
  s_barrier
  s_cmp_lg_u32 s60, 3
  s_cbranch_scc1 Lpi_63
  s_mov_b32 s13, 0
  s_atomic_add s13, s[14:15], s85 offset:640 glc
Lpi_63:
  s_mov_b32 s76, 114688
  buffer_load_dwordx4 v[224:227], v16, s[52:55], s76 offen sc1
  s_waitcnt lgkmcnt(4)
  v_mfma_f32_32x32x16_bf16 v[136:151], v[64:67], v[216:219], v[136:151]
  s_lshr_b32 s77, s63, 1
  s_lshl_b32 s77, s77, 9
  v_subrev_u32 v8, s77, v8
  v_add_u32 v6, 131072, v8
  ds_read_b64_tr_b16 v[56:57], v6 offset:8192
  ds_read_b64_tr_b16 v[58:59], v6 offset:9216
  s_mov_b32 s76, 118784
  buffer_load_dwordx4 v[228:231], v16, s[52:55], s76 offen sc1
  v_mfma_f32_32x32x16_bf16 v[152:167], v[68:71], v[216:219], v[152:167]
  s_lshr_b32 s77, s63, 1
  s_lshl_b32 s77, s77, 9
  v_subrev_u32 v9, s77, v9
  v_add_u32 v7, 131072, v9
  ds_read_b64_tr_b16 v[60:61], v7 offset:8192
  ds_read_b64_tr_b16 v[62:63], v7 offset:9216
  s_mov_b32 s76, 131072
  buffer_load_dwordx4 v[232:235], v16, s[52:55], s76 offen sc1
  s_waitcnt lgkmcnt(4)
  v_mfma_f32_32x32x16_bf16 v[136:151], v[48:51], v[220:223], v[136:151]
  ds_read_b64_tr_b16 v[64:65], v6 offset:0
  ds_read_b64_tr_b16 v[66:67], v6 offset:1024
  s_mov_b32 s76, 135168
  buffer_load_dwordx4 v[236:239], v16, s[52:55], s76 offen sc1
  v_mfma_f32_32x32x16_bf16 v[152:167], v[52:55], v[220:223], v[152:167]
  ds_read_b64_tr_b16 v[68:69], v7 offset:0
  ds_read_b64_tr_b16 v[70:71], v7 offset:1024
  s_nop 4
  v_mul_f32 v136, v252, v136
  v_mul_f32 v137, v252, v137
  v_mul_f32 v138, v252, v138
  v_mul_f32 v139, v252, v139
  v_mul_f32 v140, v252, v140
  v_mul_f32 v141, v252, v141
  v_mul_f32 v142, v252, v142
  v_mul_f32 v143, v252, v143
  v_mul_f32 v144, v252, v144
  v_mul_f32 v145, v252, v145
  v_mul_f32 v146, v252, v146
  v_mul_f32 v147, v252, v147
  v_mul_f32 v148, v252, v148
  v_mul_f32 v149, v252, v149
  v_mul_f32 v150, v252, v150
  v_mul_f32 v151, v252, v151
  v_mul_f32 v152, v252, v152
  v_mul_f32 v153, v252, v153
  v_mul_f32 v154, v252, v154
  v_mul_f32 v155, v252, v155
  v_mul_f32 v156, v252, v156
  v_mul_f32 v157, v252, v157
  v_mul_f32 v158, v252, v158
  v_mul_f32 v159, v252, v159
  v_mul_f32 v160, v252, v160
  v_mul_f32 v161, v252, v161
  v_mul_f32 v162, v252, v162
  v_mul_f32 v163, v252, v163
  v_mul_f32 v164, v252, v164
  v_mul_f32 v165, v252, v165
  v_mul_f32 v166, v252, v166
  v_mul_f32 v167, v252, v167
  s_cmp_lg_u32 s60, 3
  s_cbranch_scc1 Lpc_64
  s_waitcnt lgkmcnt(0)
  s_cmp_ge_u32 s13, 2
  s_cbranch_scc1 Lpc_64
  s_mov_b32 s93, 0
Lsp_65:
  s_mov_b32 s13, 0
  s_atomic_add s13, s[14:15], s85 offset:640 glc
  s_add_u32 s93, s93, 1
  s_waitcnt lgkmcnt(0)
  s_cmp_ge_u32 s13, 2
  s_cbranch_scc1 Lpc_64
  s_cmp_lt_u32 s93, 20000
  s_cbranch_scc1 Lsp_65
Lpc_64:
  s_waitcnt vmcnt(4)
  s_barrier
  s_mov_b32 s76, 122880
  buffer_load_dwordx4 v[240:243], v16, s[52:55], s76 offen sc1
  s_waitcnt vmcnt(4) lgkmcnt(4)
  v_mfma_f32_32x32x16_bf16 v[136:151], v[56:59], v[224:227], v[136:151]
  v_add_u32 v14, 65536, v8
  ds_read_b64_tr_b16 v[48:49], v14 offset:57344
  ds_read_b64_tr_b16 v[50:51], v14 offset:58368
  s_mov_b32 s76, 126976
  buffer_load_dwordx4 v[244:247], v16, s[52:55], s76 offen sc1
  v_mfma_f32_32x32x16_bf16 v[152:167], v[60:63], v[224:227], v[152:167]
  v_add_u32 v15, 65536, v9
  ds_read_b64_tr_b16 v[52:53], v15 offset:57344
  ds_read_b64_tr_b16 v[54:55], v15 offset:58368
  s_mov_b32 s76, 139264
  buffer_load_dwordx4 v[168:171], v16, s[52:55], s76 offen sc1
  s_waitcnt vmcnt(5) lgkmcnt(4)
  v_mfma_f32_32x32x16_bf16 v[136:151], v[64:67], v[228:231], v[136:151]
  ds_read_b64_tr_b16 v[56:57], v14 offset:49152
  ds_read_b64_tr_b16 v[58:59], v14 offset:50176
  s_mov_b32 s76, 143360
  buffer_load_dwordx4 v[172:175], v16, s[52:55], s76 offen sc1
  v_mfma_f32_32x32x16_bf16 v[152:167], v[68:71], v[228:231], v[152:167]
  ds_read_b64_tr_b16 v[60:61], v15 offset:49152
  ds_read_b64_tr_b16 v[62:63], v15 offset:50176
  s_waitcnt vmcnt(5) lgkmcnt(4)
  v_mfma_f32_32x32x16_bf16 v[136:151], v[48:51], v[232:235], v[136:151]
  ds_read_b64_tr_b16 v[64:65], v14 offset:40960
  ds_read_b64_tr_b16 v[66:67], v14 offset:41984
  v_mfma_f32_32x32x16_bf16 v[152:167], v[52:55], v[232:235], v[152:167]
  ds_read_b64_tr_b16 v[68:69], v15 offset:40960
  ds_read_b64_tr_b16 v[70:71], v15 offset:41984
  s_waitcnt vmcnt(4) lgkmcnt(4)
  v_mfma_f32_32x32x16_bf16 v[136:151], v[56:59], v[236:239], v[136:151]
  ds_read_b64_tr_b16 v[48:49], v14 offset:32768
  ds_read_b64_tr_b16 v[50:51], v14 offset:33792
  v_mfma_f32_32x32x16_bf16 v[152:167], v[60:63], v[236:239], v[152:167]
  ds_read_b64_tr_b16 v[52:53], v15 offset:32768
  ds_read_b64_tr_b16 v[54:55], v15 offset:33792
  s_waitcnt vmcnt(3) lgkmcnt(4)
  v_mfma_f32_32x32x16_bf16 v[136:151], v[64:67], v[240:243], v[136:151]
  ds_read_b64_tr_b16 v[56:57], v14 offset:24576
  ds_read_b64_tr_b16 v[58:59], v14 offset:25600
  v_mfma_f32_32x32x16_bf16 v[152:167], v[68:71], v[240:243], v[152:167]
  ds_read_b64_tr_b16 v[60:61], v15 offset:24576
  ds_read_b64_tr_b16 v[62:63], v15 offset:25600
  s_waitcnt vmcnt(2) lgkmcnt(4)
  v_mfma_f32_32x32x16_bf16 v[136:151], v[48:51], v[244:247], v[136:151]
  ds_read_b64_tr_b16 v[64:65], v14 offset:8192
  ds_read_b64_tr_b16 v[66:67], v14 offset:9216
  v_mfma_f32_32x32x16_bf16 v[152:167], v[52:55], v[244:247], v[152:167]
  ds_read_b64_tr_b16 v[68:69], v15 offset:8192
  ds_read_b64_tr_b16 v[70:71], v15 offset:9216
  s_waitcnt vmcnt(1) lgkmcnt(4)
  v_mfma_f32_32x32x16_bf16 v[136:151], v[56:59], v[168:171], v[136:151]
  v_mfma_f32_32x32x16_bf16 v[152:167], v[60:63], v[168:171], v[152:167]
  s_waitcnt vmcnt(0) lgkmcnt(0)
  v_mfma_f32_32x32x16_bf16 v[136:151], v[64:67], v[172:175], v[136:151]
  v_mfma_f32_32x32x16_bf16 v[152:167], v[68:71], v[172:175], v[152:167]
  s_nop 10
  ds_write_b128 v22, v[136:139] offset:0
  ds_write_b128 v23, v[140:143] offset:0
  ds_write_b128 v24, v[144:147] offset:0
  ds_write_b128 v25, v[148:151] offset:0
  ds_write_b128 v22, v[152:155] offset:128
  ds_write_b128 v23, v[156:159] offset:128
  ds_write_b128 v24, v[160:163] offset:128
  ds_write_b128 v25, v[164:167] offset:128
  s_waitcnt lgkmcnt(0)
  s_barrier
  ds_read_b128 v[168:171], v26 offset:0
  ds_read_b128 v[172:175], v27 offset:0
  ds_read_b128 v[176:179], v26 offset:16384
  ds_read_b128 v[180:183], v27 offset:16384
  ds_read_b128 v[184:187], v26 offset:32768
  ds_read_b128 v[188:191], v27 offset:32768
  ds_read_b128 v[192:195], v26 offset:49152
  ds_read_b128 v[196:199], v27 offset:49152
  s_waitcnt lgkmcnt(4)
  v_pk_add_f32 v[168:169], v[168:169], v[176:177]
  v_pk_add_f32 v[170:171], v[170:171], v[178:179]
  v_pk_add_f32 v[172:173], v[172:173], v[180:181]
  v_pk_add_f32 v[174:175], v[174:175], v[182:183]
  s_waitcnt lgkmcnt(2)
  v_pk_add_f32 v[168:169], v[168:169], v[184:185]
  v_pk_add_f32 v[170:171], v[170:171], v[186:187]
  v_pk_add_f32 v[172:173], v[172:173], v[188:189]
  v_pk_add_f32 v[174:175], v[174:175], v[190:191]
  s_waitcnt lgkmcnt(0)
  v_pk_add_f32 v[168:169], v[168:169], v[192:193]
  v_pk_add_f32 v[170:171], v[170:171], v[194:195]
  v_pk_add_f32 v[172:173], v[172:173], v[196:197]
  v_pk_add_f32 v[174:175], v[174:175], v[198:199]
  v_cvt_pk_bf16_f32 v176, v168, v169
  v_cvt_pk_bf16_f32 v177, v170, v171
  v_cvt_pk_bf16_f32 v178, v172, v173
  v_cvt_pk_bf16_f32 v179, v174, v175
  buffer_store_dwordx4 v[176:179], v28, s[48:51], s86 offen
  s_endpgm
L_Q_end:
.fill (32768 - (. - L_far)) / 4, 4, 0xbf800000
L_KVQ:
  v_add_u32 v248, s61, v5
  v_mov_b32 v249, 0x7ffffff0
  v_cmp_gt_u32 vcc, 896, v248
  s_add_u32 m0, s61, 73728
  s_mov_b32 s75, 0
  v_cndmask_b32 v248, v249, v248, vcc
  buffer_load_dwordx4 v248, s[44:47], s75 offen lds
  s_add_u32 m0, s61, 16384
  s_nop 0
  buffer_load_dwordx4 v1, s[16:19], s69 offen lds
  s_add_u32 m0, s61, 24576
  s_add_u32 s76, s69, 57344
  buffer_load_dwordx4 v1, s[16:19], s76 offen lds
  s_add_u32 m0, s61, 81920
  s_mul_i32 s5, s69, 1344
  buffer_load_dwordx4 v3, s[20:23], s5 offen lds
  s_mov_b32 s88, 0x3fb8aa3b
  s_mov_b32 s90, 0xbfb8aa3b
  s_lshl2_add_u32 s80, s64, s63
  s_mul_i32 s80, s80, 145
  s_lshl1_add_u32 s80, s62, s80
  s_lshl_b32 s80, s80, 10
  s_lshl_b32 s84, s64, 10
  s_add_u32 s14, s52, 9830400
  s_addc_u32 s15, s53, 0
  v_lshl_add_u32 v26, v22, 2, v23
  s_lshl_b32 s79, s63, 11
  v_lshl_add_u32 v26, v26, 7, s79
  v_lshlrev_b32 v24, 3, v24
  v_xad_u32 v8, v24, v25, v26
  v_xor_b32 v9, 64, v8
  s_lshr_b32 s79, s2, 3
  s_lshr_b32 s12, s95, 1
  s_add_u32 s12, s12, 24
  s_cmp_lt_u32 s79, 24
  s_cselect_b32 s79, s79, s12
  s_and_b32 s12, s79, 3
  s_lshr_b32 s79, s79, 2
  s_lshl_b32 s82, s79, 7
  v_add_u32 v4, s82, v4
  s_and_b32 s79, s2, 7
  s_waitcnt vmcnt(3)
  s_barrier
  v_add_u32 v14, 65536, v7
  ds_read_b128 v[136:139], v10 offset:0
  ds_read_b128 v[140:143], v11 offset:0
  ds_read_b64_tr_b16 v[48:49], v14 offset:0
  ds_read_b64_tr_b16 v[50:51], v14 offset:512
  v_lshrrev_b32 v248, 5, v0
  s_add_u32 s77, s68, 73728
  v_lshl_add_u32 v15, v248, 4, s77
  ds_read_b128 v[52:55], v15 offset:0
  ds_read_b128 v[144:147], v12 offset:0
  ds_read_b128 v[148:151], v13 offset:0
  ds_read_b64_tr_b16 v[56:57], v14 offset:2048
  ds_read_b64_tr_b16 v[58:59], v14 offset:2560
  ds_read_b128 v[60:63], v15 offset:32
  s_waitcnt lgkmcnt(5)
  v_mfma_f32_32x32x16_bf16 v[72:87], v[48:51], v[136:139], 0
  s_add_u32 m0, s61, 90112
  ds_read_b64_tr_b16 v[64:65], v14 offset:4096
  ds_read_b64_tr_b16 v[66:67], v14 offset:4608
  v_add_u32 v248, s61, v5
  v_mov_b32 v249, 0x7ffffff0
  v_cmp_gt_u32 vcc, 3136, v248
  s_mul_i32 s75, s65, 3136
  s_nop 0
  v_cndmask_b32 v248, v249, v248, vcc
  buffer_load_dwordx4 v248, s[24:27], s75 offen lds
  s_lshl2_add_u32 s79, s79, s12
  s_mul_i32 s86, s79, 57344
  v_dot2_f32_bf16 v104, v52, v136, 0
  v_dot2_f32_bf16 v105, v53, v137, 0
  v_dot2_f32_bf16 v106, v54, v138, 0
  v_dot2_f32_bf16 v107, v55, v139, 0
  s_add_u32 m0, s61, 32768
  ds_read_b128 v[68:71], v15 offset:64
  buffer_load_dwordx4 v1, s[16:19], s70 offen lds
  s_add_u32 s86, s86, s82
  s_lshr_b32 s85, s79, 1
  s_waitcnt lgkmcnt(3)
  v_mfma_f32_32x32x16_bf16 v[72:87], v[56:59], v[140:143], v[72:87]
  s_add_u32 m0, s61, 40960
  ds_read_b64_tr_b16 v[48:49], v14 offset:6144
  ds_read_b64_tr_b16 v[50:51], v14 offset:6656
  s_add_u32 s76, s70, 57344
  buffer_load_dwordx4 v1, s[16:19], s76 offen lds
  s_lshl_b32 s85, s85, 10
  s_lshl1_add_u32 s79, s79, s62
  v_dot2_f32_bf16 v104, v60, v140, v104
  v_dot2_f32_bf16 v105, v61, v141, v105
  v_dot2_f32_bf16 v106, v62, v142, v106
  v_dot2_f32_bf16 v107, v63, v143, v107
  ds_read_b128 v[52:55], v15 offset:96
  s_lshl_b32 s96, s79, 7
  s_add_u32 s96, s96, 9764864
  s_mul_i32 s81, s79, 145
  s_add_u32 s81, s81, s63
  s_lshl_b32 s81, s81, 10
  s_waitcnt vmcnt(3)
  s_barrier
  s_or_b32 s77, s2, s60
  s_cbranch_scc1 Lz_66
  s_atomic_add s87, s[56:57], 0
Lz_66:
  s_waitcnt lgkmcnt(3)
  v_mfma_f32_32x32x16_bf16 v[72:87], v[64:67], v[144:147], v[72:87]
  s_add_u32 m0, s61, 98304
  v_add_u32 v14, 81920, v7
  ds_read_b128 v[152:155], v10 offset:16384
  ds_read_b128 v[156:159], v11 offset:16384
  ds_read_b64_tr_b16 v[56:57], v14 offset:0
  ds_read_b64_tr_b16 v[58:59], v14 offset:512
  s_mul_i32 s6, s70, 1344
  buffer_load_dwordx4 v3, s[20:23], s6 offen lds
  v_add_u32 v16, s81, v5
  s_lshl_b32 s92, s65, 7
  v_dot2_f32_bf16 v104, v68, v144, v104
  v_dot2_f32_bf16 v105, v69, v145, v105
  v_dot2_f32_bf16 v106, v70, v146, v106
  v_dot2_f32_bf16 v107, v71, v147, v107
  v_lshrrev_b32 v248, 5, v0
  s_add_u32 s77, s69, 73728
  v_lshl_add_u32 v15, v248, 4, s77
  ds_read_b128 v[60:63], v15 offset:0
  s_add_u32 s92, s92, 16384
  s_lshl_b32 s94, s65, 17
  s_add_u32 s94, s94, 10485760
  v_lshrrev_b32 v22, 5, v0
  v_bfe_u32 v23, v0, 2, 2
  s_waitcnt lgkmcnt(5)
  v_mfma_f32_32x32x16_bf16 v[72:87], v[48:51], v[148:151], v[72:87]
  s_add_u32 m0, s61, 0
  ds_read_b128 v[160:163], v12 offset:16384
  ds_read_b128 v[164:167], v13 offset:16384
  ds_read_b64_tr_b16 v[64:65], v14 offset:2048
  ds_read_b64_tr_b16 v[66:67], v14 offset:2560
  buffer_load_dwordx4 v1, s[16:19], s71 offen lds
  v_xor_b32 v24, v22, v23
  v_bfe_u32 v25, v0, 1, 1
  v_dot2_f32_bf16 v104, v52, v148, v104
  v_dot2_f32_bf16 v105, v53, v149, v105
  v_dot2_f32_bf16 v106, v54, v150, v106
  v_dot2_f32_bf16 v107, v55, v151, v107
  ds_read_b128 v[68:71], v15 offset:32
  v_lshl_or_b32 v24, v25, 3, v24
  v_and_b32 v25, 31, v0
  v_lshl_or_b32 v24, v25, 4, v24
  v_lshlrev_b32 v24, 3, v24
  s_lshl_b32 s79, s61, 2
  s_waitcnt lgkmcnt(5)
  v_mfma_f32_32x32x16_bf16 v[72:87], v[56:59], v[152:155], v[72:87]
  s_add_u32 m0, s61, 8192
  ds_read_b64_tr_b16 v[48:49], v14 offset:4096
  ds_read_b64_tr_b16 v[50:51], v14 offset:4608
  s_add_u32 s76, s71, 57344
  buffer_load_dwordx4 v1, s[16:19], s76 offen lds
  v_add_u32 v19, s79, v24
  v_lshl_add_u32 v24, v22, 2, v23
  v_dot2_f32_bf16 v104, v60, v152, v104
  v_dot2_f32_bf16 v105, v61, v153, v105
  v_dot2_f32_bf16 v106, v62, v154, v106
  v_dot2_f32_bf16 v107, v63, v155, v107
  ds_read_b128 v[52:55], v15 offset:64
  v_and_b32 v25, 3, v0
  v_xor_b32 v25, v25, v22
  v_bfe_u32 v22, v0, 4, 1
  v_and_b32 v23, 2, v23
  v_or_b32 v22, v22, v23
  s_waitcnt lgkmcnt(3)
  v_mfma_f32_32x32x16_bf16 v[72:87], v[64:67], v[156:159], v[72:87]
  s_add_u32 m0, s61, 106496
  ds_read_b64_tr_b16 v[56:57], v14 offset:6144
  ds_read_b64_tr_b16 v[58:59], v14 offset:6656
  s_mul_i32 s7, s71, 1344
  buffer_load_dwordx4 v3, s[20:23], s7 offen lds
  v_xor_b32 v22, s63, v22
  v_lshl_or_b32 v25, v22, 2, v25
  v_dot2_f32_bf16 v104, v68, v156, v104
  v_dot2_f32_bf16 v105, v69, v157, v105
  v_dot2_f32_bf16 v106, v70, v158, v106
  v_dot2_f32_bf16 v107, v71, v159, v107
  ds_read_b128 v[60:63], v15 offset:96
  v_lshl_or_b32 v25, v24, 4, v25
  v_lshlrev_b32 v25, 3, v25
  s_lshl_b32 s79, s62, 14
  v_add_u32 v17, s79, v25
  s_lshl_b32 s79, s62, 13
  s_waitcnt vmcnt(3)
  s_barrier
  s_waitcnt lgkmcnt(3)
  v_mfma_f32_32x32x16_bf16 v[72:87], v[48:51], v[160:163], v[72:87]
  v_add_u32 v14, 98304, v7
  ds_read_b128 v[168:171], v10 offset:32768
  ds_read_b128 v[172:175], v11 offset:32768
  ds_read_b64_tr_b16 v[64:65], v14 offset:0
  ds_read_b64_tr_b16 v[66:67], v14 offset:512
  v_lshrrev_b32 v248, 5, v0
  v_bfe_u32 v249, v0, 2, 2
  v_lshl_add_u32 v248, v248, 2, v249
  v_mul_u32_u24 v248, 56, v248
  v_bfe_u32 v249, v0, 4, 1
  v_and_b32 v250, 3, v0
  v_lshl_add_u32 v249, v249, 2, v250
  v_min_u32 v249, 6, v249
  v_lshl_add_u32 v248, v249, 3, v248
  s_mul_i32 s77, s62, 1568
  v_add_u32 v248, s77, v248
  v_add_u32 v248, 90112, v248
  ds_read_b64_tr_b16 v[40:41], v248 offset:0
  ds_read_b64_tr_b16 v[42:43], v248 offset:448
  ds_read_b64_tr_b16 v[44:45], v248 offset:896
  ds_read_b64_tr_b16 v[46:47], v248 offset:1344
  s_add_u32 m0, s61, 16384
  s_nop 0
  buffer_load_dwordx4 v1, s[16:19], s72 offen lds
  v_dot2_f32_bf16 v104, v52, v160, v104
  v_dot2_f32_bf16 v105, v53, v161, v105
  v_dot2_f32_bf16 v106, v54, v162, v106
  v_dot2_f32_bf16 v107, v55, v163, v107
  s_add_u32 m0, s61, 24576
  v_lshrrev_b32 v248, 5, v0
  s_add_u32 s77, s70, 73728
  v_lshl_add_u32 v15, v248, 4, s77
  ds_read_b128 v[68:71], v15 offset:0
  s_add_u32 s76, s72, 57344
  buffer_load_dwordx4 v1, s[16:19], s76 offen lds
  v_add_u32 v18, s79, v5
  s_waitcnt lgkmcnt(9)
  v_mfma_f32_32x32x16_bf16 v[72:87], v[56:59], v[164:167], v[72:87]
  ds_read_b128 v[176:179], v12 offset:32768
  ds_read_b128 v[180:183], v13 offset:32768
  ds_read_b64_tr_b16 v[48:49], v14 offset:2048
  ds_read_b64_tr_b16 v[50:51], v14 offset:2560
  v_dot2_f32_bf16 v104, v60, v164, v104
  v_dot2_f32_bf16 v105, v61, v165, v105
  v_dot2_f32_bf16 v106, v62, v166, v106
  v_dot2_f32_bf16 v107, v63, v167, v107
  s_add_u32 m0, s61, 65536
  s_waitcnt lgkmcnt(12)
  ds_read_b128 v[52:55], v15 offset:32
  s_mul_i32 s8, s72, 1344
  buffer_load_dwordx4 v3, s[20:23], s8 offen lds
  s_waitcnt lgkmcnt(5)
  v_mfma_f32_32x32x16_bf16 v[72:87], v[64:67], v[168:171], v[72:87]
  s_add_u32 m0, s61, 49152
  ds_read_b64_tr_b16 v[56:57], v14 offset:4096
  ds_read_b64_tr_b16 v[58:59], v14 offset:4608
  buffer_load_dwordx4 v1, s[16:19], s73 offen lds
  v_dot2_f32_bf16 v104, v68, v168, v104
  v_dot2_f32_bf16 v105, v69, v169, v105
  v_dot2_f32_bf16 v106, v70, v170, v106
  v_dot2_f32_bf16 v107, v71, v171, v107
  ds_read_b128 v[60:63], v15 offset:64
  s_waitcnt lgkmcnt(3)
  v_mfma_f32_32x32x16_bf16 v[72:87], v[48:51], v[172:175], v[72:87]
  s_add_u32 m0, s61, 57344
  ds_read_b64_tr_b16 v[64:65], v14 offset:6144
  ds_read_b64_tr_b16 v[66:67], v14 offset:6656
  s_add_u32 s76, s73, 57344
  buffer_load_dwordx4 v1, s[16:19], s76 offen lds
  v_dot2_f32_bf16 v104, v52, v172, v104
  v_dot2_f32_bf16 v105, v53, v173, v105
  v_dot2_f32_bf16 v106, v54, v174, v106
  v_dot2_f32_bf16 v107, v55, v175, v107
  ds_read_b128 v[68:71], v15 offset:96
  s_waitcnt vmcnt(5)
  s_barrier
  s_waitcnt lgkmcnt(3)
  v_mfma_f32_32x32x16_bf16 v[72:87], v[56:59], v[176:179], v[72:87]
  s_add_u32 m0, s61, 81920
  v_add_u32 v14, 106496, v7
  ds_read_b128 v[184:187], v10 offset:0
  ds_read_b128 v[188:191], v11 offset:0
  ds_read_b64_tr_b16 v[48:49], v14 offset:0
  ds_read_b64_tr_b16 v[50:51], v14 offset:512
  s_mul_i32 s9, s73, 1344
  buffer_load_dwordx4 v3, s[20:23], s9 offen lds
  v_dot2_f32_bf16 v104, v60, v176, v104
  v_dot2_f32_bf16 v105, v61, v177, v105
  v_dot2_f32_bf16 v106, v62, v178, v106
  v_dot2_f32_bf16 v107, v63, v179, v107
  v_lshrrev_b32 v248, 5, v0
  s_add_u32 s77, s71, 73728
  v_lshl_add_u32 v15, v248, 4, s77
  ds_read_b128 v[52:55], v15 offset:0
  s_waitcnt lgkmcnt(5)
  v_mfma_f32_32x32x16_bf16 v[72:87], v[64:67], v[180:183], v[72:87]
  s_add_u32 m0, s61, 32768
  ds_read_b128 v[192:195], v12 offset:0
  ds_read_b128 v[196:199], v13 offset:0
  ds_read_b64_tr_b16 v[56:57], v14 offset:2048
  ds_read_b64_tr_b16 v[58:59], v14 offset:2560
  buffer_load_dwordx4 v1, s[16:19], s74 offen lds
  v_dot2_f32_bf16 v104, v68, v180, v104
  v_dot2_f32_bf16 v105, v69, v181, v105
  v_dot2_f32_bf16 v106, v70, v182, v106
  v_dot2_f32_bf16 v107, v71, v183, v107
  ds_read_b128 v[60:63], v15 offset:32
  s_waitcnt lgkmcnt(5)
  v_mfma_f32_32x32x16_bf16 v[72:87], v[48:51], v[184:187], v[72:87]
  ds_read_b64_tr_b16 v[64:65], v14 offset:4096
  ds_read_b64_tr_b16 v[66:67], v14 offset:4608
  v_dot2_f32_bf16 v104, v52, v184, v104
  v_dot2_f32_bf16 v105, v53, v185, v105
  v_dot2_f32_bf16 v106, v54, v186, v106
  v_dot2_f32_bf16 v107, v55, v187, v107
  s_add_u32 m0, s61, 40960
  ds_read_b128 v[68:71], v15 offset:64
  s_add_u32 s76, s74, 57344
  buffer_load_dwordx4 v1, s[16:19], s76 offen lds
  s_waitcnt lgkmcnt(3)
  v_mfma_f32_32x32x16_bf16 v[72:87], v[56:59], v[188:191], v[72:87]
  ds_read_b64_tr_b16 v[48:49], v14 offset:6144
  ds_read_b64_tr_b16 v[50:51], v14 offset:6656
  v_dot2_f32_bf16 v104, v60, v188, v104
  v_dot2_f32_bf16 v105, v61, v189, v105
  v_dot2_f32_bf16 v106, v62, v190, v106
  v_dot2_f32_bf16 v107, v63, v191, v107
  ds_read_b128 v[52:55], v15 offset:96
  s_waitcnt vmcnt(5)
  s_barrier
  s_waitcnt lgkmcnt(3)
  v_mfma_f32_32x32x16_bf16 v[72:87], v[64:67], v[192:195], v[72:87]
  s_add_u32 m0, s61, 155648
  v_add_u32 v14, 65536, v7
  ds_read_b128 v[200:203], v10 offset:16384
  ds_read_b128 v[204:207], v11 offset:16384
  ds_read_b64_tr_b16 v[56:57], v14 offset:0
  ds_read_b64_tr_b16 v[58:59], v14 offset:512
  s_mul_i32 s10, s74, 1344
  buffer_load_dwordx4 v3, s[20:23], s10 offen lds
  v_dot2_f32_bf16 v104, v68, v192, v104
  v_dot2_f32_bf16 v105, v69, v193, v105
  v_dot2_f32_bf16 v106, v70, v194, v106
  v_dot2_f32_bf16 v107, v71, v195, v107
  v_lshrrev_b32 v248, 5, v0
  s_add_u32 s77, s72, 73728
  v_lshl_add_u32 v15, v248, 4, s77
  ds_read_b128 v[60:63], v15 offset:0
  s_waitcnt lgkmcnt(5)
  v_mfma_f32_32x32x16_bf16 v[72:87], v[48:51], v[196:199], v[72:87]
  s_add_u32 m0, s61, 147456
  ds_read_b128 v[208:211], v12 offset:16384
  ds_read_b128 v[212:215], v13 offset:16384
  ds_read_b64_tr_b16 v[64:65], v14 offset:2048
  ds_read_b64_tr_b16 v[66:67], v14 offset:2560
  v_add_u32 v3, 896, v3
  s_mul_i32 s4, s68, 1344
  buffer_load_dwordx4 v3, s[20:23], s4 offen lds
  v_dot2_f32_bf16 v104, v52, v196, v104
  v_dot2_f32_bf16 v105, v53, v197, v105
  v_dot2_f32_bf16 v106, v54, v198, v106
  v_dot2_f32_bf16 v107, v55, v199, v107
  ds_read_b128 v[68:71], v15 offset:32
  s_waitcnt lgkmcnt(5)
  v_mfma_f32_32x32x16_bf16 v[72:87], v[56:59], v[200:203], v[72:87]
  ds_read_b64_tr_b16 v[48:49], v14 offset:4096
  ds_read_b64_tr_b16 v[50:51], v14 offset:4608
  v_dot2_f32_bf16 v104, v60, v200, v104
  v_dot2_f32_bf16 v105, v61, v201, v105
  v_dot2_f32_bf16 v106, v62, v202, v106
  v_dot2_f32_bf16 v107, v63, v203, v107
  s_add_u32 m0, s61, 139264
  ds_read_b128 v[52:55], v15 offset:64
  buffer_load_dwordx4 v3, s[20:23], s5 offen lds
  s_waitcnt lgkmcnt(3)
  v_mfma_f32_32x32x16_bf16 v[72:87], v[64:67], v[204:207], v[72:87]
  ds_read_b64_tr_b16 v[56:57], v14 offset:6144
  ds_read_b64_tr_b16 v[58:59], v14 offset:6656
  v_dot2_f32_bf16 v104, v68, v204, v104
  v_dot2_f32_bf16 v105, v69, v205, v105
  v_dot2_f32_bf16 v106, v70, v206, v106
  v_dot2_f32_bf16 v107, v71, v207, v107
  ds_read_b128 v[60:63], v15 offset:96
  s_waitcnt vmcnt(5)
  s_barrier
  s_waitcnt lgkmcnt(3)
  v_mfma_f32_32x32x16_bf16 v[72:87], v[48:51], v[208:211], v[72:87]
  s_add_u32 m0, s61, 0
  v_add_u32 v14, 81920, v7
  ds_read_b128 v[216:219], v10 offset:49152
  ds_read_b128 v[220:223], v11 offset:49152
  ds_read_b64_tr_b16 v[64:65], v14 offset:0
  ds_read_b64_tr_b16 v[66:67], v14 offset:512
  buffer_load_dwordx4 v3, s[20:23], s6 offen lds
  v_dot2_f32_bf16 v104, v52, v208, v104
  v_dot2_f32_bf16 v105, v53, v209, v105
  v_dot2_f32_bf16 v106, v54, v210, v106
  v_dot2_f32_bf16 v107, v55, v211, v107
  v_lshrrev_b32 v248, 5, v0
  s_add_u32 s77, s73, 73728
  v_lshl_add_u32 v15, v248, 4, s77
  ds_read_b128 v[68:71], v15 offset:0
  s_waitcnt lgkmcnt(5)
  v_mfma_f32_32x32x16_bf16 v[72:87], v[56:59], v[212:215], v[72:87]
  s_add_u32 m0, s61, 8192
  ds_read_b128 v[224:227], v12 offset:49152
  ds_read_b128 v[228:231], v13 offset:49152
  ds_read_b64_tr_b16 v[48:49], v14 offset:2048
  ds_read_b64_tr_b16 v[50:51], v14 offset:2560
  buffer_load_dwordx4 v3, s[20:23], s7 offen lds
  v_dot2_f32_bf16 v104, v60, v212, v104
  v_dot2_f32_bf16 v105, v61, v213, v105
  v_dot2_f32_bf16 v106, v62, v214, v106
  v_dot2_f32_bf16 v107, v63, v215, v107
  ds_read_b128 v[52:55], v15 offset:32
  s_waitcnt lgkmcnt(5)
  v_mfma_f32_32x32x16_bf16 v[72:87], v[64:67], v[216:219], v[72:87]
  ds_read_b64_tr_b16 v[56:57], v14 offset:4096
  ds_read_b64_tr_b16 v[58:59], v14 offset:4608
  v_dot2_f32_bf16 v104, v68, v216, v104
  v_dot2_f32_bf16 v105, v69, v217, v105
  v_dot2_f32_bf16 v106, v70, v218, v106
  v_dot2_f32_bf16 v107, v71, v219, v107
  s_add_u32 m0, s61, 16384
  ds_read_b128 v[60:63], v15 offset:64
  buffer_load_dwordx4 v3, s[20:23], s8 offen lds
  s_waitcnt lgkmcnt(3)
  v_mfma_f32_32x32x16_bf16 v[72:87], v[48:51], v[220:223], v[72:87]
  ds_read_b64_tr_b16 v[64:65], v14 offset:6144
  ds_read_b64_tr_b16 v[66:67], v14 offset:6656
  v_dot2_f32_bf16 v104, v52, v220, v104
  v_dot2_f32_bf16 v105, v53, v221, v105
  v_dot2_f32_bf16 v106, v54, v222, v106
  v_dot2_f32_bf16 v107, v55, v223, v107
  ds_read_b128 v[68:71], v15 offset:96
  s_waitcnt vmcnt(5)
  s_barrier
  s_waitcnt lgkmcnt(3)
  v_mfma_f32_32x32x16_bf16 v[72:87], v[56:59], v[224:227], v[72:87]
  v_add_u32 v14, 155648, v7
  ds_read_b128 v[232:235], v10 offset:32768
  ds_read_b128 v[236:239], v11 offset:32768
  ds_read_b64_tr_b16 v[48:49], v14 offset:0
  ds_read_b64_tr_b16 v[50:51], v14 offset:512
  s_cmp_lg_u32 s60, 0
  s_cbranch_scc1 Lpi_67
  buffer_load_dword v20, off, s[56:59], 0 sc1
Lpi_67:
  s_add_u32 m0, s61, 24576
  s_nop 0
  buffer_load_dwordx4 v3, s[20:23], s9 offen lds
  v_dot2_f32_bf16 v104, v60, v224, v104
  v_dot2_f32_bf16 v105, v61, v225, v105
  v_dot2_f32_bf16 v106, v62, v226, v106
  v_dot2_f32_bf16 v107, v63, v227, v107
  v_lshrrev_b32 v248, 5, v0
  s_add_u32 s77, s74, 73728
  v_lshl_add_u32 v15, v248, 4, s77
  ds_read_b128 v[52:55], v15 offset:0
  s_waitcnt lgkmcnt(5)
  v_mfma_f32_32x32x16_bf16 v[72:87], v[64:67], v[228:231], v[72:87]
  ds_read_b128 v[240:243], v12 offset:32768
  ds_read_b128 v[244:247], v13 offset:32768
  ds_read_b64_tr_b16 v[56:57], v14 offset:2048
  ds_read_b64_tr_b16 v[58:59], v14 offset:2560
  v_dot2_f32_bf16 v104, v68, v228, v104
  v_dot2_f32_bf16 v105, v69, v229, v105
  v_dot2_f32_bf16 v106, v70, v230, v106
  v_dot2_f32_bf16 v107, v71, v231, v107
  ds_read_b128 v[60:63], v15 offset:32
  s_waitcnt lgkmcnt(5)
  v_mfma_f32_32x32x16_bf16 v[72:87], v[48:51], v[232:235], v[72:87]
  s_add_u32 m0, s61, 131072
  ds_read_b64_tr_b16 v[64:65], v14 offset:4096
  ds_read_b64_tr_b16 v[66:67], v14 offset:4608
  buffer_load_dwordx4 v3, s[20:23], s10 offen lds
  v_dot2_f32_bf16 v104, v52, v232, v104
  v_dot2_f32_bf16 v105, v53, v233, v105
  v_dot2_f32_bf16 v106, v54, v234, v106
  v_dot2_f32_bf16 v107, v55, v235, v107
  ds_read_b128 v[68:71], v15 offset:64
  s_waitcnt lgkmcnt(3)
  v_mfma_f32_32x32x16_bf16 v[72:87], v[56:59], v[236:239], v[72:87]
  ds_read_b64_tr_b16 v[48:49], v14 offset:6144
  ds_read_b64_tr_b16 v[50:51], v14 offset:6656
  v_dot2_f32_bf16 v104, v60, v236, v104
  v_dot2_f32_bf16 v105, v61, v237, v105
  v_dot2_f32_bf16 v106, v62, v238, v106
  v_dot2_f32_bf16 v107, v63, v239, v107
  ds_read_b128 v[52:55], v15 offset:96
  s_waitcnt vmcnt(3)
  s_barrier
  s_waitcnt lgkmcnt(3)
  v_mfma_f32_32x32x16_bf16 v[72:87], v[64:67], v[240:243], v[72:87]
  s_add_u32 m0, s61, 122880
  v_add_u32 v14, 147456, v7
  ds_read_b64_tr_b16 v[56:57], v14 offset:0
  ds_read_b64_tr_b16 v[58:59], v14 offset:512
  s_mul_i32 s4, s68, 1792
  buffer_load_dwordx4 v2, s[32:35], s4 offen lds
  v_dot2_f32_bf16 v104, v68, v240, v104
  v_dot2_f32_bf16 v105, v69, v241, v105
  v_dot2_f32_bf16 v106, v70, v242, v106
  v_dot2_f32_bf16 v107, v71, v243, v107
  ds_read_b64_tr_b16 v[60:61], v14 offset:2048
  ds_read_b64_tr_b16 v[62:63], v14 offset:2560
  s_waitcnt lgkmcnt(4)
  v_mfma_f32_32x32x16_bf16 v[72:87], v[48:51], v[244:247], v[72:87]
  ds_read_b64_tr_b16 v[64:65], v14 offset:4096
  ds_read_b64_tr_b16 v[66:67], v14 offset:4608
  s_cmp_lg_u32 s60, 2
  s_cbranch_scc1 Lt_68
  v_lshlrev_b32 v253, 7, v0
  s_lshr_b32 s75, s2, 3
  s_lshr_b32 s76, s95, 1
  s_add_u32 s76, s76, 24
  s_min_u32 s76, s76, s75
  s_and_b32 s75, s2, 7
  s_lshl3_add_u32 s76, s76, s75
  s_mul_i32 s75, s76, 12544
  s_bfm_b64 exec, 49, 0
  buffer_load_dword v20, v253, s[40:43], s75 offen
  s_add_u32 s75, s75, 6272
  buffer_load_dword v20, v253, s[40:43], s75 offen
  s_mul_i32 s75, s76, 3200
  s_bfm_b64 exec, 25, 0
  buffer_load_dword v20, v253, s[28:31], s75 offen
  s_mov_b64 exec, -1
Lt_68:
  v_dot2_f32_bf16 v104, v52, v244, v104
  v_dot2_f32_bf16 v105, v53, v245, v105
  v_dot2_f32_bf16 v106, v54, v246, v106
  v_dot2_f32_bf16 v107, v55, v247, v107
  ds_read_b64_tr_b16 v[68:69], v14 offset:6144
  ds_read_b64_tr_b16 v[70:71], v14 offset:6656
  s_waitcnt lgkmcnt(4)
  v_mfma_f32_32x32x16_bf16 v[120:135], v[136:139], v[56:59], 0
  s_add_u32 m0, s61, 114688
  v_add_u32 v14, 139264, v7
  ds_read_b64_tr_b16 v[48:49], v14 offset:0
  ds_read_b64_tr_b16 v[50:51], v14 offset:512
  buffer_load_dwordx4 v2, s[36:39], s4 offen lds
  v_mfma_f32_32x32x16_bf16 v[120:135], v[140:143], v[60:63], v[120:135]
  ds_read_b64_tr_b16 v[52:53], v14 offset:2048
  ds_read_b64_tr_b16 v[54:55], v14 offset:2560
  s_waitcnt lgkmcnt(4)
  v_mfma_f32_32x32x16_bf16 v[120:135], v[144:147], v[64:67], v[120:135]
  s_add_u32 m0, s61, 106496
  ds_read_b64_tr_b16 v[56:57], v14 offset:4096
  ds_read_b64_tr_b16 v[58:59], v14 offset:4608
  s_mul_i32 s5, s69, 1792
  buffer_load_dwordx4 v2, s[32:35], s5 offen lds
  v_cvt_pk_bf16_f32 v22, v72, v73
  v_cvt_pk_bf16_f32 v23, v74, v75
  v_cvt_pk_bf16_f32 v24, v76, v77
  v_cvt_pk_bf16_f32 v25, v78, v79
  v_mfma_f32_32x32x16_bf16 v[120:135], v[148:151], v[68:71], v[120:135]
  ds_read_b64_tr_b16 v[60:61], v14 offset:6144
  ds_read_b64_tr_b16 v[62:63], v14 offset:6656
  v_cvt_pk_bf16_f32 v26, v80, v81
  v_cvt_pk_bf16_f32 v27, v82, v83
  v_cvt_pk_bf16_f32 v28, v84, v85
  v_cvt_pk_bf16_f32 v29, v86, v87
  s_mov_b32 exec_lo, 0
  v_mov_b32 v46, 0
  v_mov_b32 v47, 0
  s_mov_b32 exec_lo, -1
  v_mfma_f32_32x32x16_bf16 v[88:103], v[40:43], v[22:25], 0
  v_mfma_f32_32x32x16_bf16 v[88:103], v[44:47], v[26:29], v[88:103]
  s_waitcnt lgkmcnt(4)
  v_mfma_f32_32x32x16_bf16 v[120:135], v[152:155], v[48:51], v[120:135]
  v_add_u32 v14, 0, v7
  ds_read_b64_tr_b16 v[64:65], v14 offset:0
  ds_read_b64_tr_b16 v[66:67], v14 offset:512
  v_bfe_i32 v36, v0, 5, 1
  v_and_b32 v36, 0xf149f2ca, v36
  v_mfma_f32_32x32x16_bf16 v[120:135], v[156:159], v[52:55], v[120:135]
  s_add_u32 m0, s61, 98304
  ds_read_b64_tr_b16 v[68:69], v14 offset:2048
  ds_read_b64_tr_b16 v[70:71], v14 offset:2560
  buffer_load_dwordx4 v2, s[36:39], s5 offen lds
  v_max3_f32 v30, v88, v89, v90
  v_min3_f32 v31, v88, v89, v90
  v_max3_f32 v30, v30, v91, v92
  v_min3_f32 v31, v31, v91, v92
  v_max3_f32 v30, v30, v93, v94
  s_waitcnt lgkmcnt(4)
  v_mfma_f32_32x32x16_bf16 v[120:135], v[160:163], v[56:59], v[120:135]
  ds_read_b64_tr_b16 v[48:49], v14 offset:4096
  ds_read_b64_tr_b16 v[50:51], v14 offset:4608
  v_min3_f32 v31, v31, v93, v94
  v_max3_f32 v30, v30, v95, v96
  v_min3_f32 v31, v31, v95, v96
  v_max3_f32 v30, v30, v97, v98
  v_min3_f32 v31, v31, v97, v98
  v_max3_f32 v30, v30, v99, v100
  v_min3_f32 v31, v31, v99, v100
  v_max3_f32 v30, v30, v101, v102
  v_min3_f32 v31, v31, v101, v102
  v_max_f32 v30, v30, v103
  v_mfma_f32_32x32x16_bf16 v[120:135], v[164:167], v[60:63], v[120:135]
  s_add_u32 m0, s61, 90112
  ds_read_b64_tr_b16 v[52:53], v14 offset:6144
  ds_read_b64_tr_b16 v[54:55], v14 offset:6656
  s_mul_i32 s6, s70, 1792
  buffer_load_dwordx4 v2, s[32:35], s6 offen lds
  v_min_f32 v31, v31, v103
  v_mov_b32 v32, v30
  v_mov_b32 v33, v31
  s_nop 0
  v_permlane32_swap_b32 v30, v32
  v_permlane32_swap_b32 v31, v33
  v_max_f32 v30, v30, v32
  v_min_f32 v31, v31, v33
  s_waitcnt lgkmcnt(4)
  v_mfma_f32_32x32x16_bf16 v[120:135], v[168:171], v[64:67], v[120:135]
  v_add_u32 v14, 8192, v7
  ds_read_b64_tr_b16 v[56:57], v14 offset:0
  ds_read_b64_tr_b16 v[58:59], v14 offset:512
  v_mul_f32 v34, s90, v30
  v_mul_f32 v35, s88, v31
  v_add_f32 v37, v35, v36
  v_add_f32 v36, v34, v36
  v_fma_f32 v72, v88, s88, v34
  v_fma_f32 v73, v89, s88, v34
  v_fma_f32 v88, v88, s90, v35
  v_fma_f32 v89, v89, s90, v35
  v_fma_f32 v74, v90, s88, v34
  v_fma_f32 v75, v91, s88, v34
  v_mfma_f32_32x32x16_bf16 v[120:135], v[172:175], v[68:71], v[120:135]
  s_add_u32 m0, s61, 81920
  ds_read_b64_tr_b16 v[60:61], v14 offset:2048
  ds_read_b64_tr_b16 v[62:63], v14 offset:2560
  buffer_load_dwordx4 v2, s[36:39], s6 offen lds
  v_fma_f32 v90, v90, s90, v35
  v_fma_f32 v91, v91, s90, v35
  v_fma_f32 v76, v92, s88, v34
  v_fma_f32 v77, v93, s88, v34
  v_fma_f32 v92, v92, s90, v35
  v_fma_f32 v93, v93, s90, v35
  v_fma_f32 v78, v94, s88, v34
  s_waitcnt lgkmcnt(4)
  v_mfma_f32_32x32x16_bf16 v[120:135], v[176:179], v[48:51], v[120:135]
  ds_read_b64_tr_b16 v[64:65], v14 offset:4096
  ds_read_b64_tr_b16 v[66:67], v14 offset:4608
  v_fma_f32 v79, v95, s88, v34
  v_fma_f32 v94, v94, s90, v35
  v_fma_f32 v95, v95, s90, v35
  v_fma_f32 v80, v96, s88, v34
  v_fma_f32 v81, v97, s88, v34
  v_fma_f32 v96, v96, s90, v35
  v_fma_f32 v97, v97, s90, v35
  v_fma_f32 v82, v98, s88, v34
  v_fma_f32 v83, v99, s88, v34
  v_fma_f32 v98, v98, s90, v35
  v_mfma_f32_32x32x16_bf16 v[120:135], v[180:183], v[52:55], v[120:135]
  ds_read_b64_tr_b16 v[68:69], v14 offset:6144
  ds_read_b64_tr_b16 v[70:71], v14 offset:6656
  v_fma_f32 v99, v99, s90, v35
  v_fma_f32 v84, v100, s88, v36
  v_fma_f32 v85, v101, s88, v36
  v_fma_f32 v100, v100, s90, v37
  v_fma_f32 v101, v101, s90, v37
  v_fma_f32 v86, v102, s88, v36
  v_fma_f32 v87, v103, s88, v36
  v_fma_f32 v102, v102, s90, v37
  v_fma_f32 v103, v103, s90, v37
  s_cmp_lg_u32 s60, 0
  s_cbranch_scc1 Lpc_69
  s_waitcnt vmcnt(8)
  v_readfirstlane_b32 s13, v20
  s_nop 0
  s_cmp_ge_u32 s13, 1
  s_cbranch_scc1 Lpc_69
  s_mov_b32 s93, 0
Lsp_70:
  buffer_load_dword v20, off, s[56:59], 0 sc1
  s_add_u32 s93, s93, 1
  s_waitcnt vmcnt(0)
  v_readfirstlane_b32 s13, v20
  s_nop 0
  s_cmp_ge_u32 s13, 1
  s_cbranch_scc1 Lpc_69
  s_cmp_lt_u32 s93, 20000
  s_cbranch_scc1 Lsp_70
Lpc_69:
  s_waitcnt vmcnt(6)
  s_barrier
  s_waitcnt lgkmcnt(4)
  v_mfma_f32_32x32x16_bf16 v[120:135], v[184:187], v[56:59], v[120:135]
  s_add_u32 m0, s61, 155648
  v_add_u32 v14, 16384, v7
  ds_read_b64_tr_b16 v[48:49], v14 offset:0
  ds_read_b64_tr_b16 v[50:51], v14 offset:512
  s_mul_i32 s7, s71, 1792
  buffer_load_dwordx4 v2, s[32:35], s7 offen lds
  v_exp_f32 v72, v72
  v_exp_f32 v88, v88
  v_exp_f32 v73, v73
  v_mfma_f32_32x32x16_bf16 v[120:135], v[188:191], v[60:63], v[120:135]
  ds_read_b64_tr_b16 v[52:53], v14 offset:2048
  ds_read_b64_tr_b16 v[54:55], v14 offset:2560
  v_exp_f32 v89, v89
  v_exp_f32 v74, v74
  v_exp_f32 v90, v90
  v_exp_f32 v75, v75
  v_exp_f32 v91, v91
  v_add_f32 v104, v104, v105
  v_add_f32 v106, v106, v107
  v_add_f32 v105, v104, v106
  v_add_f32 v104, v104, v106
  s_nop 1
  v_permlane32_swap_b32 v104, v105
  v_add_f32 v104, v104, v105
  v_mul_f32 v104, s90, v104
  v_exp_f32 v104, v104
  v_and_b32 v248, 31, v0
  v_lshlrev_b32 v248, 2, v248
  v_add_f32 v104, 1.0, v104
  v_rcp_f32 v104, v104
  s_lshl2_add_u32 s77, s64, s63
  s_lshl_b32 s77, s77, 7
  s_add_u32 s77, s77, 9764864
  s_xor_b32 s78, s65, s60
  s_cmp_lt_u32 s78, 2
  s_cselect_b32 s77, s77, 11538432
  s_mov_b32 exec_hi, 0
  v_sub_f32 v104, 1.0, v104
  s_not_b64 exec, exec
  v_add_u32 v248, 8192, v248
  s_mov_b64 exec, -1
  buffer_store_dword v104, v248, s[52:55], s77 offen sc1
  s_waitcnt lgkmcnt(4)
  v_mfma_f32_32x32x16_bf16 v[120:135], v[192:195], v[64:67], v[120:135]
  s_add_u32 m0, s61, 147456
  ds_read_b64_tr_b16 v[56:57], v14 offset:4096
  ds_read_b64_tr_b16 v[58:59], v14 offset:4608
  buffer_load_dwordx4 v2, s[36:39], s7 offen lds
  v_exp_f32 v76, v76
  v_exp_f32 v92, v92
  v_exp_f32 v77, v77
  v_mfma_f32_32x32x16_bf16 v[120:135], v[196:199], v[68:71], v[120:135]
  ds_read_b64_tr_b16 v[60:61], v14 offset:6144
  ds_read_b64_tr_b16 v[62:63], v14 offset:6656
  v_exp_f32 v93, v93
  v_exp_f32 v78, v78
  v_exp_f32 v94, v94
  v_exp_f32 v79, v79
  v_exp_f32 v95, v95
  s_waitcnt lgkmcnt(4)
  v_mfma_f32_32x32x16_bf16 v[120:135], v[200:203], v[48:51], v[120:135]
  s_add_u32 m0, s61, 139264
  v_add_u32 v14, 24576, v7
  ds_read_b64_tr_b16 v[64:65], v14 offset:0
  ds_read_b64_tr_b16 v[66:67], v14 offset:512
  s_mul_i32 s8, s72, 1792
  buffer_load_dwordx4 v2, s[32:35], s8 offen lds
  v_exp_f32 v80, v80
  v_exp_f32 v96, v96
  v_exp_f32 v81, v81
  v_mfma_f32_32x32x16_bf16 v[120:135], v[204:207], v[52:55], v[120:135]
  ds_read_b64_tr_b16 v[68:69], v14 offset:2048
  ds_read_b64_tr_b16 v[70:71], v14 offset:2560
  v_exp_f32 v97, v97
  v_exp_f32 v82, v82
  v_exp_f32 v98, v98
  v_exp_f32 v83, v83
  v_exp_f32 v99, v99
  s_waitcnt lgkmcnt(4)
  v_mfma_f32_32x32x16_bf16 v[120:135], v[208:211], v[56:59], v[120:135]
  s_add_u32 m0, s61, 73728
  ds_read_b64_tr_b16 v[48:49], v14 offset:4096
  ds_read_b64_tr_b16 v[50:51], v14 offset:4608
  buffer_load_dwordx4 v2, s[36:39], s8 offen lds
  v_exp_f32 v84, v84
  v_exp_f32 v100, v100
  v_exp_f32 v85, v85
  v_mfma_f32_32x32x16_bf16 v[120:135], v[212:215], v[60:63], v[120:135]
  ds_read_b64_tr_b16 v[52:53], v14 offset:6144
  ds_read_b64_tr_b16 v[54:55], v14 offset:6656
  v_exp_f32 v101, v101
  v_exp_f32 v86, v86
  v_exp_f32 v102, v102
  v_exp_f32 v87, v87
  v_exp_f32 v103, v103
  s_waitcnt lgkmcnt(4)
  v_mfma_f32_32x32x16_bf16 v[120:135], v[216:219], v[64:67], v[120:135]
  s_add_u32 m0, s61, 65536
  v_add_u32 v14, 131072, v7
  ds_read_b64_tr_b16 v[56:57], v14 offset:0
  ds_read_b64_tr_b16 v[58:59], v14 offset:512
  s_mul_i32 s9, s73, 1792
  buffer_load_dwordx4 v2, s[32:35], s9 offen lds
  v_add_f32 v22, v74, v72
  v_add_f32 v23, v75, v73
  v_add_f32 v24, v90, v88
  v_add_f32 v25, v91, v89
  v_add_f32 v22, v76, v22
  v_add_f32 v23, v77, v23
  v_add_f32 v24, v92, v24
  v_mfma_f32_32x32x16_bf16 v[120:135], v[220:223], v[68:71], v[120:135]
  ds_read_b64_tr_b16 v[60:61], v14 offset:2048
  ds_read_b64_tr_b16 v[62:63], v14 offset:2560
  v_add_f32 v25, v93, v25
  v_add_f32 v22, v78, v22
  v_add_f32 v23, v79, v23
  v_add_f32 v24, v94, v24
  v_add_f32 v25, v95, v25
  v_add_f32 v22, v80, v22
  v_add_f32 v23, v81, v23
  v_add_f32 v24, v96, v24
  v_add_f32 v25, v97, v25
  v_add_f32 v22, v82, v22
  s_waitcnt lgkmcnt(4)
  v_mfma_f32_32x32x16_bf16 v[120:135], v[224:227], v[48:51], v[120:135]
  s_add_u32 m0, s61, 57344
  ds_read_b64_tr_b16 v[64:65], v14 offset:4096
  ds_read_b64_tr_b16 v[66:67], v14 offset:4608
  buffer_load_dwordx4 v2, s[36:39], s9 offen lds
  v_add_f32 v23, v83, v23
  v_add_f32 v24, v98, v24
  v_add_f32 v25, v99, v25
  v_add_f32 v22, v84, v22
  v_add_f32 v23, v85, v23
  v_add_f32 v24, v100, v24
  v_add_f32 v25, v101, v25
  v_mfma_f32_32x32x16_bf16 v[120:135], v[228:231], v[52:55], v[120:135]
  ds_read_b64_tr_b16 v[68:69], v14 offset:6144
  ds_read_b64_tr_b16 v[70:71], v14 offset:6656
  v_add_f32 v22, v86, v22
  v_add_f32 v23, v87, v23
  v_add_f32 v24, v102, v24
  v_add_f32 v25, v103, v25
  v_add_f32 v22, v22, v23
  v_add_f32 v24, v24, v25
  v_mov_b32 v23, v22
  v_mov_b32 v25, v24
  s_nop 0
  v_permlane32_swap_b32 v22, v23
  v_permlane32_swap_b32 v24, v25
  s_waitcnt vmcnt(11)
  s_barrier
  s_waitcnt lgkmcnt(4)
  v_mfma_f32_32x32x16_bf16 v[120:135], v[232:235], v[56:59], v[120:135]
  s_add_u32 m0, s61, 49152
  v_add_u32 v14, 122880, v6
  ds_read_b64_tr_b16 v[48:49], v14 offset:0
  ds_read_b64_tr_b16 v[50:51], v14 offset:512
  s_mul_i32 s10, s74, 1792
  buffer_load_dwordx4 v2, s[32:35], s10 offen lds
  v_add_f32 v22, v22, v23
  v_add_f32 v24, v24, v25
  v_rcp_f32 v22, v22
  v_rcp_f32 v24, v24
  v_mul_f32 v72, v22, v72
  v_mfma_f32_32x32x16_bf16 v[120:135], v[236:239], v[60:63], v[120:135]
  v_add_u32 v15, 114688, v6
  ds_read_b64_tr_b16 v[52:53], v15 offset:0
  ds_read_b64_tr_b16 v[54:55], v15 offset:512
  v_mul_f32 v73, v22, v73
  v_mul_f32 v88, v24, v88
  v_mul_f32 v89, v24, v89
  v_mul_f32 v74, v22, v74
  v_mul_f32 v75, v22, v75
  v_mul_f32 v90, v24, v90
  v_mul_f32 v91, v24, v91
  v_mul_f32 v76, v22, v76
  v_mul_f32 v77, v22, v77
  v_mul_f32 v92, v24, v92
  s_waitcnt lgkmcnt(4)
  v_mfma_f32_32x32x16_bf16 v[120:135], v[240:243], v[64:67], v[120:135]
  ds_read_b64_tr_b16 v[56:57], v14 offset:2048
  ds_read_b64_tr_b16 v[58:59], v14 offset:2560
  v_mul_f32 v93, v24, v93
  v_mul_f32 v78, v22, v78
  v_mul_f32 v79, v22, v79
  v_mul_f32 v94, v24, v94
  v_mul_f32 v95, v24, v95
  v_mul_f32 v80, v22, v80
  v_mul_f32 v81, v22, v81
  v_mul_f32 v96, v24, v96
  v_mul_f32 v97, v24, v97
  v_mul_f32 v82, v22, v82
  v_mfma_f32_32x32x16_bf16 v[120:135], v[244:247], v[68:71], v[120:135]
  ds_read_b64_tr_b16 v[60:61], v15 offset:2048
  ds_read_b64_tr_b16 v[62:63], v15 offset:2560
  v_mul_f32 v83, v22, v83
  v_mul_f32 v98, v24, v98
  v_mul_f32 v99, v24, v99
  v_mul_f32 v84, v22, v84
  v_mul_f32 v85, v22, v85
  v_mul_f32 v100, v24, v100
  v_mul_f32 v101, v24, v101
  v_mul_f32 v86, v22, v86
  v_mul_f32 v87, v22, v87
  v_mul_f32 v102, v24, v102
  s_lshl_b32 s77, s61, 1
  v_add_u32 v248, s77, v5
  v_mul_f32 v103, v24, v103
  v_cvt_pk_bf16_f32 v88, v88, v89
  v_cvt_pk_bf16_f32 v89, v90, v91
  v_cvt_pk_bf16_f32 v90, v92, v93
  v_cvt_pk_bf16_f32 v91, v94, v95
  v_cvt_pk_bf16_f32 v92, v96, v97
  v_cvt_pk_bf16_f32 v93, v98, v99
  v_cvt_pk_bf16_f32 v94, v100, v101
  v_cvt_pk_bf16_f32 v95, v102, v103
  v_cvt_pk_bf16_f32 v96, v72, v73
  v_cvt_pk_bf16_f32 v97, v74, v75
  v_cvt_pk_bf16_f32 v120, v120, v121
  v_cvt_pk_bf16_f32 v121, v122, v123
  v_cvt_pk_bf16_f32 v122, v124, v125
  v_cvt_pk_bf16_f32 v123, v126, v127
  v_cvt_pk_bf16_f32 v124, v128, v129
  v_cvt_pk_bf16_f32 v125, v130, v131
  v_cvt_pk_bf16_f32 v126, v132, v133
  v_cvt_pk_bf16_f32 v127, v134, v135
  s_mov_b32 exec_lo, 0x10000000
  s_mov_b32 exec_hi, 0x10000000
  v_mov_b32 v120, 0x3f803f80
  v_mov_b32 v121, 0x3f803f80
  v_mov_b32 v122, 0x3f803f80
  v_mov_b32 v123, 0x3f803f80
  v_mov_b32 v124, 0x3f803f80
  v_mov_b32 v125, 0x3f803f80
  v_mov_b32 v126, 0x3f803f80
  v_mov_b32 v127, 0x3f803f80
  s_mov_b64 exec, -1
  ds_write_b128 v248, v[120:123] offset:32768
  ds_write_b128 v248, v[124:127] offset:33792
  s_waitcnt lgkmcnt(6)
  v_mfma_f32_32x32x16_bf16 v[104:119], v[48:51], v[136:139], 0
  ds_read_b64_tr_b16 v[64:65], v14 offset:4096
  ds_read_b64_tr_b16 v[66:67], v14 offset:4608
  v_cvt_pk_bf16_f32 v98, v76, v77
  v_cvt_pk_bf16_f32 v99, v78, v79
  v_cvt_pk_bf16_f32 v100, v80, v81
  v_cvt_pk_bf16_f32 v101, v82, v83
  v_cvt_pk_bf16_f32 v102, v84, v85
  v_cvt_pk_bf16_f32 v103, v86, v87
  v_xor_b32 v30, 16, v19
  v_xor_b32 v31, 64, v19
  v_xor_b32 v32, 0x50, v19
  v_mfma_f32_32x32x16_bf16 v[120:135], v[52:55], v[136:139], 0
  ds_read_b64_tr_b16 v[68:69], v15 offset:4096
  ds_read_b64_tr_b16 v[70:71], v15 offset:4608
  ds_write_b64 v19, v[96:97] offset:0
  ds_write_b64 v30, v[98:99] offset:0
  ds_write_b64 v19, v[100:101] offset:32
  s_waitcnt lgkmcnt(12)
  ds_write_b64 v30, v[102:103] offset:32
  s_waitcnt lgkmcnt(12)
  ds_write_b64 v31, v[88:89] offset:0
  s_waitcnt lgkmcnt(11)
  v_mfma_f32_32x32x16_bf16 v[104:119], v[56:59], v[140:143], v[104:119]
  ds_read_b64_tr_b16 v[48:49], v14 offset:6144
  ds_read_b64_tr_b16 v[50:51], v14 offset:6656
  s_waitcnt lgkmcnt(12)
  ds_write_b64 v32, v[90:91] offset:0
  s_waitcnt lgkmcnt(12)
  ds_write_b64 v31, v[92:93] offset:32
  s_waitcnt lgkmcnt(12)
  ds_write_b64 v32, v[94:95] offset:32
  v_xor_b32 v19, 16, v17
  v_mfma_f32_32x32x16_bf16 v[120:135], v[60:63], v[140:143], v[120:135]
  s_waitcnt lgkmcnt(12)
  ds_read_b64_tr_b16 v[52:53], v15 offset:6144
  s_waitcnt lgkmcnt(12)
  ds_read_b64_tr_b16 v[54:55], v15 offset:6656
  s_waitcnt lgkmcnt(0)
  s_barrier
  v_mfma_f32_32x32x16_bf16 v[104:119], v[64:67], v[144:147], v[104:119]
  s_add_u32 m0, s61, 131072
  ds_read_b64_tr_b16 v[56:57], v17 offset:0
  ds_read_b64_tr_b16 v[58:59], v19 offset:1024
  ds_read_b128 v[60:63], v18 offset:32768
  buffer_load_dwordx4 v2, s[36:39], s10 offen lds
  v_mfma_f32_32x32x16_bf16 v[120:135], v[68:71], v[144:147], v[120:135]
  v_mfma_f32_32x32x16_bf16 v[104:119], v[48:51], v[148:151], v[104:119]
  ds_read_b64_tr_b16 v[64:65], v17 offset:2048
  ds_read_b64_tr_b16 v[66:67], v19 offset:3072
  ds_read_b128 v[68:71], v18 offset:33792
  v_mfma_f32_32x32x16_bf16 v[120:135], v[52:55], v[148:151], v[120:135]
  s_add_u32 m0, s61, 114688
  s_mov_b32 s75, 0
  buffer_load_dwordx4 v4, s[40:43], s75 offen lds
  s_waitcnt lgkmcnt(3)
  v_mfma_f32_32x32x16_bf16 v[72:87], v[56:59], v[60:63], 0
  ds_read_b64_tr_b16 v[48:49], v17 offset:4096
  ds_read_b64_tr_b16 v[50:51], v19 offset:5120
  ds_read_b128 v[52:55], v18 offset:34816
  s_waitcnt lgkmcnt(3)
  v_mfma_f32_32x32x16_bf16 v[72:87], v[64:67], v[68:71], v[72:87]
  ds_read_b64_tr_b16 v[56:57], v17 offset:6144
  ds_read_b64_tr_b16 v[58:59], v19 offset:7168
  ds_read_b128 v[60:63], v18 offset:35840
  s_waitcnt lgkmcnt(3)
  v_mfma_f32_32x32x16_bf16 v[72:87], v[48:51], v[52:55], v[72:87]
  s_add_u32 m0, s61, 122880
  ds_read_b64_tr_b16 v[64:65], v17 offset:8192
  ds_read_b64_tr_b16 v[66:67], v19 offset:9216
  ds_read_b128 v[68:71], v18 offset:36864
  s_mov_b32 s75, 57344
  buffer_load_dwordx4 v4, s[40:43], s75 offen lds
  s_waitcnt lgkmcnt(3)
  v_mfma_f32_32x32x16_bf16 v[72:87], v[56:59], v[60:63], v[72:87]
  ds_read_b64_tr_b16 v[48:49], v17 offset:10240
  ds_read_b64_tr_b16 v[50:51], v19 offset:11264
  ds_read_b128 v[52:55], v18 offset:37888
  s_waitcnt lgkmcnt(3)
  v_mfma_f32_32x32x16_bf16 v[72:87], v[64:67], v[68:71], v[72:87]
  ds_read_b64_tr_b16 v[56:57], v17 offset:12288
  ds_read_b64_tr_b16 v[58:59], v19 offset:13312
  ds_read_b128 v[60:63], v18 offset:38912
  s_waitcnt lgkmcnt(3)
  v_mfma_f32_32x32x16_bf16 v[72:87], v[48:51], v[52:55], v[72:87]
  ds_read_b64_tr_b16 v[64:65], v17 offset:14336
  ds_read_b64_tr_b16 v[66:67], v19 offset:15360
  ds_read_b128 v[68:71], v18 offset:39936
  s_waitcnt vmcnt(13)
  s_barrier
  s_waitcnt lgkmcnt(3)
  v_mfma_f32_32x32x16_bf16 v[72:87], v[56:59], v[60:63], v[72:87]
  v_add_u32 v14, 106496, v6
  ds_read_b64_tr_b16 v[48:49], v14 offset:0
  ds_read_b64_tr_b16 v[50:51], v14 offset:512
  v_add_u32 v15, 98304, v6
  ds_read_b64_tr_b16 v[52:53], v15 offset:0
  ds_read_b64_tr_b16 v[54:55], v15 offset:512
  s_waitcnt lgkmcnt(4)
  v_mfma_f32_32x32x16_bf16 v[72:87], v[64:67], v[68:71], v[72:87]
  ds_read_b64_tr_b16 v[56:57], v14 offset:2048
  ds_read_b64_tr_b16 v[58:59], v14 offset:2560
  ds_read_b64_tr_b16 v[60:61], v15 offset:2048
  ds_read_b64_tr_b16 v[62:63], v15 offset:2560
  s_nop 7
  v_cvt_pk_bf16_f32 v22, v72, v73
  v_cvt_pk_bf16_f32 v23, v74, v75
  v_cvt_pk_bf16_f32 v24, v76, v77
  v_cvt_pk_bf16_f32 v25, v78, v79
  s_lshl_b32 s77, s64, 13
  s_add_u32 s77, s77, s94
  s_add_u32 s77, s77, s61
  buffer_store_dwordx4 v[22:25], v5, s[52:55], s77 offen sc1
  s_waitcnt lgkmcnt(4)
  v_mfma_f32_32x32x16_bf16 v[104:119], v[48:51], v[152:155], v[104:119]
  ds_read_b64_tr_b16 v[64:65], v14 offset:4096
  ds_read_b64_tr_b16 v[66:67], v14 offset:4608
  s_lshl_b32 s79, s64, 9
  s_add_u32 s89, s79, s94
  s_lshl_b32 s91, s65, 13
  s_add_u32 s91, s91, s79
  s_add_u32 s91, s91, 9699328
  v_mfma_f32_32x32x16_bf16 v[120:135], v[52:55], v[152:155], v[120:135]
  ds_read_b64_tr_b16 v[68:69], v15 offset:4096
  ds_read_b64_tr_b16 v[70:71], v15 offset:4608
  v_and_b32 v12, 15, v0
  s_lshl_b32 s79, s60, 4
  v_add_lshl_u32 v12, v12, s79, 2
  v_lshrrev_b32 v13, 4, v0
  v_lshl_add_u32 v1, v13, 13, v12
  s_waitcnt lgkmcnt(4)
  v_mfma_f32_32x32x16_bf16 v[104:119], v[56:59], v[156:159], v[104:119]
  ds_read_b64_tr_b16 v[48:49], v14 offset:6144
  ds_read_b64_tr_b16 v[50:51], v14 offset:6656
  v_mov_b32 v21, 0x3f80
  v_mov_b32 v251, 0x3f800000
  v_mfma_f32_32x32x16_bf16 v[120:135], v[60:63], v[156:159], v[120:135]
  ds_read_b64_tr_b16 v[52:53], v15 offset:6144
  ds_read_b64_tr_b16 v[54:55], v15 offset:6656
  s_waitcnt vmcnt(10)
  s_barrier
  s_cmp_lg_u32 s60, 1
  s_cbranch_scc1 Lsig_71
  s_atomic_add s87, s[14:15], s84 offset:0
Lsig_71:
  s_waitcnt lgkmcnt(4)
  v_mfma_f32_32x32x16_bf16 v[104:119], v[64:67], v[160:163], v[104:119]
  s_add_u32 m0, s61, 0
  v_add_u32 v14, 90112, v6
  ds_read_b64_tr_b16 v[56:57], v14 offset:0
  ds_read_b64_tr_b16 v[58:59], v14 offset:512
  s_mov_b32 s75, 114688
  buffer_load_dwordx4 v4, s[40:43], s75 offen lds
  v_mfma_f32_32x32x16_bf16 v[120:135], v[68:71], v[160:163], v[120:135]
  s_add_u32 m0, s61, 8192
  v_add_u32 v15, 81920, v6
  ds_read_b64_tr_b16 v[60:61], v15 offset:0
  ds_read_b64_tr_b16 v[62:63], v15 offset:512
  s_mov_b32 s75, 172032
  buffer_load_dwordx4 v4, s[40:43], s75 offen lds
  s_waitcnt lgkmcnt(4)
  v_mfma_f32_32x32x16_bf16 v[104:119], v[48:51], v[164:167], v[104:119]
  s_add_u32 m0, s61, 16384
  ds_read_b64_tr_b16 v[64:65], v14 offset:2048
  ds_read_b64_tr_b16 v[66:67], v14 offset:2560
  s_mov_b32 s75, 229376
  buffer_load_dwordx4 v4, s[40:43], s75 offen lds
  v_mfma_f32_32x32x16_bf16 v[120:135], v[52:55], v[164:167], v[120:135]
  ds_read_b64_tr_b16 v[68:69], v15 offset:2048
  ds_read_b64_tr_b16 v[70:71], v15 offset:2560
  s_waitcnt lgkmcnt(4)
  v_mfma_f32_32x32x16_bf16 v[104:119], v[56:59], v[168:171], v[104:119]
  s_add_u32 m0, s61, 24576
  ds_read_b64_tr_b16 v[48:49], v14 offset:4096
  ds_read_b64_tr_b16 v[50:51], v14 offset:4608
  s_mov_b32 s75, 286720
  buffer_load_dwordx4 v4, s[40:43], s75 offen lds
  v_mfma_f32_32x32x16_bf16 v[120:135], v[60:63], v[168:171], v[120:135]
  s_add_u32 m0, s61, 32768
  ds_read_b64_tr_b16 v[52:53], v15 offset:4096
  ds_read_b64_tr_b16 v[54:55], v15 offset:4608
  s_mov_b32 s75, 344064
  buffer_load_dwordx4 v4, s[40:43], s75 offen lds
  s_waitcnt lgkmcnt(4)
  v_mfma_f32_32x32x16_bf16 v[104:119], v[64:67], v[172:175], v[104:119]
  s_add_u32 m0, s61, 40960
  ds_read_b64_tr_b16 v[56:57], v14 offset:6144
  ds_read_b64_tr_b16 v[58:59], v14 offset:6656
  s_mov_b32 s75, 401408
  buffer_load_dwordx4 v4, s[40:43], s75 offen lds
  v_mfma_f32_32x32x16_bf16 v[120:135], v[68:71], v[172:175], v[120:135]
  ds_read_b64_tr_b16 v[60:61], v15 offset:6144
  ds_read_b64_tr_b16 v[62:63], v15 offset:6656
  s_waitcnt vmcnt(6)
  s_barrier
  s_cmp_lg_u32 s60, 1
  s_cbranch_scc1 Lsig_72
  s_atomic_add s87, s[14:15], s92 offset:0
Lsig_72:
  s_waitcnt lgkmcnt(4)
  v_mfma_f32_32x32x16_bf16 v[104:119], v[48:51], v[176:179], v[104:119]
  s_add_u32 m0, s61, 106496
  v_add_u32 v14, 155648, v6
  ds_read_b64_tr_b16 v[64:65], v14 offset:0
  ds_read_b64_tr_b16 v[66:67], v14 offset:512
  s_mov_b32 s75, 458752
  buffer_load_dwordx4 v4, s[40:43], s75 offen lds
  v_mfma_f32_32x32x16_bf16 v[120:135], v[52:55], v[176:179], v[120:135]
  v_add_u32 v15, 147456, v6
  ds_read_b64_tr_b16 v[68:69], v15 offset:0
  ds_read_b64_tr_b16 v[70:71], v15 offset:512
  s_waitcnt lgkmcnt(4)
  v_mfma_f32_32x32x16_bf16 v[104:119], v[56:59], v[180:183], v[104:119]
  ds_read_b64_tr_b16 v[48:49], v14 offset:2048
  ds_read_b64_tr_b16 v[50:51], v14 offset:2560
  v_mfma_f32_32x32x16_bf16 v[120:135], v[60:63], v[180:183], v[120:135]
  ds_read_b64_tr_b16 v[52:53], v15 offset:2048
  ds_read_b64_tr_b16 v[54:55], v15 offset:2560
  s_waitcnt lgkmcnt(4)
  v_mfma_f32_32x32x16_bf16 v[104:119], v[64:67], v[184:187], v[104:119]
  s_add_u32 m0, s61, 98304
  ds_read_b64_tr_b16 v[56:57], v14 offset:4096
  ds_read_b64_tr_b16 v[58:59], v14 offset:4608
  s_mov_b32 s75, 516096
  buffer_load_dwordx4 v4, s[40:43], s75 offen lds
  v_mfma_f32_32x32x16_bf16 v[120:135], v[68:71], v[184:187], v[120:135]
  ds_read_b64_tr_b16 v[60:61], v15 offset:4096
  ds_read_b64_tr_b16 v[62:63], v15 offset:4608
  s_waitcnt lgkmcnt(4)
  v_mfma_f32_32x32x16_bf16 v[104:119], v[48:51], v[188:191], v[104:119]
  ds_read_b64_tr_b16 v[64:65], v14 offset:6144
  ds_read_b64_tr_b16 v[66:67], v14 offset:6656
  v_mfma_f32_32x32x16_bf16 v[120:135], v[52:55], v[188:191], v[120:135]
  ds_read_b64_tr_b16 v[68:69], v15 offset:6144
  ds_read_b64_tr_b16 v[70:71], v15 offset:6656
  s_barrier
  s_cmp_lg_u32 s60, 4
  s_cbranch_scc1 Lpi_73
  s_mov_b32 s13, 0
  s_atomic_add s13, s[14:15], s92 offset:0 glc
Lpi_73:
  s_cmp_lg_u32 s60, 0
  s_cbranch_scc1 Lpi_74
  s_mov_b32 s13, 0
  s_atomic_add s13, s[14:15], s85 offset:0 glc
Lpi_74:
  s_waitcnt lgkmcnt(4)
  v_mfma_f32_32x32x16_bf16 v[104:119], v[56:59], v[192:195], v[104:119]
  s_add_u32 m0, s61, 90112
  v_add_u32 v14, 139264, v6
  ds_read_b64_tr_b16 v[48:49], v14 offset:0
  ds_read_b64_tr_b16 v[50:51], v14 offset:512
  s_mov_b32 s75, 573440
  buffer_load_dwordx4 v4, s[40:43], s75 offen lds
  v_mfma_f32_32x32x16_bf16 v[120:135], v[60:63], v[192:195], v[120:135]
  v_add_u32 v15, 73728, v6
  ds_read_b64_tr_b16 v[52:53], v15 offset:0
  ds_read_b64_tr_b16 v[54:55], v15 offset:512
  s_waitcnt lgkmcnt(4)
  v_mfma_f32_32x32x16_bf16 v[104:119], v[64:67], v[196:199], v[104:119]
  ds_read_b64_tr_b16 v[56:57], v14 offset:2048
  ds_read_b64_tr_b16 v[58:59], v14 offset:2560
  v_mfma_f32_32x32x16_bf16 v[120:135], v[68:71], v[196:199], v[120:135]
  ds_read_b64_tr_b16 v[60:61], v15 offset:2048
  ds_read_b64_tr_b16 v[62:63], v15 offset:2560
  s_waitcnt lgkmcnt(4)
  v_mfma_f32_32x32x16_bf16 v[104:119], v[48:51], v[200:203], v[104:119]
  s_add_u32 m0, s61, 81920
  ds_read_b64_tr_b16 v[64:65], v14 offset:4096
  ds_read_b64_tr_b16 v[66:67], v14 offset:4608
  s_mov_b32 s75, 630784
  buffer_load_dwordx4 v4, s[40:43], s75 offen lds
  v_mfma_f32_32x32x16_bf16 v[120:135], v[52:55], v[200:203], v[120:135]
  ds_read_b64_tr_b16 v[68:69], v15 offset:4096
  ds_read_b64_tr_b16 v[70:71], v15 offset:4608
  s_waitcnt lgkmcnt(4)
  v_mfma_f32_32x32x16_bf16 v[104:119], v[56:59], v[204:207], v[104:119]
  ds_read_b64_tr_b16 v[48:49], v14 offset:6144
  ds_read_b64_tr_b16 v[50:51], v14 offset:6656
  v_mfma_f32_32x32x16_bf16 v[120:135], v[60:63], v[204:207], v[120:135]
  ds_read_b64_tr_b16 v[52:53], v15 offset:6144
  ds_read_b64_tr_b16 v[54:55], v15 offset:6656
  s_cmp_lg_u32 s60, 4
  s_cbranch_scc1 Lpc_75
  s_waitcnt lgkmcnt(0)
  s_cmp_ge_u32 s13, 16
  s_cbranch_scc1 Lpc_75
  s_mov_b32 s93, 0
Lsp_76:
  s_mov_b32 s13, 0
  s_atomic_add s13, s[14:15], s92 offset:0 glc
  s_add_u32 s93, s93, 1
  s_waitcnt lgkmcnt(0)
  s_cmp_ge_u32 s13, 16
  s_cbranch_scc1 Lpc_75
  s_cmp_lt_u32 s93, 20000
  s_cbranch_scc1 Lsp_76
Lpc_75:
  s_cmp_lg_u32 s60, 0
  s_cbranch_scc1 Lpc_77
  s_waitcnt lgkmcnt(0)
  s_cmp_ge_u32 s13, 10
  s_cbranch_scc1 Lpc_77
  s_mov_b32 s93, 0
Lsp_78:
  s_mov_b32 s13, 0
  s_atomic_add s13, s[14:15], s85 offset:0 glc
  s_add_u32 s93, s93, 1
  s_waitcnt lgkmcnt(0)
  s_cmp_ge_u32 s13, 10
  s_cbranch_scc1 Lpc_77
  s_cmp_lt_u32 s93, 20000
  s_cbranch_scc1 Lsp_78
Lpc_77:
  s_barrier
  buffer_load_dword v10, v1, s[52:55], s89 offen sc1
  s_add_u32 s89, s89, 32768
  buffer_load_dword v11, v1, s[52:55], s89 offen sc1
  s_add_u32 s89, s89, 32768
  buffer_load_dword v12, v1, s[52:55], s89 offen sc1
  s_add_u32 s89, s89, 32768
  buffer_load_dword v13, v1, s[52:55], s89 offen sc1
  s_waitcnt lgkmcnt(4)
  v_mfma_f32_32x32x16_bf16 v[104:119], v[64:67], v[208:211], v[104:119]
  v_add_u32 v14, 65536, v6
  ds_read_b64_tr_b16 v[56:57], v14 offset:0
  ds_read_b64_tr_b16 v[58:59], v14 offset:512
  s_mov_b32 s76, 0
  buffer_load_dwordx4 v[72:75], v16, s[52:55], s76 offen sc1
  v_mfma_f32_32x32x16_bf16 v[120:135], v[68:71], v[208:211], v[120:135]
  v_add_u32 v15, 57344, v6
  ds_read_b64_tr_b16 v[60:61], v15 offset:0
  ds_read_b64_tr_b16 v[62:63], v15 offset:512
  s_mov_b32 s76, 4096
  buffer_load_dwordx4 v[76:79], v16, s[52:55], s76 offen sc1
  s_waitcnt lgkmcnt(4)
  v_mfma_f32_32x32x16_bf16 v[104:119], v[48:51], v[212:215], v[104:119]
  ds_read_b64_tr_b16 v[64:65], v14 offset:2048
  ds_read_b64_tr_b16 v[66:67], v14 offset:2560
  s_mov_b32 s76, 8192
  buffer_load_dwordx4 v[80:83], v16, s[52:55], s76 offen sc1
  v_mfma_f32_32x32x16_bf16 v[120:135], v[52:55], v[212:215], v[120:135]
  ds_read_b64_tr_b16 v[68:69], v15 offset:2048
  ds_read_b64_tr_b16 v[70:71], v15 offset:2560
  s_waitcnt lgkmcnt(4)
  v_mfma_f32_32x32x16_bf16 v[104:119], v[56:59], v[216:219], v[104:119]
  ds_read_b64_tr_b16 v[48:49], v14 offset:4096
  ds_read_b64_tr_b16 v[50:51], v14 offset:4608
  s_mov_b32 s76, 12288
  buffer_load_dwordx4 v[84:87], v16, s[52:55], s76 offen sc1
  v_mfma_f32_32x32x16_bf16 v[120:135], v[60:63], v[216:219], v[120:135]
  ds_read_b64_tr_b16 v[52:53], v15 offset:4096
  ds_read_b64_tr_b16 v[54:55], v15 offset:4608
  s_mov_b32 s76, 16384
  buffer_load_dwordx4 v[88:91], v16, s[52:55], s76 offen sc1
  s_waitcnt lgkmcnt(4)
  v_mfma_f32_32x32x16_bf16 v[104:119], v[64:67], v[220:223], v[104:119]
  ds_read_b64_tr_b16 v[56:57], v14 offset:6144
  ds_read_b64_tr_b16 v[58:59], v14 offset:6656
  s_mov_b32 s76, 20480
  buffer_load_dwordx4 v[92:95], v16, s[52:55], s76 offen sc1
  v_mfma_f32_32x32x16_bf16 v[120:135], v[68:71], v[220:223], v[120:135]
  ds_read_b64_tr_b16 v[60:61], v15 offset:6144
  ds_read_b64_tr_b16 v[62:63], v15 offset:6656
  s_waitcnt vmcnt(9)
  v_dot2_f32_bf16 v17, v10, v21, 0
  v_dot2_f32_bf16 v18, v10, v251, 0
  s_waitcnt vmcnt(8)
  v_dot2_f32_bf16 v17, v11, v21, v17
  v_dot2_f32_bf16 v18, v11, v251, v18
  s_waitcnt vmcnt(7)
  v_dot2_f32_bf16 v17, v12, v21, v17
  v_dot2_f32_bf16 v18, v12, v251, v18
  s_waitcnt vmcnt(6)
  v_dot2_f32_bf16 v17, v13, v21, v17
  v_dot2_f32_bf16 v18, v13, v251, v18
  s_nop 2
  v_permlane32_swap_b32 v17, v18
  v_add_f32 v17, v17, v18
  v_mov_b32 v18, v17
  s_nop 1
  v_permlane16_swap_b32 v17, v18
  v_add_f32 v17, v17, v18
  v_mov_b32 v18, v17
  s_nop 1
  v_permlane32_swap_b32 v17, v18
  v_cvt_pk_bf16_f32 v17, v17, v18
  s_and_b32 s77, s64, 3
  s_cmp_eq_u32 s77, 3
  s_cselect_b32 s77, 48, 0xf0
  s_cmp_eq_u32 s60, 7
  s_cselect_b32 vcc_lo, s77, 0
  s_mov_b32 vcc_hi, 0
  v_mov_b32 v18, 0x3f803f80
  v_cndmask_b32 v17, v17, v18, vcc
  s_mov_b64 exec, 0xffff
  buffer_store_dword v17, v1, s[52:55], s91 offen sc1
  s_mov_b64 exec, -1
  s_barrier
  s_waitcnt lgkmcnt(4)
  v_mfma_f32_32x32x16_bf16 v[104:119], v[48:51], v[224:227], v[104:119]
  v_add_u32 v14, 49152, v6
  ds_read_b64_tr_b16 v[64:65], v14 offset:0
  ds_read_b64_tr_b16 v[66:67], v14 offset:512
  s_mov_b32 s76, 24576
  buffer_load_dwordx4 v[96:99], v16, s[52:55], s76 offen sc1
  v_mfma_f32_32x32x16_bf16 v[120:135], v[52:55], v[224:227], v[120:135]
  v_add_u32 v15, 131072, v6
  ds_read_b64_tr_b16 v[68:69], v15 offset:0
  ds_read_b64_tr_b16 v[70:71], v15 offset:512
  s_waitcnt lgkmcnt(4)
  v_mfma_f32_32x32x16_bf16 v[104:119], v[56:59], v[228:231], v[104:119]
  ds_read_b64_tr_b16 v[48:49], v14 offset:2048
  ds_read_b64_tr_b16 v[50:51], v14 offset:2560
  s_mov_b32 s76, 28672
  buffer_load_dwordx4 v[100:103], v16, s[52:55], s76 offen sc1
  v_mfma_f32_32x32x16_bf16 v[120:135], v[60:63], v[228:231], v[120:135]
  ds_read_b64_tr_b16 v[52:53], v15 offset:2048
  ds_read_b64_tr_b16 v[54:55], v15 offset:2560
  s_waitcnt lgkmcnt(4)
  v_mfma_f32_32x32x16_bf16 v[104:119], v[64:67], v[232:235], v[104:119]
  s_add_u32 m0, s61, 155648
  ds_read_b64_tr_b16 v[56:57], v14 offset:4096
  ds_read_b64_tr_b16 v[58:59], v14 offset:4608
  s_mov_b32 s75, 688128
  buffer_load_dwordx4 v4, s[40:43], s75 offen lds
  v_mfma_f32_32x32x16_bf16 v[120:135], v[68:71], v[232:235], v[120:135]
  ds_read_b64_tr_b16 v[60:61], v15 offset:4096
  ds_read_b64_tr_b16 v[62:63], v15 offset:4608
  s_waitcnt lgkmcnt(4)
  v_mfma_f32_32x32x16_bf16 v[104:119], v[48:51], v[236:239], v[104:119]
  s_add_u32 m0, s61, 147456
  ds_read_b64_tr_b16 v[64:65], v14 offset:6144
  ds_read_b64_tr_b16 v[66:67], v14 offset:6656
  s_mov_b32 s75, 745472
  buffer_load_dwordx4 v4, s[40:43], s75 offen lds
  v_mfma_f32_32x32x16_bf16 v[120:135], v[52:55], v[236:239], v[120:135]
  ds_read_b64_tr_b16 v[68:69], v15 offset:6144
  ds_read_b64_tr_b16 v[70:71], v15 offset:6656
  s_waitcnt lgkmcnt(4)
  v_mfma_f32_32x32x16_bf16 v[104:119], v[56:59], v[240:243], v[104:119]
  s_add_u32 m0, s61, 139264
  s_mov_b32 s75, 802816
  buffer_load_dwordx4 v4, s[40:43], s75 offen lds
  v_mfma_f32_32x32x16_bf16 v[120:135], v[60:63], v[240:243], v[120:135]
  s_waitcnt lgkmcnt(0)
  v_mfma_f32_32x32x16_bf16 v[104:119], v[64:67], v[244:247], v[104:119]
  s_add_u32 m0, s61, 73728
  s_mov_b32 s75, 860160
  buffer_load_dwordx4 v4, s[40:43], s75 offen lds
  v_mfma_f32_32x32x16_bf16 v[120:135], v[68:71], v[244:247], v[120:135]
  s_waitcnt vmcnt(6)
  s_barrier
  s_cmp_lg_u32 s60, 2
  s_cbranch_scc1 Lpi_79
  s_mov_b32 s13, 0
  s_atomic_add s13, s[14:15], s85 offset:128 glc
Lpi_79:
  s_cmp_lg_u32 s60, 1
  s_cbranch_scc1 Lsig_80
  s_atomic_add s87, s[14:15], s92 offset:1024
Lsig_80:
  v_add_u32 v14, 65536, v8
  ds_read_b64_tr_b16 v[48:49], v14 offset:49152
  ds_read_b64_tr_b16 v[50:51], v14 offset:50176
  v_add_u32 v15, 65536, v9
  ds_read_b64_tr_b16 v[52:53], v15 offset:49152
  ds_read_b64_tr_b16 v[54:55], v15 offset:50176
  ds_read_b64_tr_b16 v[56:57], v14 offset:57344
  ds_read_b64_tr_b16 v[58:59], v14 offset:58368
  ds_read_b64_tr_b16 v[60:61], v15 offset:57344
  ds_read_b64_tr_b16 v[62:63], v15 offset:58368
  s_add_u32 m0, s61, 131072
  s_mov_b32 s75, 917504
  buffer_load_dwordx4 v4, s[40:43], s75 offen lds
  s_add_u32 m0, s61, 65536
  s_mov_b32 s75, 974848
  buffer_load_dwordx4 v4, s[40:43], s75 offen lds
  s_add_u32 m0, s61, 57344
  s_mov_b32 s75, 1032192
  buffer_load_dwordx4 v4, s[40:43], s75 offen lds
  v_pk_mul_f32 v[104:105], v[104:105], s[90:91] op_sel_hi:[1,0]
  v_pk_mul_f32 v[106:107], v[106:107], s[90:91] op_sel_hi:[1,0]
  v_pk_mul_f32 v[108:109], v[108:109], s[90:91] op_sel_hi:[1,0]
  v_pk_mul_f32 v[110:111], v[110:111], s[90:91] op_sel_hi:[1,0]
  v_exp_f32 v104, v104
  v_exp_f32 v105, v105
  v_exp_f32 v106, v106
  v_exp_f32 v107, v107
  v_exp_f32 v108, v108
  v_exp_f32 v109, v109
  v_exp_f32 v110, v110
  v_exp_f32 v111, v111
  v_pk_add_f32 v[104:105], v[104:105], 1.0 op_sel_hi:[1,0]
  v_pk_add_f32 v[106:107], v[106:107], 1.0 op_sel_hi:[1,0]
  v_pk_add_f32 v[108:109], v[108:109], 1.0 op_sel_hi:[1,0]
  v_pk_add_f32 v[110:111], v[110:111], 1.0 op_sel_hi:[1,0]
  v_rcp_f32 v104, v104
  v_rcp_f32 v105, v105
  v_rcp_f32 v106, v106
  v_rcp_f32 v107, v107
  v_rcp_f32 v108, v108
  v_rcp_f32 v109, v109
  v_rcp_f32 v110, v110
  v_rcp_f32 v111, v111
  v_pk_mul_f32 v[120:121], v[120:121], v[104:105]
  v_pk_mul_f32 v[122:123], v[122:123], v[106:107]
  v_pk_mul_f32 v[124:125], v[124:125], v[108:109]
  v_pk_mul_f32 v[126:127], v[126:127], v[110:111]
  v_cvt_pk_bf16_f32 v104, v120, v121
  v_cvt_pk_bf16_f32 v105, v122, v123
  v_cvt_pk_bf16_f32 v106, v124, v125
  v_cvt_pk_bf16_f32 v107, v126, v127
  s_lshl_b32 s12, s66, 12
  s_add_u32 s12, s12, s80
  buffer_store_dwordx4 v[104:107], v5, s[52:55], s12 offen sc1
  v_pk_mul_f32 v[112:113], v[112:113], s[90:91] op_sel_hi:[1,0]
  v_pk_mul_f32 v[114:115], v[114:115], s[90:91] op_sel_hi:[1,0]
  v_pk_mul_f32 v[116:117], v[116:117], s[90:91] op_sel_hi:[1,0]
  v_pk_mul_f32 v[118:119], v[118:119], s[90:91] op_sel_hi:[1,0]
  v_exp_f32 v112, v112
  v_exp_f32 v113, v113
  v_exp_f32 v114, v114
  v_exp_f32 v115, v115
  v_exp_f32 v116, v116
  v_exp_f32 v117, v117
  v_exp_f32 v118, v118
  v_exp_f32 v119, v119
  v_pk_add_f32 v[112:113], v[112:113], 1.0 op_sel_hi:[1,0]
  v_pk_add_f32 v[114:115], v[114:115], 1.0 op_sel_hi:[1,0]
  v_pk_add_f32 v[116:117], v[116:117], 1.0 op_sel_hi:[1,0]
  v_pk_add_f32 v[118:119], v[118:119], 1.0 op_sel_hi:[1,0]
  v_rcp_f32 v112, v112
  v_rcp_f32 v113, v113
  v_rcp_f32 v114, v114
  v_rcp_f32 v115, v115
  v_rcp_f32 v116, v116
  v_rcp_f32 v117, v117
  v_rcp_f32 v118, v118
  v_rcp_f32 v119, v119
  v_pk_mul_f32 v[128:129], v[128:129], v[112:113]
  v_pk_mul_f32 v[130:131], v[130:131], v[114:115]
  v_pk_mul_f32 v[132:133], v[132:133], v[116:117]
  v_pk_mul_f32 v[134:135], v[134:135], v[118:119]
  v_cvt_pk_bf16_f32 v112, v128, v129
  v_cvt_pk_bf16_f32 v113, v130, v131
  v_cvt_pk_bf16_f32 v114, v132, v133
  v_cvt_pk_bf16_f32 v115, v134, v135
  buffer_store_dwordx4 v[112:115], v5, s[52:55], s12 offen offset:1024 sc1
  s_cmp_lg_u32 s60, 2
  s_cbranch_scc1 Lpc_81
  s_waitcnt lgkmcnt(0)
  s_cmp_ge_u32 s13, 6
  s_cbranch_scc1 Lpc_81
  s_mov_b32 s93, 0
Lsp_82:
  s_mov_b32 s13, 0
  s_atomic_add s13, s[14:15], s85 offset:128 glc
  s_add_u32 s93, s93, 1
  s_waitcnt lgkmcnt(0)
  s_cmp_ge_u32 s13, 6
  s_cbranch_scc1 Lpc_81
  s_cmp_lt_u32 s93, 20000
  s_cbranch_scc1 Lsp_82
Lpc_81:
  s_barrier
  s_waitcnt lgkmcnt(4)
  v_mfma_f32_32x32x16_bf16 v[136:151], v[48:51], v[72:75], 0
  ds_read_b64_tr_b16 v[64:65], v8 offset:0
  ds_read_b64_tr_b16 v[66:67], v8 offset:1024
  s_mov_b32 s76, 32768
  buffer_load_dwordx4 v[168:171], v16, s[52:55], s76 offen sc1
  v_mfma_f32_32x32x16_bf16 v[152:167], v[52:55], v[72:75], 0
  ds_read_b64_tr_b16 v[68:69], v9 offset:0
  ds_read_b64_tr_b16 v[70:71], v9 offset:1024
  s_mov_b32 s76, 36864
  buffer_load_dwordx4 v[172:175], v16, s[52:55], s76 offen sc1
  s_waitcnt lgkmcnt(4)
  v_mfma_f32_32x32x16_bf16 v[136:151], v[56:59], v[76:79], v[136:151]
  ds_read_b64_tr_b16 v[48:49], v8 offset:8192
  ds_read_b64_tr_b16 v[50:51], v8 offset:9216
  s_mov_b32 s76, 40960
  buffer_load_dwordx4 v[176:179], v16, s[52:55], s76 offen sc1
  v_mfma_f32_32x32x16_bf16 v[152:167], v[60:63], v[76:79], v[152:167]
  ds_read_b64_tr_b16 v[52:53], v9 offset:8192
  ds_read_b64_tr_b16 v[54:55], v9 offset:9216
  s_mov_b32 s76, 45056
  buffer_load_dwordx4 v[180:183], v16, s[52:55], s76 offen sc1
  s_waitcnt vmcnt(4)
  s_barrier
  s_cmp_lg_u32 s60, 1
  s_cbranch_scc1 Lsig_83
  s_atomic_add s87, s[14:15], s84 offset:384
Lsig_83:
  s_waitcnt lgkmcnt(4)
  v_mfma_f32_32x32x16_bf16 v[136:151], v[64:67], v[80:83], v[136:151]
  ds_read_b64_tr_b16 v[56:57], v8 offset:16384
  ds_read_b64_tr_b16 v[58:59], v8 offset:17408
  s_mov_b32 s76, 49152
  buffer_load_dwordx4 v[184:187], v16, s[52:55], s76 offen sc1
  v_mfma_f32_32x32x16_bf16 v[152:167], v[68:71], v[80:83], v[152:167]
  ds_read_b64_tr_b16 v[60:61], v9 offset:16384
  ds_read_b64_tr_b16 v[62:63], v9 offset:17408
  s_mov_b32 s76, 53248
  buffer_load_dwordx4 v[188:191], v16, s[52:55], s76 offen sc1
  s_waitcnt lgkmcnt(4)
  v_mfma_f32_32x32x16_bf16 v[136:151], v[48:51], v[84:87], v[136:151]
  s_add_u32 m0, s61, 122880
  ds_read_b64_tr_b16 v[64:65], v8 offset:24576
  ds_read_b64_tr_b16 v[66:67], v8 offset:25600
  s_mov_b32 s75, 1089536
  buffer_load_dwordx4 v4, s[40:43], s75 offen lds
  v_mfma_f32_32x32x16_bf16 v[152:167], v[52:55], v[84:87], v[152:167]
  ds_read_b64_tr_b16 v[68:69], v9 offset:24576
  ds_read_b64_tr_b16 v[70:71], v9 offset:25600
  s_barrier
  s_waitcnt lgkmcnt(4)
  v_mfma_f32_32x32x16_bf16 v[136:151], v[56:59], v[88:91], v[136:151]
  s_add_u32 m0, s61, 0
  ds_read_b64_tr_b16 v[48:49], v8 offset:32768
  ds_read_b64_tr_b16 v[50:51], v8 offset:33792
  s_mov_b32 s75, 1146880
  buffer_load_dwordx4 v4, s[40:43], s75 offen lds
  v_mfma_f32_32x32x16_bf16 v[152:167], v[60:63], v[88:91], v[152:167]
  s_add_u32 m0, s61, 8192
  ds_read_b64_tr_b16 v[52:53], v9 offset:32768
  ds_read_b64_tr_b16 v[54:55], v9 offset:33792
  s_mov_b32 s75, 1204224
  buffer_load_dwordx4 v4, s[40:43], s75 offen lds
  s_waitcnt lgkmcnt(4)
  v_mfma_f32_32x32x16_bf16 v[136:151], v[64:67], v[92:95], v[136:151]
  s_add_u32 m0, s61, 49152
  ds_read_b64_tr_b16 v[56:57], v8 offset:40960
  ds_read_b64_tr_b16 v[58:59], v8 offset:41984
  s_mov_b32 s75, 1261568
  buffer_load_dwordx4 v4, s[40:43], s75 offen lds
  v_mfma_f32_32x32x16_bf16 v[152:167], v[68:71], v[92:95], v[152:167]
  ds_read_b64_tr_b16 v[60:61], v9 offset:40960
  ds_read_b64_tr_b16 v[62:63], v9 offset:41984
  s_barrier
  s_cmp_lg_u32 s60, 0
  s_cbranch_scc1 Lpi_84
  s_mov_b32 s13, 0
  s_atomic_add s13, s[14:15], s85 offset:256 glc
Lpi_84:
  s_waitcnt lgkmcnt(4)
  v_mfma_f32_32x32x16_bf16 v[136:151], v[48:51], v[96:99], v[136:151]
  s_add_u32 m0, s61, 16384
  ds_read_b64_tr_b16 v[64:65], v14 offset:40960
  ds_read_b64_tr_b16 v[66:67], v14 offset:41984
  s_mov_b32 s75, 1318912
  buffer_load_dwordx4 v4, s[40:43], s75 offen lds
  v_mfma_f32_32x32x16_bf16 v[152:167], v[52:55], v[96:99], v[152:167]
  s_add_u32 m0, s61, 24576
  ds_read_b64_tr_b16 v[68:69], v15 offset:40960
  ds_read_b64_tr_b16 v[70:71], v15 offset:41984
  s_mov_b32 s75, 1376256
  buffer_load_dwordx4 v4, s[40:43], s75 offen lds
  s_waitcnt lgkmcnt(4)
  v_mfma_f32_32x32x16_bf16 v[136:151], v[56:59], v[100:103], v[136:151]
  s_add_u32 m0, s61, 114688
  ds_read_b64_tr_b16 v[48:49], v14 offset:32768
  ds_read_b64_tr_b16 v[50:51], v14 offset:33792
  s_mov_b32 s75, 1433600
  buffer_load_dwordx4 v4, s[40:43], s75 offen lds
  v_mfma_f32_32x32x16_bf16 v[152:167], v[60:63], v[100:103], v[152:167]
  ds_read_b64_tr_b16 v[52:53], v15 offset:32768
  ds_read_b64_tr_b16 v[54:55], v15 offset:33792
  s_barrier
  s_waitcnt vmcnt(12) lgkmcnt(4)
  v_mfma_f32_32x32x16_bf16 v[136:151], v[64:67], v[168:171], v[136:151]
  s_add_u32 m0, s61, 32768
  ds_read_b64_tr_b16 v[56:57], v14 offset:24576
  ds_read_b64_tr_b16 v[58:59], v14 offset:25600
  s_mov_b32 s75, 1490944
  buffer_load_dwordx4 v4, s[40:43], s75 offen lds
  v_mfma_f32_32x32x16_bf16 v[152:167], v[68:71], v[168:171], v[152:167]
  ds_read_b64_tr_b16 v[60:61], v15 offset:24576
  ds_read_b64_tr_b16 v[62:63], v15 offset:25600
  s_waitcnt vmcnt(12) lgkmcnt(4)
  v_mfma_f32_32x32x16_bf16 v[136:151], v[48:51], v[172:175], v[136:151]
  s_add_u32 m0, s61, 40960
  ds_read_b64_tr_b16 v[64:65], v14 offset:16384
  ds_read_b64_tr_b16 v[66:67], v14 offset:17408
  s_mov_b32 s75, 1548288
  buffer_load_dwordx4 v4, s[40:43], s75 offen lds
  v_mfma_f32_32x32x16_bf16 v[152:167], v[52:55], v[172:175], v[152:167]
  ds_read_b64_tr_b16 v[68:69], v15 offset:16384
  ds_read_b64_tr_b16 v[70:71], v15 offset:17408
  s_cmp_lg_u32 s60, 0
  s_cbranch_scc1 Lpc_85
  s_waitcnt lgkmcnt(0)
  s_cmp_ge_u32 s13, 6
  s_cbranch_scc1 Lpc_85
  s_mov_b32 s93, 0
Lsp_86:
  s_mov_b32 s13, 0
  s_atomic_add s13, s[14:15], s85 offset:256 glc
  s_add_u32 s93, s93, 1
  s_waitcnt lgkmcnt(0)
  s_cmp_ge_u32 s13, 6
  s_cbranch_scc1 Lpc_85
  s_cmp_lt_u32 s93, 20000
  s_cbranch_scc1 Lsp_86
Lpc_85:
  s_barrier
  s_cmp_lg_u32 s60, 3
  s_cbranch_scc1 Lpi_87
  s_mov_b32 s13, 0
  s_atomic_add s13, s[14:15], s85 offset:384 glc
Lpi_87:
  s_waitcnt vmcnt(12) lgkmcnt(4)
  v_mfma_f32_32x32x16_bf16 v[136:151], v[56:59], v[176:179], v[136:151]
  v_add_u32 v6, 131072, v8
  ds_read_b64_tr_b16 v[48:49], v6 offset:24576
  ds_read_b64_tr_b16 v[50:51], v6 offset:25600
  v_and_b32 v248, 31, v0
  v_lshlrev_b32 v248, 2, v248
  buffer_load_dword v252, v248, s[52:55], s96 offen sc1
  s_mov_b32 s76, 57344
  buffer_load_dwordx4 v[192:195], v16, s[52:55], s76 offen sc1
  v_mfma_f32_32x32x16_bf16 v[152:167], v[60:63], v[176:179], v[152:167]
  v_add_u32 v7, 131072, v9
  ds_read_b64_tr_b16 v[52:53], v7 offset:24576
  ds_read_b64_tr_b16 v[54:55], v7 offset:25600
  s_mov_b32 s76, 61440
  buffer_load_dwordx4 v[196:199], v16, s[52:55], s76 offen sc1
  s_waitcnt vmcnt(14) lgkmcnt(4)
  v_mfma_f32_32x32x16_bf16 v[136:151], v[64:67], v[180:183], v[136:151]
  ds_read_b64_tr_b16 v[56:57], v6 offset:16384
  ds_read_b64_tr_b16 v[58:59], v6 offset:17408
  s_mov_b32 s76, 65536
  buffer_load_dwordx4 v[200:203], v16, s[52:55], s76 offen sc1
  v_mfma_f32_32x32x16_bf16 v[152:167], v[68:71], v[180:183], v[152:167]
  ds_read_b64_tr_b16 v[60:61], v7 offset:16384
  ds_read_b64_tr_b16 v[62:63], v7 offset:17408
  s_barrier
  s_waitcnt vmcnt(14) lgkmcnt(4)
  v_mfma_f32_32x32x16_bf16 v[136:151], v[48:51], v[184:187], v[136:151]
  ds_read_b64_tr_b16 v[64:65], v6 offset:8192
  ds_read_b64_tr_b16 v[66:67], v6 offset:9216
  s_mov_b32 s76, 69632
  buffer_load_dwordx4 v[204:207], v16, s[52:55], s76 offen sc1
  v_mfma_f32_32x32x16_bf16 v[152:167], v[52:55], v[184:187], v[152:167]
  ds_read_b64_tr_b16 v[68:69], v7 offset:8192
  ds_read_b64_tr_b16 v[70:71], v7 offset:9216
  s_mov_b32 s76, 73728
  buffer_load_dwordx4 v[208:211], v16, s[52:55], s76 offen sc1
  s_waitcnt vmcnt(15) lgkmcnt(4)
  v_mfma_f32_32x32x16_bf16 v[136:151], v[56:59], v[188:191], v[136:151]
  ds_read_b64_tr_b16 v[48:49], v14 offset:8192
  ds_read_b64_tr_b16 v[50:51], v14 offset:9216
  s_mov_b32 s76, 77824
  buffer_load_dwordx4 v[212:215], v16, s[52:55], s76 offen sc1
  v_lshrrev_b32 v30, 5, v0
  v_and_b32 v31, 7, v0
  v_xor_b32 v30, v30, v31
  v_and_b32 v32, 31, v0
  v_lshl_or_b32 v30, v32, 4, v30
  v_lshlrev_b32 v30, 4, v30
  s_lshl_b32 s77, s63, 1
  s_add_u32 s77, s77, s62
  s_lshl_b32 s77, s77, 13
  v_add_u32 v22, s77, v30
  v_mfma_f32_32x32x16_bf16 v[152:167], v[60:63], v[188:191], v[152:167]
  ds_read_b64_tr_b16 v[52:53], v15 offset:8192
  ds_read_b64_tr_b16 v[54:55], v15 offset:9216
  v_xor_b32 v23, 32, v22
  v_xor_b32 v24, 64, v22
  v_xor_b32 v25, 96, v22
  v_lshrrev_b32 v30, 3, v0
  v_lshlrev_b32 v32, 1, v31
  v_xor_b32 v32, v32, v30
  v_lshl_or_b32 v32, v30, 4, v32
  v_lshlrev_b32 v32, 4, v32
  s_lshl_b32 s77, s61, 1
  v_add_u32 v26, s77, v32
  s_cmp_lg_u32 s60, 3
  s_cbranch_scc1 Lpc_88
  s_waitcnt lgkmcnt(0)
  s_cmp_ge_u32 s13, 8
  s_cbranch_scc1 Lpc_88
  s_mov_b32 s93, 0
Lsp_89:
  s_mov_b32 s13, 0
  s_atomic_add s13, s[14:15], s85 offset:384 glc
  s_add_u32 s93, s93, 1
  s_waitcnt lgkmcnt(0)
  s_cmp_ge_u32 s13, 8
  s_cbranch_scc1 Lpc_88
  s_cmp_lt_u32 s93, 20000
  s_cbranch_scc1 Lsp_89
Lpc_88:
  s_barrier
  s_waitcnt vmcnt(5) lgkmcnt(4)
  v_mfma_f32_32x32x16_bf16 v[136:151], v[64:67], v[192:195], v[136:151]
  ds_read_b64_tr_b16 v[56:57], v6 offset:0
  ds_read_b64_tr_b16 v[58:59], v6 offset:1024
  s_mov_b32 s76, 81920
  buffer_load_dwordx4 v[216:219], v16, s[52:55], s76 offen sc1
  v_xor_b32 v27, 16, v26
  v_mul_u32_u24 v30, 896, v30
  v_lshl_add_u32 v28, v31, 4, v30
  s_mul_i32 s77, s60, 7168
  s_add_u32 s86, s86, s77
  v_mfma_f32_32x32x16_bf16 v[152:167], v[68:71], v[192:195], v[152:167]
  ds_read_b64_tr_b16 v[60:61], v7 offset:0
  ds_read_b64_tr_b16 v[62:63], v7 offset:1024
  s_mov_b32 s76, 86016
  buffer_load_dwordx4 v[220:223], v16, s[52:55], s76 offen sc1
  s_waitcnt vmcnt(6) lgkmcnt(4)
  v_mfma_f32_32x32x16_bf16 v[136:151], v[48:51], v[196:199], v[136:151]
  ds_read_b64_tr_b16 v[64:65], v14 offset:0
  ds_read_b64_tr_b16 v[66:67], v14 offset:1024
  s_mov_b32 s76, 90112
  buffer_load_dwordx4 v[224:227], v16, s[52:55], s76 offen sc1
  v_mfma_f32_32x32x16_bf16 v[152:167], v[52:55], v[196:199], v[152:167]
  ds_read_b64_tr_b16 v[68:69], v15 offset:0
  ds_read_b64_tr_b16 v[70:71], v15 offset:1024
  s_mov_b32 s76, 94208
  buffer_load_dwordx4 v[228:231], v16, s[52:55], s76 offen sc1
  s_barrier
  s_waitcnt vmcnt(7) lgkmcnt(4)
  v_mfma_f32_32x32x16_bf16 v[136:151], v[56:59], v[200:203], v[136:151]
  ds_read_b64_tr_b16 v[48:49], v8 offset:57344
  ds_read_b64_tr_b16 v[50:51], v8 offset:58368
  s_mov_b32 s76, 98304
  buffer_load_dwordx4 v[232:235], v16, s[52:55], s76 offen sc1
  v_mfma_f32_32x32x16_bf16 v[152:167], v[60:63], v[200:203], v[152:167]
  ds_read_b64_tr_b16 v[52:53], v9 offset:57344
  ds_read_b64_tr_b16 v[54:55], v9 offset:58368
  s_waitcnt vmcnt(7) lgkmcnt(4)
  v_mfma_f32_32x32x16_bf16 v[136:151], v[64:67], v[204:207], v[136:151]
  ds_read_b64_tr_b16 v[56:57], v14 offset:57344
  ds_read_b64_tr_b16 v[58:59], v14 offset:58368
  s_mov_b32 s76, 102400
  buffer_load_dwordx4 v[236:239], v16, s[52:55], s76 offen sc1
  v_mfma_f32_32x32x16_bf16 v[152:167], v[68:71], v[204:207], v[152:167]
  ds_read_b64_tr_b16 v[60:61], v15 offset:57344
  ds_read_b64_tr_b16 v[62:63], v15 offset:58368
  s_barrier
  s_waitcnt vmcnt(7) lgkmcnt(4)
  v_mfma_f32_32x32x16_bf16 v[136:151], v[48:51], v[208:211], v[136:151]
  ds_read_b64_tr_b16 v[64:65], v8 offset:0
  ds_read_b64_tr_b16 v[66:67], v8 offset:1024
  s_mov_b32 s76, 106496
  buffer_load_dwordx4 v[240:243], v16, s[52:55], s76 offen sc1
  v_mfma_f32_32x32x16_bf16 v[152:167], v[52:55], v[208:211], v[152:167]
  ds_read_b64_tr_b16 v[68:69], v9 offset:0
  ds_read_b64_tr_b16 v[70:71], v9 offset:1024
  s_waitcnt vmcnt(7) lgkmcnt(4)
  v_mfma_f32_32x32x16_bf16 v[136:151], v[56:59], v[212:215], v[136:151]
  ds_read_b64_tr_b16 v[48:49], v8 offset:8192
  ds_read_b64_tr_b16 v[50:51], v8 offset:9216
  s_mov_b32 s76, 110592
  buffer_load_dwordx4 v[244:247], v16, s[52:55], s76 offen sc1
  v_mfma_f32_32x32x16_bf16 v[152:167], v[60:63], v[212:215], v[152:167]
  ds_read_b64_tr_b16 v[52:53], v9 offset:8192
  ds_read_b64_tr_b16 v[54:55], v9 offset:9216
  s_barrier
  s_waitcnt vmcnt(7) lgkmcnt(4)
  v_mfma_f32_32x32x16_bf16 v[136:151], v[64:67], v[216:219], v[136:151]
  s_add_u32 m0, s61, 155648
  ds_read_b64_tr_b16 v[56:57], v8 offset:49152
  ds_read_b64_tr_b16 v[58:59], v8 offset:50176
  s_mov_b32 s75, 0
  buffer_load_dwordx4 v4, s[28:31], s75 offen lds
  v_mfma_f32_32x32x16_bf16 v[152:167], v[68:71], v[216:219], v[152:167]
  s_add_u32 m0, s61, 147456
  ds_read_b64_tr_b16 v[60:61], v9 offset:49152
  ds_read_b64_tr_b16 v[62:63], v9 offset:50176
  s_mov_b32 s75, 50176
  buffer_load_dwordx4 v4, s[28:31], s75 offen lds
  s_waitcnt vmcnt(8) lgkmcnt(4)
  v_mfma_f32_32x32x16_bf16 v[136:151], v[48:51], v[220:223], v[136:151]
  s_add_u32 m0, s61, 139264
  ds_read_b64_tr_b16 v[64:65], v8 offset:16384
  ds_read_b64_tr_b16 v[66:67], v8 offset:17408
  s_mov_b32 s75, 200704
  buffer_load_dwordx4 v4, s[28:31], s75 offen lds
  v_mfma_f32_32x32x16_bf16 v[152:167], v[52:55], v[220:223], v[152:167]
  s_add_u32 m0, s61, 131072
  ds_read_b64_tr_b16 v[68:69], v9 offset:16384
  ds_read_b64_tr_b16 v[70:71], v9 offset:17408
  s_mov_b32 s75, 250880
  buffer_load_dwordx4 v4, s[28:31], s75 offen lds
  s_barrier
  s_waitcnt vmcnt(9) lgkmcnt(4)
  v_mfma_f32_32x32x16_bf16 v[136:151], v[56:59], v[224:227], v[136:151]
  s_add_u32 m0, s61, 122880
  ds_read_b64_tr_b16 v[48:49], v8 offset:24576
  ds_read_b64_tr_b16 v[50:51], v8 offset:25600
  s_mov_b32 s75, 100352
  buffer_load_dwordx4 v4, s[28:31], s75 offen lds
  v_mfma_f32_32x32x16_bf16 v[152:167], v[60:63], v[224:227], v[152:167]
  ds_read_b64_tr_b16 v[52:53], v9 offset:24576
  ds_read_b64_tr_b16 v[54:55], v9 offset:25600
  s_waitcnt vmcnt(9) lgkmcnt(4)
  v_mfma_f32_32x32x16_bf16 v[136:151], v[64:67], v[228:231], v[136:151]
  s_add_u32 m0, s61, 106496
  ds_read_b64_tr_b16 v[56:57], v14 offset:49152
  ds_read_b64_tr_b16 v[58:59], v14 offset:50176
  s_mov_b32 s75, 150528
  buffer_load_dwordx4 v4, s[28:31], s75 offen lds
  v_mfma_f32_32x32x16_bf16 v[152:167], v[68:71], v[228:231], v[152:167]
  ds_read_b64_tr_b16 v[60:61], v15 offset:49152
  ds_read_b64_tr_b16 v[62:63], v15 offset:50176
  s_barrier
  s_cmp_lg_u32 s60, 2
  s_cbranch_scc1 Lpi_90
  s_mov_b32 s13, 0
  s_atomic_add s13, s[14:15], s85 offset:512 glc
Lpi_90:
  s_waitcnt vmcnt(9) lgkmcnt(4)
  v_mfma_f32_32x32x16_bf16 v[136:151], v[48:51], v[232:235], v[136:151]
  s_add_u32 m0, s61, 98304
  ds_read_b64_tr_b16 v[64:65], v8 offset:32768
  ds_read_b64_tr_b16 v[66:67], v8 offset:33792
  s_mov_b32 s75, 301056
  buffer_load_dwordx4 v4, s[28:31], s75 offen lds
  v_mfma_f32_32x32x16_bf16 v[152:167], v[52:55], v[232:235], v[152:167]
  ds_read_b64_tr_b16 v[68:69], v9 offset:32768
  ds_read_b64_tr_b16 v[70:71], v9 offset:33792
  s_waitcnt vmcnt(9) lgkmcnt(4)
  v_mfma_f32_32x32x16_bf16 v[136:151], v[56:59], v[236:239], v[136:151]
  s_add_u32 m0, s61, 90112
  ds_read_b64_tr_b16 v[48:49], v8 offset:40960
  ds_read_b64_tr_b16 v[50:51], v8 offset:41984
  s_mov_b32 s75, 351232
  buffer_load_dwordx4 v4, s[28:31], s75 offen lds
  v_mfma_f32_32x32x16_bf16 v[152:167], v[60:63], v[236:239], v[152:167]
  ds_read_b64_tr_b16 v[52:53], v9 offset:40960
  ds_read_b64_tr_b16 v[54:55], v9 offset:41984
  s_cmp_lg_u32 s60, 2
  s_cbranch_scc1 Lpc_91
  s_waitcnt lgkmcnt(0)
  s_cmp_ge_u32 s13, 2
  s_cbranch_scc1 Lpc_91
  s_mov_b32 s93, 0
Lsp_92:
  s_mov_b32 s13, 0
  s_atomic_add s13, s[14:15], s85 offset:512 glc
  s_add_u32 s93, s93, 1
  s_waitcnt lgkmcnt(0)
  s_cmp_ge_u32 s13, 2
  s_cbranch_scc1 Lpc_91
  s_cmp_lt_u32 s93, 20000
  s_cbranch_scc1 Lsp_92
Lpc_91:
  s_waitcnt vmcnt(6)
  s_barrier
  s_cmp_lg_u32 s60, 3
  s_cbranch_scc1 Lpi_93
  s_mov_b32 s13, 0
  s_atomic_add s13, s[14:15], s85 offset:640 glc
Lpi_93:
  s_mov_b32 s76, 114688
  buffer_load_dwordx4 v[168:171], v16, s[52:55], s76 offen sc1
  s_waitcnt lgkmcnt(4)
  v_mfma_f32_32x32x16_bf16 v[136:151], v[64:67], v[240:243], v[136:151]
  s_lshr_b32 s77, s63, 1
  s_lshl_b32 s77, s77, 9
  v_subrev_u32 v8, s77, v8
  v_add_u32 v6, 131072, v8
  ds_read_b64_tr_b16 v[56:57], v6 offset:24576
  ds_read_b64_tr_b16 v[58:59], v6 offset:25600
  s_mov_b32 s76, 118784
  buffer_load_dwordx4 v[172:175], v16, s[52:55], s76 offen sc1
  v_mfma_f32_32x32x16_bf16 v[152:167], v[68:71], v[240:243], v[152:167]
  s_lshr_b32 s77, s63, 1
  s_lshl_b32 s77, s77, 9
  v_subrev_u32 v9, s77, v9
  v_add_u32 v7, 131072, v9
  ds_read_b64_tr_b16 v[60:61], v7 offset:24576
  ds_read_b64_tr_b16 v[62:63], v7 offset:25600
  s_mov_b32 s76, 131072
  buffer_load_dwordx4 v[176:179], v16, s[52:55], s76 offen sc1
  s_waitcnt lgkmcnt(4)
  v_mfma_f32_32x32x16_bf16 v[136:151], v[48:51], v[244:247], v[136:151]
  ds_read_b64_tr_b16 v[64:65], v6 offset:16384
  ds_read_b64_tr_b16 v[66:67], v6 offset:17408
  s_mov_b32 s76, 135168
  buffer_load_dwordx4 v[180:183], v16, s[52:55], s76 offen sc1
  v_mfma_f32_32x32x16_bf16 v[152:167], v[52:55], v[244:247], v[152:167]
  ds_read_b64_tr_b16 v[68:69], v7 offset:16384
  ds_read_b64_tr_b16 v[70:71], v7 offset:17408
  s_nop 4
  v_mul_f32 v136, v252, v136
  v_mul_f32 v137, v252, v137
  v_mul_f32 v138, v252, v138
  v_mul_f32 v139, v252, v139
  v_mul_f32 v140, v252, v140
  v_mul_f32 v141, v252, v141
  v_mul_f32 v142, v252, v142
  v_mul_f32 v143, v252, v143
  v_mul_f32 v144, v252, v144
  v_mul_f32 v145, v252, v145
  v_mul_f32 v146, v252, v146
  v_mul_f32 v147, v252, v147
  v_mul_f32 v148, v252, v148
  v_mul_f32 v149, v252, v149
  v_mul_f32 v150, v252, v150
  v_mul_f32 v151, v252, v151
  v_mul_f32 v152, v252, v152
  v_mul_f32 v153, v252, v153
  v_mul_f32 v154, v252, v154
  v_mul_f32 v155, v252, v155
  v_mul_f32 v156, v252, v156
  v_mul_f32 v157, v252, v157
  v_mul_f32 v158, v252, v158
  v_mul_f32 v159, v252, v159
  v_mul_f32 v160, v252, v160
  v_mul_f32 v161, v252, v161
  v_mul_f32 v162, v252, v162
  v_mul_f32 v163, v252, v163
  v_mul_f32 v164, v252, v164
  v_mul_f32 v165, v252, v165
  v_mul_f32 v166, v252, v166
  v_mul_f32 v167, v252, v167
  s_cmp_lg_u32 s60, 3
  s_cbranch_scc1 Lpc_94
  s_waitcnt lgkmcnt(0)
  s_cmp_ge_u32 s13, 2
  s_cbranch_scc1 Lpc_94
  s_mov_b32 s93, 0
Lsp_95:
  s_mov_b32 s13, 0
  s_atomic_add s13, s[14:15], s85 offset:640 glc
  s_add_u32 s93, s93, 1
  s_waitcnt lgkmcnt(0)
  s_cmp_ge_u32 s13, 2
  s_cbranch_scc1 Lpc_94
  s_cmp_lt_u32 s93, 20000
  s_cbranch_scc1 Lsp_95
Lpc_94:
  s_waitcnt vmcnt(4)
  s_barrier
  s_mov_b32 s76, 122880
  buffer_load_dwordx4 v[184:187], v16, s[52:55], s76 offen sc1
  s_waitcnt vmcnt(4) lgkmcnt(4)
  v_mfma_f32_32x32x16_bf16 v[136:151], v[56:59], v[168:171], v[136:151]
  ds_read_b64_tr_b16 v[48:49], v6 offset:8192
  ds_read_b64_tr_b16 v[50:51], v6 offset:9216
  s_mov_b32 s76, 126976
  buffer_load_dwordx4 v[188:191], v16, s[52:55], s76 offen sc1
  v_mfma_f32_32x32x16_bf16 v[152:167], v[60:63], v[168:171], v[152:167]
  ds_read_b64_tr_b16 v[52:53], v7 offset:8192
  ds_read_b64_tr_b16 v[54:55], v7 offset:9216
  s_mov_b32 s76, 139264
  buffer_load_dwordx4 v[192:195], v16, s[52:55], s76 offen sc1
  s_waitcnt vmcnt(5) lgkmcnt(4)
  v_mfma_f32_32x32x16_bf16 v[136:151], v[64:67], v[172:175], v[136:151]
  ds_read_b64_tr_b16 v[56:57], v6 offset:0
  ds_read_b64_tr_b16 v[58:59], v6 offset:1024
  s_mov_b32 s76, 143360
  buffer_load_dwordx4 v[196:199], v16, s[52:55], s76 offen sc1
  v_mfma_f32_32x32x16_bf16 v[152:167], v[68:71], v[172:175], v[152:167]
  ds_read_b64_tr_b16 v[60:61], v7 offset:0
  ds_read_b64_tr_b16 v[62:63], v7 offset:1024
  s_waitcnt vmcnt(5) lgkmcnt(4)
  v_mfma_f32_32x32x16_bf16 v[136:151], v[48:51], v[176:179], v[136:151]
  v_add_u32 v14, 65536, v8
  ds_read_b64_tr_b16 v[64:65], v14 offset:57344
  ds_read_b64_tr_b16 v[66:67], v14 offset:58368
  v_mfma_f32_32x32x16_bf16 v[152:167], v[52:55], v[176:179], v[152:167]
  v_add_u32 v15, 65536, v9
  ds_read_b64_tr_b16 v[68:69], v15 offset:57344
  ds_read_b64_tr_b16 v[70:71], v15 offset:58368
  s_waitcnt vmcnt(4) lgkmcnt(4)
  v_mfma_f32_32x32x16_bf16 v[136:151], v[56:59], v[180:183], v[136:151]
  ds_read_b64_tr_b16 v[48:49], v14 offset:40960
  ds_read_b64_tr_b16 v[50:51], v14 offset:41984
  v_mfma_f32_32x32x16_bf16 v[152:167], v[60:63], v[180:183], v[152:167]
  ds_read_b64_tr_b16 v[52:53], v15 offset:40960
  ds_read_b64_tr_b16 v[54:55], v15 offset:41984
  s_waitcnt vmcnt(3) lgkmcnt(4)
  v_mfma_f32_32x32x16_bf16 v[136:151], v[64:67], v[184:187], v[136:151]
  ds_read_b64_tr_b16 v[56:57], v14 offset:32768
  ds_read_b64_tr_b16 v[58:59], v14 offset:33792
  v_mfma_f32_32x32x16_bf16 v[152:167], v[68:71], v[184:187], v[152:167]
  ds_read_b64_tr_b16 v[60:61], v15 offset:32768
  ds_read_b64_tr_b16 v[62:63], v15 offset:33792
  s_waitcnt vmcnt(2) lgkmcnt(4)
  v_mfma_f32_32x32x16_bf16 v[136:151], v[48:51], v[188:191], v[136:151]
  ds_read_b64_tr_b16 v[64:65], v14 offset:24576
  ds_read_b64_tr_b16 v[66:67], v14 offset:25600
  v_mfma_f32_32x32x16_bf16 v[152:167], v[52:55], v[188:191], v[152:167]
  ds_read_b64_tr_b16 v[68:69], v15 offset:24576
  ds_read_b64_tr_b16 v[70:71], v15 offset:25600
  s_waitcnt vmcnt(1) lgkmcnt(4)
  v_mfma_f32_32x32x16_bf16 v[136:151], v[56:59], v[192:195], v[136:151]
  v_mfma_f32_32x32x16_bf16 v[152:167], v[60:63], v[192:195], v[152:167]
  s_waitcnt vmcnt(0) lgkmcnt(0)
  v_mfma_f32_32x32x16_bf16 v[136:151], v[64:67], v[196:199], v[136:151]
  v_mfma_f32_32x32x16_bf16 v[152:167], v[68:71], v[196:199], v[152:167]
  s_nop 10
  ds_write_b128 v22, v[136:139] offset:0
  ds_write_b128 v23, v[140:143] offset:0
  ds_write_b128 v24, v[144:147] offset:0
  ds_write_b128 v25, v[148:151] offset:0
  ds_write_b128 v22, v[152:155] offset:128
  ds_write_b128 v23, v[156:159] offset:128
  ds_write_b128 v24, v[160:163] offset:128
  ds_write_b128 v25, v[164:167] offset:128
  s_waitcnt lgkmcnt(0)
  s_barrier
  ds_read_b128 v[168:171], v26 offset:0
  ds_read_b128 v[172:175], v27 offset:0
  ds_read_b128 v[176:179], v26 offset:16384
  ds_read_b128 v[180:183], v27 offset:16384
  ds_read_b128 v[184:187], v26 offset:32768
  ds_read_b128 v[188:191], v27 offset:32768
  ds_read_b128 v[192:195], v26 offset:49152
  ds_read_b128 v[196:199], v27 offset:49152
  s_waitcnt lgkmcnt(4)
  v_pk_add_f32 v[168:169], v[168:169], v[176:177]
  v_pk_add_f32 v[170:171], v[170:171], v[178:179]
  v_pk_add_f32 v[172:173], v[172:173], v[180:181]
  v_pk_add_f32 v[174:175], v[174:175], v[182:183]
  s_waitcnt lgkmcnt(2)
  v_pk_add_f32 v[168:169], v[168:169], v[184:185]
  v_pk_add_f32 v[170:171], v[170:171], v[186:187]
  v_pk_add_f32 v[172:173], v[172:173], v[188:189]
  v_pk_add_f32 v[174:175], v[174:175], v[190:191]
  s_waitcnt lgkmcnt(0)
  v_pk_add_f32 v[168:169], v[168:169], v[192:193]
  v_pk_add_f32 v[170:171], v[170:171], v[194:195]
  v_pk_add_f32 v[172:173], v[172:173], v[196:197]
  v_pk_add_f32 v[174:175], v[174:175], v[198:199]
  v_cvt_pk_bf16_f32 v176, v168, v169
  v_cvt_pk_bf16_f32 v177, v170, v171
  v_cvt_pk_bf16_f32 v178, v172, v173
  v_cvt_pk_bf16_f32 v179, v174, v175
  buffer_store_dwordx4 v[176:179], v28, s[48:51], s86 offen
  s_endpgm
L_KVQ_end:
L_exit:
  s_endpgm
.fill (49152 - (. - L_far)) / 4, 4, 0xbf800000
.section .rodata,"a"
.p2align 6
.amdhsa_kernel gated_mix__linear_kernel_hedgehog__glu_gated_glu__prompt_kernel
  .amdhsa_next_free_vgpr 256
  .amdhsa_next_free_sgpr 102
  .amdhsa_accum_offset 256
  .amdhsa_group_segment_fixed_size 0
  .amdhsa_kernarg_size 96
  .amdhsa_user_sgpr_count 2
  .amdhsa_user_sgpr_kernarg_segment_ptr 1
  .amdhsa_system_sgpr_workgroup_id_x 1
.end_amdhsa_kernel
```
